```python
import torch

def _softmax(x, axis=-1):
    return torch.softmax(x, dim=axis)
def _gelu(x):
    return torch.nn.functional.gelu(x, approximate="tanh")
def _silu(x):
    return torch.nn.functional.silu(x)
def _sigmoid(x):
    return torch.sigmoid(x)
def _layernorm(x, axis=-1, eps=1e-5):
    m = x.mean(dim=axis, keepdim=True)
    v = x.var(dim=axis, keepdim=True, unbiased=False)
    return (x - m) / torch.sqrt(v + eps)
def _scatter_add(tgt, idx, src, axis=0):
    return tgt.clone().index_add_(axis, idx, src)
def _segment_sum(src, seg, n):
    out = torch.zeros((n,) + src.shape[1:], dtype=src.dtype)
    return out.index_add_(0, seg, src)
def _pad(x, pw):
    flat = tuple(v for pair in reversed(pw) for v in pair)
    return torch.nn.functional.pad(x, flat)

kernel_name = 'parallel_sum__mha_block__swiglu_ffn__prompt'

def setup_inputs():

    _w = (lambda a: (lambda t: t.to(torch.bfloat16) if t.is_floating_point() else t)(torch.as_tensor(a)))
    def _A_setup():
        B, S, D, H = 1, 2048, 640, 32
        return {
            "x": _w((lambda *s: torch.randn(*s, dtype=torch.bfloat16) * 0.05)(B, S, D)),
            "wqkv": _w((lambda *s: torch.randn(*s, dtype=torch.bfloat16) * 0.2)(D, 3 * D)),
            "wo": _w((lambda *s: torch.randn(*s, dtype=torch.bfloat16) * 0.1)(D, D)),
        }
    _A_in = _A_setup()

    def _B_setup():
        B, S, D, F = 1, 2048, 640, 1536
        return {
            "x": _w((lambda *s: torch.randn(*s, dtype=torch.bfloat16) * 0.05)(B, S, D)),
            "w_gate": _w((lambda *s: torch.randn(*s, dtype=torch.bfloat16) * 0.1)(D, F)),
            "w_up": _w((lambda *s: torch.randn(*s, dtype=torch.bfloat16) * 0.1)(D, F)),
            "w_down": _w((lambda *s: torch.randn(*s, dtype=torch.bfloat16) * 0.1)(F, D)),
        }
    _B_in = _B_setup()

    return {
        "A_x": _A_in["x"],
        "A_wqkv": _A_in["wqkv"],
        "A_wo": _A_in["wo"],
        "B_x": _B_in["x"],
        "B_w_gate": _B_in["w_gate"],
        "B_w_up": _B_in["w_up"],
        "B_w_down": _B_in["w_down"],
    }

def reference(A_x, A_wqkv, A_wo, B_x, B_w_gate, B_w_up, B_w_down):
    def _A_ref(x, wqkv, wo):
        B, S, D = x.shape
        H = 32
        Dh = D // H
        qkv = (lambda x, *d: x.permute(*d))((x @ wqkv).reshape(B, S, 3, H, Dh), 2, 0, 3, 1, 4)
        q, k, v = qkv[0], qkv[1], qkv[2]
        scores = torch.einsum("bhqd,bhkd->bhqk", q, k) * (Dh ** -0.5)
        p = _softmax(scores, axis=-1)
        o = torch.einsum("bhqk,bhkd->bhqd", p, v)
        return (lambda x, *d: x.permute(*d))(o, 0, 2, 1, 3).reshape(B, S, D) @ wo

    def _B_ref(x, w_gate, w_up, w_down):
        g = _silu(x @ w_gate)
        u = x @ w_up
        return (g * u) @ w_down

    x = A_x
    xn = _layernorm(x, axis=-1)
    return x + _A_ref(xn, A_wqkv, A_wo) + _B_ref(xn, B_w_gate, B_w_up, B_w_down)
```

```asm
; @launch kernel=k1_proj_kernel grid=(256,1,1) block=(512,1,1) lds=155648
; @launch kernel=k2_attn_kernel grid=(256,1,1) block=(768,1,1) lds=157696
.amdgcn_target "amdgcn-amd-amdhsa--gfx950"
.text
.globl k1_proj_kernel
.p2align 8
.type k1_proj_kernel,@function
k1_proj_kernel:
    s_cmp_ge_u32 s2, 256
    s_cbranch_scc1 K1_END
    s_load_dwordx4 s[4:7], s[0:1], 0
    s_load_dwordx4 s[8:11], s[0:1], 32
    s_load_dwordx2 s[12:13], s[0:1], 72
    v_lshrrev_b32 v1, 6, v0
    v_and_b32 v0, 63, v0
    s_and_b32 s3, s2, 7
    v_readfirstlane_b32 s14, v1
    s_lshr_b32 s17, s2, 3
    s_and_b32 s15, s3, 1
    s_lshl_b32 s15, s15, 3
    s_and_b32 s18, s17, 7
    s_add_u32 s15, s15, s18
    s_lshr_b32 s19, s3, 1
    s_lshl_b32 s19, s19, 2
    s_lshr_b32 s18, s17, 3
    s_add_u32 s19, s19, s18
    s_lshr_b32 s18, s19, 2
    s_mul_i32 s16, s18, 3
    s_add_u32 s18, s18, 12
    s_and_b32 s19, s19, 3
    s_add_u32 s16, s16, s19
    s_cmp_eq_u32 s19, 3
    s_cselect_b32 s16, s18, s16
    s_cmp_ge_u32 s14, 4
    s_cbranch_scc1 K1_LOADER
    v_lshlrev_b32 v90, 4, v0
    s_getpc_b64 s[96:97]
K1PF_PC:
    s_sub_u32 s96, s96, K1PF_PC-k1_proj_kernel
    s_subb_u32 s97, s97, 0
    s_and_b32 s97, s97, 0xffff
    s_mov_b32 s98, K1_END-k1_proj_kernel
    s_mov_b32 s99, 0x20000
    s_lshl_b32 s100, s14, 10
    buffer_load_dwordx4 v[16:19], v90, s[96:99], s100 offen
    s_add_u32 s100, s100, 4096
    buffer_load_dwordx4 v[20:23], v90, s[96:99], s100 offen
    s_add_u32 s100, s100, 4096
    buffer_load_dwordx4 v[24:27], v90, s[96:99], s100 offen
    s_add_u32 s100, s100, 4096
    buffer_load_dwordx4 v[28:31], v90, s[96:99], s100 offen
    s_add_u32 s100, s100, 4096
    buffer_load_dwordx4 v[32:35], v90, s[96:99], s100 offen
    s_add_u32 s100, s100, 4096
    buffer_load_dwordx4 v[36:39], v90, s[96:99], s100 offen
    s_add_u32 s100, s100, 4096
    s_branch K1_COMPUTE
K1_COMPUTE:
    s_waitcnt lgkmcnt(0)
    s_cmp_lt_u32 s16, 12
    s_cbranch_scc0 K1_SQ_C
    s_mov_b32 s51, 1
    s_movk_i32 s48, 3072
    s_lshl_b32 s17, s16, 8
    s_add_u32 s18, s17, 128
    s_add_u32 s28, s8, s17
    s_addc_u32 s29, s9, 0
    s_and_b32 s29, s29, 0xffff
    s_sub_u32 s30, 1966080, s17
    s_mov_b32 s31, 0x20000
    s_add_u32 s32, s10, s17
    s_addc_u32 s33, s11, 0
    s_and_b32 s33, s33, 0xffff
    s_sub_u32 s34, 1966080, s17
    s_mov_b32 s35, 0x20000
    s_add_u32 s36, s8, s18
    s_addc_u32 s37, s9, 0
    s_and_b32 s37, s37, 0xffff
    s_sub_u32 s38, 1966080, s18
    s_mov_b32 s39, 0x20000
    s_add_u32 s40, s10, s18
    s_addc_u32 s41, s11, 0
    s_and_b32 s41, s41, 0xffff
    s_sub_u32 s42, 1966080, s18
    s_mov_b32 s43, 0x20000
    s_add_u32 s50, s16, 20
    s_add_u32 s17, s16, 8
    s_cmp_lt_u32 s16, 10
    s_cselect_b32 s50, s50, s17
    s_mov_b32 s49, 0
    s_branch K1_SR4_C
K1_SQ_C:
    s_mov_b32 s51, 0
    s_movk_i32 s48, 3840
    s_sub_u32 s17, s16, 12
    s_mul_i32 s49, s17, 5
    s_sub_u32 s17, s49, 2
    s_cmp_eq_u32 s16, 15
    s_cselect_b32 s49, s17, s49
    s_add_u32 s17, s49, 0
    s_lshl_b32 s17, s17, 7
    s_add_u32 s28, s6, s17
    s_addc_u32 s29, s7, 0
    s_and_b32 s29, s29, 0xffff
    s_sub_u32 s30, 2457600, s17
    s_mov_b32 s31, 0x20000
    s_add_u32 s17, s49, 1
    s_lshl_b32 s17, s17, 7
    s_add_u32 s32, s6, s17
    s_addc_u32 s33, s7, 0
    s_and_b32 s33, s33, 0xffff
    s_sub_u32 s34, 2457600, s17
    s_mov_b32 s35, 0x20000
    s_add_u32 s17, s49, 2
    s_lshl_b32 s17, s17, 7
    s_add_u32 s36, s6, s17
    s_addc_u32 s37, s7, 0
    s_and_b32 s37, s37, 0xffff
    s_sub_u32 s38, 2457600, s17
    s_mov_b32 s39, 0x20000
    s_add_u32 s17, s49, 3
    s_lshl_b32 s17, s17, 7
    s_add_u32 s40, s6, s17
    s_addc_u32 s41, s7, 0
    s_and_b32 s41, s41, 0xffff
    s_sub_u32 s42, 2457600, s17
    s_mov_b32 s43, 0x20000
    s_add_u32 s50, s49, 4
K1_SR4_C:
    s_lshl_b32 s17, s50, 7
    s_add_u32 s44, s6, s17
    s_addc_u32 s45, s7, 0
    s_and_b32 s45, s45, 0xffff
    s_sub_u32 s46, 2457600, s17
    s_mov_b32 s47, 0x20000
    v_lshrrev_b32 v76, 3, v0
    v_and_b32 v77, 7, v0
    v_bfe_u32 v78, v76, 1, 1
    v_lshlrev_b32 v78, 1, v78
    v_xor_b32 v78, v78, v77
    v_lshlrev_b32 v78, 4, v78
    v_mul_lo_u32 v79, v76, s48
    v_add_u32 v72, v79, v78
    v_mul_u32_u24 v79, 3840, v76
    v_add_u32 v73, v79, v78
    v_xor_b32 v74, 64, v72
    v_xor_b32 v75, 64, v73
    s_lshl_b32 s17, s14, 4
    s_add_u32 s17, s17, 0
    s_mul_i32 s53, s17, s48
    s_lshl_b32 s3, s48, 3
    s_add_u32 s54, s53, s3
    s_mul_i32 s55, s17, 3840
    s_add_u32 s56, s55, 30720
    s_lshl_b32 s57, s14, 11
    s_lshl_b32 s65, s48, 6
    s_add_u32 m0, s57, 32768
    s_nop 0
    buffer_load_dwordx4 v72, s[28:31], s53 offen lds
    s_add_u32 m0, s57, 33792
    s_nop 0
    buffer_load_dwordx4 v74, s[28:31], s54 offen lds
    s_add_u32 m0, s57, 40960
    s_nop 0
    buffer_load_dwordx4 v72, s[32:35], s53 offen lds
    s_add_u32 m0, s57, 41984
    s_nop 0
    buffer_load_dwordx4 v74, s[32:35], s54 offen lds
    s_add_u32 m0, s57, 49152
    s_nop 0
    buffer_load_dwordx4 v72, s[36:39], s53 offen lds
    s_add_u32 m0, s57, 50176
    s_nop 0
    buffer_load_dwordx4 v74, s[36:39], s54 offen lds
    s_add_u32 m0, s57, 57344
    s_nop 0
    buffer_load_dwordx4 v72, s[40:43], s53 offen lds
    s_add_u32 m0, s57, 58368
    s_nop 0
    buffer_load_dwordx4 v74, s[40:43], s54 offen lds
    s_add_u32 m0, s57, 65536
    s_nop 0
    buffer_load_dwordx4 v73, s[44:47], s55 offen lds
    s_add_u32 m0, s57, 66560
    s_nop 0
    buffer_load_dwordx4 v75, s[44:47], s56 offen lds
    s_add_u32 s53, s53, s65
    s_add_u32 s54, s54, s65
    s_add_u32 s55, s55, 245760
    s_add_u32 s56, s56, 245760
    s_mov_b32 s24, s12
    s_and_b32 s25, s13, 0xffff
    s_mov_b32 s26, 25165824
    s_mov_b32 s27, 0x20000
    s_lshr_b32 s17, s14, 1
    s_and_b32 s18, s14, 1
    v_and_b32 v9, 31, v0
    v_lshrrev_b32 v10, 5, v0
    v_lshrrev_b32 v11, 1, v9
    v_and_b32 v11, 7, v11
    s_lshl_b32 s3, s17, 6
    v_add_u32 v12, s3, v9
    v_lshlrev_b32 v12, 7, v12
    v_and_b32 v13, 15, v0
    v_lshrrev_b32 v10, 4, v0
    s_lshl_b32 s3, s17, 6
    v_add_u32 v12, s3, v13
    v_lshlrev_b32 v12, 7, v12
    v_lshrrev_b32 v11, 1, v13
    v_xor_b32 v14, v10, v11
    v_lshl_add_u32 v2, v14, 4, v12
    v_add_u32 v14, 4, v10
    v_xor_b32 v14, v14, v11
    v_lshl_add_u32 v3, v14, 4, v12
    v_lshrrev_b32 v14, 2, v13
    v_lshl_add_u32 v14, v10, 3, v14
    v_lshlrev_b32 v14, 7, v14
    v_and_b32 v15, 3, v13
    v_lshl_add_u32 v14, v15, 3, v14
    v_lshrrev_b32 v15, 3, v13
    v_and_b32 v11, 1, v10
    v_lshl_or_b32 v15, v11, 1, v15
    s_lshl_b32 s3, s18, 14
    s_add_u32 s3, s3, 32768
    v_xor_b32 v11, 0, v15
    v_lshl_add_u32 v4, v11, 5, v14
    v_xor_b32 v11, 1, v15
    v_lshl_add_u32 v5, v11, 5, v14
    v_xor_b32 v11, 2, v15
    v_lshl_add_u32 v6, v11, 5, v14
    v_xor_b32 v11, 3, v15
    v_lshl_add_u32 v7, v11, 5, v14
    s_cmp_eq_u32 s18, 0
    s_cselect_b64 vcc, -1, 0
    s_nop 0
    v_cndmask_b32 v8, v6, v4, vcc
    v_cndmask_b32 v9, v7, v5, vcc
    v_add_u32 v8, 65536, v8
    v_add_u32 v9, 65536, v9
    v_add_u32 v4, s3, v4
    v_add_u32 v5, s3, v5
    v_add_u32 v6, s3, v6
    v_add_u32 v7, s3, v7
    v_mov_b32 v96, 0
    v_mov_b32 v97, 0
    v_mov_b32 v98, 0
    v_mov_b32 v99, 0
    v_mov_b32 v100, 0
    v_mov_b32 v101, 0
    v_mov_b32 v102, 0
    v_mov_b32 v103, 0
    v_mov_b32 v104, 0
    v_mov_b32 v105, 0
    v_mov_b32 v106, 0
    v_mov_b32 v107, 0
    v_mov_b32 v108, 0
    v_mov_b32 v109, 0
    v_mov_b32 v110, 0
    v_mov_b32 v111, 0
    v_mov_b32 v112, 0
    v_mov_b32 v113, 0
    v_mov_b32 v114, 0
    v_mov_b32 v115, 0
    v_mov_b32 v116, 0
    v_mov_b32 v117, 0
    v_mov_b32 v118, 0
    v_mov_b32 v119, 0
    v_mov_b32 v120, 0
    v_mov_b32 v121, 0
    v_mov_b32 v122, 0
    v_mov_b32 v123, 0
    v_mov_b32 v124, 0
    v_mov_b32 v125, 0
    v_mov_b32 v126, 0
    v_mov_b32 v127, 0
    v_mov_b32 v128, 0
    v_mov_b32 v129, 0
    v_mov_b32 v130, 0
    v_mov_b32 v131, 0
    v_mov_b32 v132, 0
    v_mov_b32 v133, 0
    v_mov_b32 v134, 0
    v_mov_b32 v135, 0
    v_mov_b32 v136, 0
    v_mov_b32 v137, 0
    v_mov_b32 v138, 0
    v_mov_b32 v139, 0
    v_mov_b32 v140, 0
    v_mov_b32 v141, 0
    v_mov_b32 v142, 0
    v_mov_b32 v143, 0
    v_mov_b32 v144, 0
    v_mov_b32 v145, 0
    v_mov_b32 v146, 0
    v_mov_b32 v147, 0
    v_mov_b32 v148, 0
    v_mov_b32 v149, 0
    v_mov_b32 v150, 0
    v_mov_b32 v151, 0
    v_mov_b32 v152, 0
    v_mov_b32 v153, 0
    v_mov_b32 v154, 0
    v_mov_b32 v155, 0
    v_mov_b32 v156, 0
    v_mov_b32 v157, 0
    v_mov_b32 v158, 0
    v_mov_b32 v159, 0
    v_mov_b32 v160, 0
    v_mov_b32 v161, 0
    v_mov_b32 v162, 0
    v_mov_b32 v163, 0
    v_mov_b32 v164, 0
    v_mov_b32 v165, 0
    v_mov_b32 v166, 0
    v_mov_b32 v167, 0
    v_mov_b32 v168, 0
    v_mov_b32 v169, 0
    v_mov_b32 v170, 0
    v_mov_b32 v171, 0
    v_mov_b32 v172, 0
    v_mov_b32 v173, 0
    v_mov_b32 v174, 0
    v_mov_b32 v175, 0
    v_mov_b32 v176, 0
    v_mov_b32 v177, 0
    v_mov_b32 v178, 0
    v_mov_b32 v179, 0
    v_mov_b32 v180, 0
    v_mov_b32 v181, 0
    v_mov_b32 v182, 0
    v_mov_b32 v183, 0
    v_mov_b32 v184, 0
    v_mov_b32 v185, 0
    v_mov_b32 v186, 0
    v_mov_b32 v187, 0
    v_mov_b32 v188, 0
    v_mov_b32 v189, 0
    v_mov_b32 v190, 0
    v_mov_b32 v191, 0
    v_mov_b32 v192, 0
    v_mov_b32 v193, 0
    v_mov_b32 v194, 0
    v_mov_b32 v195, 0
    v_mov_b32 v196, 0
    v_mov_b32 v197, 0
    v_mov_b32 v198, 0
    v_mov_b32 v199, 0
    v_mov_b32 v200, 0
    v_mov_b32 v201, 0
    v_mov_b32 v202, 0
    v_mov_b32 v203, 0
    v_mov_b32 v204, 0
    v_mov_b32 v205, 0
    v_mov_b32 v206, 0
    v_mov_b32 v207, 0
    v_mov_b32 v208, 0
    v_mov_b32 v209, 0
    v_mov_b32 v210, 0
    v_mov_b32 v211, 0
    v_mov_b32 v212, 0
    v_mov_b32 v213, 0
    v_mov_b32 v214, 0
    v_mov_b32 v215, 0
    v_mov_b32 v216, 0
    v_mov_b32 v217, 0
    v_mov_b32 v218, 0
    v_mov_b32 v219, 0
    v_mov_b32 v220, 0
    v_mov_b32 v221, 0
    v_mov_b32 v222, 0
    v_mov_b32 v223, 0
    v_mov_b32 v224, 0
    v_mov_b32 v225, 0
    v_mov_b32 v226, 0
    v_mov_b32 v227, 0
    v_mov_b32 v228, 0
    v_mov_b32 v229, 0
    v_mov_b32 v230, 0
    v_mov_b32 v231, 0
    v_mov_b32 v232, 0
    v_mov_b32 v233, 0
    v_mov_b32 v234, 0
    v_mov_b32 v235, 0
    v_mov_b32 v236, 0
    v_mov_b32 v237, 0
    v_mov_b32 v238, 0
    v_mov_b32 v239, 0
    v_mov_b32 v240, 0
    v_mov_b32 v241, 0
    v_mov_b32 v242, 0
    v_mov_b32 v243, 0
    v_mov_b32 v244, 0
    v_mov_b32 v245, 0
    v_mov_b32 v246, 0
    v_mov_b32 v247, 0
    v_mov_b32 v248, 0
    v_mov_b32 v249, 0
    v_mov_b32 v250, 0
    v_mov_b32 v251, 0
    v_mov_b32 v252, 0
    v_mov_b32 v253, 0
    v_mov_b32 v254, 0
    v_mov_b32 v255, 0
    s_barrier
    s_add_u32 m0, s57, 73728
    s_nop 0
    buffer_load_dwordx4 v72, s[28:31], s53 offen lds
    s_add_u32 m0, s57, 74752
    s_nop 0
    buffer_load_dwordx4 v74, s[28:31], s54 offen lds
    s_add_u32 m0, s57, 81920
    s_nop 0
    buffer_load_dwordx4 v72, s[32:35], s53 offen lds
    s_add_u32 m0, s57, 82944
    s_nop 0
    buffer_load_dwordx4 v74, s[32:35], s54 offen lds
    s_add_u32 m0, s57, 90112
    s_nop 0
    buffer_load_dwordx4 v72, s[36:39], s53 offen lds
    s_add_u32 m0, s57, 91136
    s_nop 0
    buffer_load_dwordx4 v74, s[36:39], s54 offen lds
    s_add_u32 m0, s57, 98304
    s_nop 0
    buffer_load_dwordx4 v72, s[40:43], s53 offen lds
    s_add_u32 m0, s57, 99328
    s_nop 0
    buffer_load_dwordx4 v74, s[40:43], s54 offen lds
    s_add_u32 m0, s57, 106496
    s_nop 0
    buffer_load_dwordx4 v73, s[44:47], s55 offen lds
    s_add_u32 m0, s57, 107520
    s_nop 0
    buffer_load_dwordx4 v75, s[44:47], s56 offen lds
    s_waitcnt vmcnt(10)
    s_cmp_lt_u32 s16, 10
    s_cbranch_scc0 K1_MAIN_B
    s_mov_b32 s58, 0
    s_mov_b32 s70, 0
    s_mov_b32 s66, 4294885376
    s_mov_b32 s67, 40960
    s_barrier
    ds_read_b64_tr_b16 v[48:49], v4 offset:0
    ds_read_b64_tr_b16 v[50:51], v4 offset:512
    ds_read_b128 v[16:19], v2 offset:0
    ds_read_b128 v[20:23], v2 offset:2048
    ds_read_b128 v[24:27], v2 offset:4096
    ds_read_b128 v[28:31], v2 offset:6144
    ds_read_b64_tr_b16 v[52:53], v5 offset:0
    ds_read_b64_tr_b16 v[54:55], v5 offset:512
    ds_read_b64_tr_b16 v[56:57], v4 offset:8192
    ds_read_b64_tr_b16 v[58:59], v4 offset:8704
K1_LOOP_A:
    s_waitcnt lgkmcnt(7)
    v_mfma_f32_16x16x32_bf16 v[96:99], v[48:51], v[16:19], v[96:99]
    ds_read_b64_tr_b16 v[60:61], v5 offset:8192
    s_waitcnt lgkmcnt(7)
    v_mfma_f32_16x16x32_bf16 v[136:139], v[48:51], v[20:23], v[136:139]
    ds_read_b64_tr_b16 v[62:63], v5 offset:8704
    s_waitcnt lgkmcnt(7)
    v_mfma_f32_16x16x32_bf16 v[176:179], v[48:51], v[24:27], v[176:179]
    ds_read_b128 v[32:35], v3 offset:0
    s_waitcnt lgkmcnt(7)
    v_mfma_f32_16x16x32_bf16 v[216:219], v[48:51], v[28:31], v[216:219]
    s_waitcnt lgkmcnt(5)
    v_mfma_f32_16x16x32_bf16 v[100:103], v[52:55], v[16:19], v[100:103]
    ds_read_b64_tr_b16 v[48:49], v6 offset:0
    v_mfma_f32_16x16x32_bf16 v[140:143], v[52:55], v[20:23], v[140:143]
    ds_read_b64_tr_b16 v[50:51], v6 offset:512
    v_mfma_f32_16x16x32_bf16 v[180:183], v[52:55], v[24:27], v[180:183]
    ds_read_b128 v[36:39], v3 offset:2048
    v_mfma_f32_16x16x32_bf16 v[220:223], v[52:55], v[28:31], v[220:223]
    s_waitcnt lgkmcnt(6)
    v_mfma_f32_16x16x32_bf16 v[104:107], v[56:59], v[16:19], v[104:107]
    ds_read_b64_tr_b16 v[52:53], v7 offset:0
    v_mfma_f32_16x16x32_bf16 v[144:147], v[56:59], v[20:23], v[144:147]
    ds_read_b64_tr_b16 v[54:55], v7 offset:512
    v_mfma_f32_16x16x32_bf16 v[184:187], v[56:59], v[24:27], v[184:187]
    ds_read_b128 v[40:43], v3 offset:4096
    v_mfma_f32_16x16x32_bf16 v[224:227], v[56:59], v[28:31], v[224:227]
    s_waitcnt lgkmcnt(7)
    v_mfma_f32_16x16x32_bf16 v[108:111], v[60:63], v[16:19], v[108:111]
    ds_read_b64_tr_b16 v[56:57], v6 offset:8192
    v_mfma_f32_16x16x32_bf16 v[148:151], v[60:63], v[20:23], v[148:151]
    ds_read_b64_tr_b16 v[58:59], v6 offset:8704
    v_mfma_f32_16x16x32_bf16 v[188:191], v[60:63], v[24:27], v[188:191]
    ds_read_b128 v[44:47], v3 offset:6144
    v_mfma_f32_16x16x32_bf16 v[228:231], v[60:63], v[28:31], v[228:231]
    s_waitcnt lgkmcnt(7)
    v_mfma_f32_16x16x32_bf16 v[112:115], v[48:51], v[16:19], v[112:115]
    ds_read_b64_tr_b16 v[60:61], v7 offset:8192
    v_mfma_f32_16x16x32_bf16 v[152:155], v[48:51], v[20:23], v[152:155]
    ds_read_b64_tr_b16 v[62:63], v7 offset:8704
    v_mfma_f32_16x16x32_bf16 v[192:195], v[48:51], v[24:27], v[192:195]
    v_mfma_f32_16x16x32_bf16 v[232:235], v[48:51], v[28:31], v[232:235]
    s_waitcnt lgkmcnt(6)
    v_mfma_f32_16x16x32_bf16 v[116:119], v[52:55], v[16:19], v[116:119]
    ds_read_b64_tr_b16 v[48:49], v8 offset:0
    v_mfma_f32_16x16x32_bf16 v[156:159], v[52:55], v[20:23], v[156:159]
    ds_read_b64_tr_b16 v[50:51], v8 offset:512
    v_mfma_f32_16x16x32_bf16 v[196:199], v[52:55], v[24:27], v[196:199]
    v_mfma_f32_16x16x32_bf16 v[236:239], v[52:55], v[28:31], v[236:239]
    s_waitcnt lgkmcnt(5)
    v_mfma_f32_16x16x32_bf16 v[120:123], v[56:59], v[16:19], v[120:123]
    ds_read_b64_tr_b16 v[52:53], v9 offset:0
    v_mfma_f32_16x16x32_bf16 v[160:163], v[56:59], v[20:23], v[160:163]
    ds_read_b64_tr_b16 v[54:55], v9 offset:512
    v_mfma_f32_16x16x32_bf16 v[200:203], v[56:59], v[24:27], v[200:203]
    v_mfma_f32_16x16x32_bf16 v[240:243], v[56:59], v[28:31], v[240:243]
    s_waitcnt lgkmcnt(4)
    v_mfma_f32_16x16x32_bf16 v[124:127], v[60:63], v[16:19], v[124:127]
    ds_read_b64_tr_b16 v[56:57], v4 offset:4096
    v_mfma_f32_16x16x32_bf16 v[164:167], v[60:63], v[20:23], v[164:167]
    ds_read_b64_tr_b16 v[58:59], v4 offset:4608
    v_mfma_f32_16x16x32_bf16 v[204:207], v[60:63], v[24:27], v[204:207]
    v_mfma_f32_16x16x32_bf16 v[244:247], v[60:63], v[28:31], v[244:247]
    s_waitcnt lgkmcnt(4)
    v_mfma_f32_16x16x32_bf16 v[128:131], v[16:19], v[48:51], v[128:131]
    ds_read_b64_tr_b16 v[60:61], v5 offset:4096
    v_mfma_f32_16x16x32_bf16 v[168:171], v[20:23], v[48:51], v[168:171]
    ds_read_b64_tr_b16 v[62:63], v5 offset:4608
    v_mfma_f32_16x16x32_bf16 v[208:211], v[24:27], v[48:51], v[208:211]
    v_mfma_f32_16x16x32_bf16 v[248:251], v[28:31], v[48:51], v[248:251]
    s_waitcnt lgkmcnt(4)
    v_mfma_f32_16x16x32_bf16 v[132:135], v[16:19], v[52:55], v[132:135]
    ds_read_b64_tr_b16 v[48:49], v4 offset:12288
    v_mfma_f32_16x16x32_bf16 v[172:175], v[20:23], v[52:55], v[172:175]
    ds_read_b64_tr_b16 v[50:51], v4 offset:12800
    v_mfma_f32_16x16x32_bf16 v[212:215], v[24:27], v[52:55], v[212:215]
    v_mfma_f32_16x16x32_bf16 v[252:255], v[28:31], v[52:55], v[252:255]
    s_waitcnt lgkmcnt(4)
    v_mfma_f32_16x16x32_bf16 v[96:99], v[56:59], v[32:35], v[96:99]
    ds_read_b64_tr_b16 v[52:53], v5 offset:12288
    v_mfma_f32_16x16x32_bf16 v[136:139], v[56:59], v[36:39], v[136:139]
    ds_read_b64_tr_b16 v[54:55], v5 offset:12800
    v_mfma_f32_16x16x32_bf16 v[176:179], v[56:59], v[40:43], v[176:179]
    v_mfma_f32_16x16x32_bf16 v[216:219], v[56:59], v[44:47], v[216:219]
    s_waitcnt lgkmcnt(4)
    v_mfma_f32_16x16x32_bf16 v[100:103], v[60:63], v[32:35], v[100:103]
    ds_read_b64_tr_b16 v[56:57], v6 offset:4096
    v_mfma_f32_16x16x32_bf16 v[140:143], v[60:63], v[36:39], v[140:143]
    ds_read_b64_tr_b16 v[58:59], v6 offset:4608
    v_mfma_f32_16x16x32_bf16 v[180:183], v[60:63], v[40:43], v[180:183]
    v_mfma_f32_16x16x32_bf16 v[220:223], v[60:63], v[44:47], v[220:223]
    s_waitcnt lgkmcnt(4)
    v_mfma_f32_16x16x32_bf16 v[104:107], v[48:51], v[32:35], v[104:107]
    ds_read_b64_tr_b16 v[60:61], v7 offset:4096
    v_mfma_f32_16x16x32_bf16 v[144:147], v[48:51], v[36:39], v[144:147]
    ds_read_b64_tr_b16 v[62:63], v7 offset:4608
    v_mfma_f32_16x16x32_bf16 v[184:187], v[48:51], v[40:43], v[184:187]
    v_mfma_f32_16x16x32_bf16 v[224:227], v[48:51], v[44:47], v[224:227]
    s_waitcnt lgkmcnt(4)
    v_mfma_f32_16x16x32_bf16 v[108:111], v[52:55], v[32:35], v[108:111]
    ds_read_b64_tr_b16 v[48:49], v6 offset:12288
    v_mfma_f32_16x16x32_bf16 v[148:151], v[52:55], v[36:39], v[148:151]
    ds_read_b64_tr_b16 v[50:51], v6 offset:12800
    v_mfma_f32_16x16x32_bf16 v[188:191], v[52:55], v[40:43], v[188:191]
    v_mfma_f32_16x16x32_bf16 v[228:231], v[52:55], v[44:47], v[228:231]
    s_waitcnt lgkmcnt(4)
    v_mfma_f32_16x16x32_bf16 v[112:115], v[56:59], v[32:35], v[112:115]
    ds_read_b64_tr_b16 v[52:53], v7 offset:12288
    s_add_u32 s70, s70, 1
    v_mfma_f32_16x16x32_bf16 v[152:155], v[56:59], v[36:39], v[152:155]
    ds_read_b64_tr_b16 v[54:55], v7 offset:12800
    s_cmp_eq_u32 s70, 3
    v_mfma_f32_16x16x32_bf16 v[192:195], v[56:59], v[40:43], v[192:195]
    s_cselect_b32 s59, s66, s67
    v_mfma_f32_16x16x32_bf16 v[232:235], v[56:59], v[44:47], v[232:235]
    s_cselect_b32 s70, 0, s70
    s_waitcnt lgkmcnt(4)
    v_mfma_f32_16x16x32_bf16 v[116:119], v[60:63], v[32:35], v[116:119]
    ds_read_b64_tr_b16 v[56:57], v8 offset:4096
    v_mfma_f32_16x16x32_bf16 v[156:159], v[60:63], v[36:39], v[156:159]
    ds_read_b64_tr_b16 v[58:59], v8 offset:4608
    v_mfma_f32_16x16x32_bf16 v[196:199], v[60:63], v[40:43], v[196:199]
    v_mfma_f32_16x16x32_bf16 v[236:239], v[60:63], v[44:47], v[236:239]
    s_waitcnt lgkmcnt(4)
    v_mfma_f32_16x16x32_bf16 v[120:123], v[48:51], v[32:35], v[120:123]
    ds_read_b64_tr_b16 v[60:61], v9 offset:4096
    v_mfma_f32_16x16x32_bf16 v[160:163], v[48:51], v[36:39], v[160:163]
    ds_read_b64_tr_b16 v[62:63], v9 offset:4608
    v_mfma_f32_16x16x32_bf16 v[200:203], v[48:51], v[40:43], v[200:203]
    v_mfma_f32_16x16x32_bf16 v[240:243], v[48:51], v[44:47], v[240:243]
    s_waitcnt lgkmcnt(4)
    v_mfma_f32_16x16x32_bf16 v[124:127], v[52:55], v[32:35], v[124:127]
    v_xor_b32 v2, 0x4000, v2
    v_xor_b32 v3, 0x4000, v3
    v_mfma_f32_16x16x32_bf16 v[164:167], v[52:55], v[36:39], v[164:167]
    v_add_u32 v4, s59, v4
    v_add_u32 v5, s59, v5
    v_mfma_f32_16x16x32_bf16 v[204:207], v[52:55], v[40:43], v[204:207]
    v_add_u32 v6, s59, v6
    v_add_u32 v7, s59, v7
    v_mfma_f32_16x16x32_bf16 v[244:247], v[52:55], v[44:47], v[244:247]
    v_add_u32 v8, s59, v8
    v_add_u32 v9, s59, v9
    s_waitcnt vmcnt(0) lgkmcnt(0)
    s_barrier
    v_mfma_f32_16x16x32_bf16 v[128:131], v[32:35], v[56:59], v[128:131]
    ds_read_b64_tr_b16 v[48:49], v4 offset:0
    ds_read_b64_tr_b16 v[50:51], v4 offset:512
    v_mfma_f32_16x16x32_bf16 v[168:171], v[36:39], v[56:59], v[168:171]
    ds_read_b128 v[16:19], v2 offset:0
    ds_read_b128 v[20:23], v2 offset:2048
    v_mfma_f32_16x16x32_bf16 v[208:211], v[40:43], v[56:59], v[208:211]
    v_mfma_f32_16x16x32_bf16 v[248:251], v[44:47], v[56:59], v[248:251]
    v_mfma_f32_16x16x32_bf16 v[132:135], v[32:35], v[60:63], v[132:135]
    ds_read_b128 v[24:27], v2 offset:4096
    ds_read_b128 v[28:31], v2 offset:6144
    v_mfma_f32_16x16x32_bf16 v[172:175], v[36:39], v[60:63], v[172:175]
    ds_read_b64_tr_b16 v[52:53], v5 offset:0
    ds_read_b64_tr_b16 v[54:55], v5 offset:512
    v_mfma_f32_16x16x32_bf16 v[212:215], v[40:43], v[60:63], v[212:215]
    ds_read_b64_tr_b16 v[56:57], v4 offset:8192
    ds_read_b64_tr_b16 v[58:59], v4 offset:8704
    v_mfma_f32_16x16x32_bf16 v[252:255], v[44:47], v[60:63], v[252:255]
    s_add_u32 s58, s58, 1
    s_cmp_lt_u32 s58, 10
    s_cbranch_scc1 K1_LOOP_A
    s_branch K1_EPI
K1_MAIN_B:
    s_mov_b32 s58, 0
    s_mov_b32 s70, 0
    s_mov_b32 s66, 4294885376
    s_mov_b32 s67, 40960
    s_barrier
    ds_read_b64_tr_b16 v[48:49], v4 offset:0
    ds_read_b64_tr_b16 v[50:51], v4 offset:512
    ds_read_b128 v[16:19], v2 offset:0
    ds_read_b128 v[20:23], v2 offset:2048
    ds_read_b128 v[24:27], v2 offset:4096
    ds_read_b128 v[28:31], v2 offset:6144
    ds_read_b64_tr_b16 v[52:53], v5 offset:0
    ds_read_b64_tr_b16 v[54:55], v5 offset:512
    ds_read_b64_tr_b16 v[56:57], v4 offset:8192
    ds_read_b64_tr_b16 v[58:59], v4 offset:8704
K1_LOOP_B:
    s_waitcnt lgkmcnt(7)
    v_mfma_f32_16x16x32_bf16 v[96:99], v[48:51], v[16:19], v[96:99]
    ds_read_b64_tr_b16 v[60:61], v5 offset:8192
    s_waitcnt lgkmcnt(7)
    v_mfma_f32_16x16x32_bf16 v[136:139], v[48:51], v[20:23], v[136:139]
    ds_read_b64_tr_b16 v[62:63], v5 offset:8704
    s_waitcnt lgkmcnt(7)
    v_mfma_f32_16x16x32_bf16 v[176:179], v[48:51], v[24:27], v[176:179]
    ds_read_b128 v[32:35], v3 offset:0
    s_waitcnt lgkmcnt(7)
    v_mfma_f32_16x16x32_bf16 v[216:219], v[48:51], v[28:31], v[216:219]
    s_waitcnt lgkmcnt(5)
    v_mfma_f32_16x16x32_bf16 v[100:103], v[52:55], v[16:19], v[100:103]
    ds_read_b64_tr_b16 v[48:49], v6 offset:0
    v_mfma_f32_16x16x32_bf16 v[140:143], v[52:55], v[20:23], v[140:143]
    ds_read_b64_tr_b16 v[50:51], v6 offset:512
    v_mfma_f32_16x16x32_bf16 v[180:183], v[52:55], v[24:27], v[180:183]
    ds_read_b128 v[36:39], v3 offset:2048
    v_mfma_f32_16x16x32_bf16 v[220:223], v[52:55], v[28:31], v[220:223]
    s_waitcnt lgkmcnt(6)
    v_mfma_f32_16x16x32_bf16 v[104:107], v[56:59], v[16:19], v[104:107]
    ds_read_b64_tr_b16 v[52:53], v7 offset:0
    v_mfma_f32_16x16x32_bf16 v[144:147], v[56:59], v[20:23], v[144:147]
    ds_read_b64_tr_b16 v[54:55], v7 offset:512
    v_mfma_f32_16x16x32_bf16 v[184:187], v[56:59], v[24:27], v[184:187]
    ds_read_b128 v[40:43], v3 offset:4096
    v_mfma_f32_16x16x32_bf16 v[224:227], v[56:59], v[28:31], v[224:227]
    s_waitcnt lgkmcnt(7)
    v_mfma_f32_16x16x32_bf16 v[108:111], v[60:63], v[16:19], v[108:111]
    ds_read_b64_tr_b16 v[56:57], v6 offset:8192
    v_mfma_f32_16x16x32_bf16 v[148:151], v[60:63], v[20:23], v[148:151]
    ds_read_b64_tr_b16 v[58:59], v6 offset:8704
    v_mfma_f32_16x16x32_bf16 v[188:191], v[60:63], v[24:27], v[188:191]
    ds_read_b128 v[44:47], v3 offset:6144
    v_mfma_f32_16x16x32_bf16 v[228:231], v[60:63], v[28:31], v[228:231]
    s_waitcnt lgkmcnt(7)
    v_mfma_f32_16x16x32_bf16 v[112:115], v[48:51], v[16:19], v[112:115]
    ds_read_b64_tr_b16 v[60:61], v7 offset:8192
    v_mfma_f32_16x16x32_bf16 v[152:155], v[48:51], v[20:23], v[152:155]
    ds_read_b64_tr_b16 v[62:63], v7 offset:8704
    v_mfma_f32_16x16x32_bf16 v[192:195], v[48:51], v[24:27], v[192:195]
    v_mfma_f32_16x16x32_bf16 v[232:235], v[48:51], v[28:31], v[232:235]
    s_waitcnt lgkmcnt(6)
    v_mfma_f32_16x16x32_bf16 v[116:119], v[52:55], v[16:19], v[116:119]
    ds_read_b64_tr_b16 v[48:49], v8 offset:0
    v_mfma_f32_16x16x32_bf16 v[156:159], v[52:55], v[20:23], v[156:159]
    ds_read_b64_tr_b16 v[50:51], v8 offset:512
    v_mfma_f32_16x16x32_bf16 v[196:199], v[52:55], v[24:27], v[196:199]
    v_mfma_f32_16x16x32_bf16 v[236:239], v[52:55], v[28:31], v[236:239]
    s_waitcnt lgkmcnt(5)
    v_mfma_f32_16x16x32_bf16 v[120:123], v[56:59], v[16:19], v[120:123]
    ds_read_b64_tr_b16 v[52:53], v9 offset:0
    v_mfma_f32_16x16x32_bf16 v[160:163], v[56:59], v[20:23], v[160:163]
    ds_read_b64_tr_b16 v[54:55], v9 offset:512
    v_mfma_f32_16x16x32_bf16 v[200:203], v[56:59], v[24:27], v[200:203]
    v_mfma_f32_16x16x32_bf16 v[240:243], v[56:59], v[28:31], v[240:243]
    s_waitcnt lgkmcnt(4)
    v_mfma_f32_16x16x32_bf16 v[124:127], v[60:63], v[16:19], v[124:127]
    ds_read_b64_tr_b16 v[56:57], v4 offset:4096
    v_mfma_f32_16x16x32_bf16 v[164:167], v[60:63], v[20:23], v[164:167]
    ds_read_b64_tr_b16 v[58:59], v4 offset:4608
    v_mfma_f32_16x16x32_bf16 v[204:207], v[60:63], v[24:27], v[204:207]
    v_mfma_f32_16x16x32_bf16 v[244:247], v[60:63], v[28:31], v[244:247]
    s_waitcnt lgkmcnt(4)
    v_mfma_f32_16x16x32_bf16 v[128:131], v[48:51], v[16:19], v[128:131]
    ds_read_b64_tr_b16 v[60:61], v5 offset:4096
    v_mfma_f32_16x16x32_bf16 v[168:171], v[48:51], v[20:23], v[168:171]
    ds_read_b64_tr_b16 v[62:63], v5 offset:4608
    v_mfma_f32_16x16x32_bf16 v[208:211], v[48:51], v[24:27], v[208:211]
    v_mfma_f32_16x16x32_bf16 v[248:251], v[48:51], v[28:31], v[248:251]
    s_waitcnt lgkmcnt(4)
    v_mfma_f32_16x16x32_bf16 v[132:135], v[52:55], v[16:19], v[132:135]
    ds_read_b64_tr_b16 v[48:49], v4 offset:12288
    v_mfma_f32_16x16x32_bf16 v[172:175], v[52:55], v[20:23], v[172:175]
    ds_read_b64_tr_b16 v[50:51], v4 offset:12800
    v_mfma_f32_16x16x32_bf16 v[212:215], v[52:55], v[24:27], v[212:215]
    v_mfma_f32_16x16x32_bf16 v[252:255], v[52:55], v[28:31], v[252:255]
    s_waitcnt lgkmcnt(4)
    v_mfma_f32_16x16x32_bf16 v[96:99], v[56:59], v[32:35], v[96:99]
    ds_read_b64_tr_b16 v[52:53], v5 offset:12288
    v_mfma_f32_16x16x32_bf16 v[136:139], v[56:59], v[36:39], v[136:139]
    ds_read_b64_tr_b16 v[54:55], v5 offset:12800
    v_mfma_f32_16x16x32_bf16 v[176:179], v[56:59], v[40:43], v[176:179]
    v_mfma_f32_16x16x32_bf16 v[216:219], v[56:59], v[44:47], v[216:219]
    s_waitcnt lgkmcnt(4)
    v_mfma_f32_16x16x32_bf16 v[100:103], v[60:63], v[32:35], v[100:103]
    ds_read_b64_tr_b16 v[56:57], v6 offset:4096
    v_mfma_f32_16x16x32_bf16 v[140:143], v[60:63], v[36:39], v[140:143]
    ds_read_b64_tr_b16 v[58:59], v6 offset:4608
    v_mfma_f32_16x16x32_bf16 v[180:183], v[60:63], v[40:43], v[180:183]
    v_mfma_f32_16x16x32_bf16 v[220:223], v[60:63], v[44:47], v[220:223]
    s_waitcnt lgkmcnt(4)
    v_mfma_f32_16x16x32_bf16 v[104:107], v[48:51], v[32:35], v[104:107]
    ds_read_b64_tr_b16 v[60:61], v7 offset:4096
    v_mfma_f32_16x16x32_bf16 v[144:147], v[48:51], v[36:39], v[144:147]
    ds_read_b64_tr_b16 v[62:63], v7 offset:4608
    v_mfma_f32_16x16x32_bf16 v[184:187], v[48:51], v[40:43], v[184:187]
    v_mfma_f32_16x16x32_bf16 v[224:227], v[48:51], v[44:47], v[224:227]
    s_waitcnt lgkmcnt(4)
    v_mfma_f32_16x16x32_bf16 v[108:111], v[52:55], v[32:35], v[108:111]
    ds_read_b64_tr_b16 v[48:49], v6 offset:12288
    v_mfma_f32_16x16x32_bf16 v[148:151], v[52:55], v[36:39], v[148:151]
    ds_read_b64_tr_b16 v[50:51], v6 offset:12800
    v_mfma_f32_16x16x32_bf16 v[188:191], v[52:55], v[40:43], v[188:191]
    v_mfma_f32_16x16x32_bf16 v[228:231], v[52:55], v[44:47], v[228:231]
    s_waitcnt lgkmcnt(4)
    v_mfma_f32_16x16x32_bf16 v[112:115], v[56:59], v[32:35], v[112:115]
    ds_read_b64_tr_b16 v[52:53], v7 offset:12288
    s_add_u32 s70, s70, 1
    v_mfma_f32_16x16x32_bf16 v[152:155], v[56:59], v[36:39], v[152:155]
    ds_read_b64_tr_b16 v[54:55], v7 offset:12800
    s_cmp_eq_u32 s70, 3
    v_mfma_f32_16x16x32_bf16 v[192:195], v[56:59], v[40:43], v[192:195]
    s_cselect_b32 s59, s66, s67
    v_mfma_f32_16x16x32_bf16 v[232:235], v[56:59], v[44:47], v[232:235]
    s_cselect_b32 s70, 0, s70
    s_waitcnt lgkmcnt(4)
    v_mfma_f32_16x16x32_bf16 v[116:119], v[60:63], v[32:35], v[116:119]
    ds_read_b64_tr_b16 v[56:57], v8 offset:4096
    v_mfma_f32_16x16x32_bf16 v[156:159], v[60:63], v[36:39], v[156:159]
    ds_read_b64_tr_b16 v[58:59], v8 offset:4608
    v_mfma_f32_16x16x32_bf16 v[196:199], v[60:63], v[40:43], v[196:199]
    v_mfma_f32_16x16x32_bf16 v[236:239], v[60:63], v[44:47], v[236:239]
    s_waitcnt lgkmcnt(4)
    v_mfma_f32_16x16x32_bf16 v[120:123], v[48:51], v[32:35], v[120:123]
    ds_read_b64_tr_b16 v[60:61], v9 offset:4096
    v_mfma_f32_16x16x32_bf16 v[160:163], v[48:51], v[36:39], v[160:163]
    ds_read_b64_tr_b16 v[62:63], v9 offset:4608
    v_mfma_f32_16x16x32_bf16 v[200:203], v[48:51], v[40:43], v[200:203]
    v_mfma_f32_16x16x32_bf16 v[240:243], v[48:51], v[44:47], v[240:243]
    s_waitcnt lgkmcnt(4)
    v_mfma_f32_16x16x32_bf16 v[124:127], v[52:55], v[32:35], v[124:127]
    v_xor_b32 v2, 0x4000, v2
    v_xor_b32 v3, 0x4000, v3
    v_mfma_f32_16x16x32_bf16 v[164:167], v[52:55], v[36:39], v[164:167]
    v_add_u32 v4, s59, v4
    v_add_u32 v5, s59, v5
    v_mfma_f32_16x16x32_bf16 v[204:207], v[52:55], v[40:43], v[204:207]
    v_add_u32 v6, s59, v6
    v_add_u32 v7, s59, v7
    v_mfma_f32_16x16x32_bf16 v[244:247], v[52:55], v[44:47], v[244:247]
    v_add_u32 v8, s59, v8
    v_add_u32 v9, s59, v9
    s_waitcnt vmcnt(0) lgkmcnt(0)
    s_barrier
    v_mfma_f32_16x16x32_bf16 v[128:131], v[56:59], v[32:35], v[128:131]
    ds_read_b64_tr_b16 v[48:49], v4 offset:0
    ds_read_b64_tr_b16 v[50:51], v4 offset:512
    v_mfma_f32_16x16x32_bf16 v[168:171], v[56:59], v[36:39], v[168:171]
    ds_read_b128 v[16:19], v2 offset:0
    ds_read_b128 v[20:23], v2 offset:2048
    v_mfma_f32_16x16x32_bf16 v[208:211], v[56:59], v[40:43], v[208:211]
    v_mfma_f32_16x16x32_bf16 v[248:251], v[56:59], v[44:47], v[248:251]
    v_mfma_f32_16x16x32_bf16 v[132:135], v[60:63], v[32:35], v[132:135]
    ds_read_b128 v[24:27], v2 offset:4096
    ds_read_b128 v[28:31], v2 offset:6144
    v_mfma_f32_16x16x32_bf16 v[172:175], v[60:63], v[36:39], v[172:175]
    ds_read_b64_tr_b16 v[52:53], v5 offset:0
    ds_read_b64_tr_b16 v[54:55], v5 offset:512
    v_mfma_f32_16x16x32_bf16 v[212:215], v[60:63], v[40:43], v[212:215]
    ds_read_b64_tr_b16 v[56:57], v4 offset:8192
    ds_read_b64_tr_b16 v[58:59], v4 offset:8704
    v_mfma_f32_16x16x32_bf16 v[252:255], v[60:63], v[44:47], v[252:255]
    s_add_u32 s58, s58, 1
    s_cmp_lt_u32 s58, 10
    s_cbranch_scc1 K1_LOOP_B
K1_EPI:
    s_waitcnt lgkmcnt(0)
    s_lshr_b32 s17, s14, 1
    s_and_b32 s70, s14, 1
    s_lshl_b32 s52, s15, 2
    s_lshl_b32 s3, s17, 1
    s_add_u32 s52, s52, s3
    v_and_b32 v10, 15, v0
    v_lshrrev_b32 v11, 4, v0
    v_lshrrev_b32 v12, 5, v0
    v_lshl_add_u32 v9, v12, 4, v10
    v_and_b32 v12, 1, v11
    v_lshl_add_u32 v9, v12, 5, v9
    v_lshlrev_b32 v9, 4, v9
    s_mov_b32 s74, 0xbfb8aa3b
    s_mov_b32 s75, 0xbfb8aa3b
    s_mov_b32 s18, 1.0
    s_mov_b32 s19, 1.0
    s_nop 4
    s_cmp_eq_u32 s51, 0
    s_cbranch_scc1 K1_EPI_QONLY
    s_add_u32 s3, s52, 0
    s_mul_i32 s3, s3, 136
    s_lshl_b32 s17, s16, 3
    s_add_u32 s3, s3, s17
    s_lshl_b32 s17, s70, 2
    s_add_u32 s3, s3, s17
    s_add_u32 s3, s3, 0
    s_lshl_b32 s3, s3, 10
    s_add_u32 s68, s3, 9437184
    s_add_u32 s66, s68, 1024
    v_pk_mul_f32 v[16:17], v[96:97], s[74:75]
    v_pk_mul_f32 v[18:19], v[98:99], s[74:75]
    v_pk_mul_f32 v[20:21], v[136:137], s[74:75]
    v_pk_mul_f32 v[22:23], v[138:139], s[74:75]
    v_exp_f32 v16, v16
    v_exp_f32 v17, v17
    v_exp_f32 v18, v18
    v_exp_f32 v19, v19
    v_exp_f32 v20, v20
    v_exp_f32 v21, v21
    v_exp_f32 v22, v22
    v_exp_f32 v23, v23
    v_pk_mul_f32 v[96:97], v[96:97], v[104:105]
    v_pk_mul_f32 v[98:99], v[98:99], v[106:107]
    v_pk_mul_f32 v[136:137], v[136:137], v[144:145]
    v_pk_mul_f32 v[138:139], v[138:139], v[146:147]
    v_pk_add_f32 v[16:17], v[16:17], s[18:19]
    v_pk_add_f32 v[18:19], v[18:19], s[18:19]
    v_pk_add_f32 v[20:21], v[20:21], s[18:19]
    v_pk_add_f32 v[22:23], v[22:23], s[18:19]
    v_rcp_f32 v16, v16
    v_rcp_f32 v17, v17
    v_rcp_f32 v18, v18
    v_rcp_f32 v19, v19
    v_rcp_f32 v20, v20
    v_rcp_f32 v21, v21
    v_rcp_f32 v22, v22
    v_rcp_f32 v23, v23
    s_nop 0
    v_pk_mul_f32 v[96:97], v[96:97], v[16:17]
    v_pk_mul_f32 v[98:99], v[98:99], v[18:19]
    v_pk_mul_f32 v[136:137], v[136:137], v[20:21]
    v_pk_mul_f32 v[138:139], v[138:139], v[22:23]
    v_cvt_pk_bf16_f32 v32, v96, v97
    v_cvt_pk_bf16_f32 v33, v98, v99
    v_cvt_pk_bf16_f32 v34, v136, v137
    v_cvt_pk_bf16_f32 v35, v138, v139
    s_nop 1
    v_permlane32_swap_b32 v32, v34
    v_permlane32_swap_b32 v33, v35
    buffer_store_dwordx4 v[32:35], v9, s[24:27], s68 offen sc1
    v_pk_mul_f32 v[24:25], v[100:101], s[74:75]
    v_pk_mul_f32 v[26:27], v[102:103], s[74:75]
    v_pk_mul_f32 v[28:29], v[140:141], s[74:75]
    v_pk_mul_f32 v[30:31], v[142:143], s[74:75]
    v_exp_f32 v24, v24
    v_exp_f32 v25, v25
    v_exp_f32 v26, v26
    v_exp_f32 v27, v27
    v_exp_f32 v28, v28
    v_exp_f32 v29, v29
    v_exp_f32 v30, v30
    v_exp_f32 v31, v31
    v_pk_mul_f32 v[100:101], v[100:101], v[108:109]
    v_pk_mul_f32 v[102:103], v[102:103], v[110:111]
    v_pk_mul_f32 v[140:141], v[140:141], v[148:149]
    v_pk_mul_f32 v[142:143], v[142:143], v[150:151]
    v_pk_add_f32 v[24:25], v[24:25], s[18:19]
    v_pk_add_f32 v[26:27], v[26:27], s[18:19]
    v_pk_add_f32 v[28:29], v[28:29], s[18:19]
    v_pk_add_f32 v[30:31], v[30:31], s[18:19]
    v_rcp_f32 v24, v24
    v_rcp_f32 v25, v25
    v_rcp_f32 v26, v26
    v_rcp_f32 v27, v27
    v_rcp_f32 v28, v28
    v_rcp_f32 v29, v29
    v_rcp_f32 v30, v30
    v_rcp_f32 v31, v31
    s_nop 0
    v_pk_mul_f32 v[100:101], v[100:101], v[24:25]
    v_pk_mul_f32 v[102:103], v[102:103], v[26:27]
    v_pk_mul_f32 v[140:141], v[140:141], v[28:29]
    v_pk_mul_f32 v[142:143], v[142:143], v[30:31]
    v_cvt_pk_bf16_f32 v36, v100, v101
    v_cvt_pk_bf16_f32 v37, v102, v103
    v_cvt_pk_bf16_f32 v38, v140, v141
    v_cvt_pk_bf16_f32 v39, v142, v143
    s_nop 1
    v_permlane32_swap_b32 v36, v38
    v_permlane32_swap_b32 v37, v39
    buffer_store_dwordx4 v[36:39], v9, s[24:27], s66 offen sc1
    s_add_u32 s3, s52, 0
    s_mul_i32 s3, s3, 136
    s_lshl_b32 s17, s16, 3
    s_add_u32 s3, s3, s17
    s_lshl_b32 s17, s70, 2
    s_add_u32 s3, s3, s17
    s_add_u32 s3, s3, 2
    s_lshl_b32 s3, s3, 10
    s_add_u32 s68, s3, 9437184
    s_add_u32 s66, s68, 1024
    v_pk_mul_f32 v[16:17], v[112:113], s[74:75]
    v_pk_mul_f32 v[18:19], v[114:115], s[74:75]
    v_pk_mul_f32 v[20:21], v[152:153], s[74:75]
    v_pk_mul_f32 v[22:23], v[154:155], s[74:75]
    v_exp_f32 v16, v16
    v_exp_f32 v17, v17
    v_exp_f32 v18, v18
    v_exp_f32 v19, v19
    v_exp_f32 v20, v20
    v_exp_f32 v21, v21
    v_exp_f32 v22, v22
    v_exp_f32 v23, v23
    v_pk_mul_f32 v[112:113], v[112:113], v[120:121]
    v_pk_mul_f32 v[114:115], v[114:115], v[122:123]
    v_pk_mul_f32 v[152:153], v[152:153], v[160:161]
    v_pk_mul_f32 v[154:155], v[154:155], v[162:163]
    v_pk_add_f32 v[16:17], v[16:17], s[18:19]
    v_pk_add_f32 v[18:19], v[18:19], s[18:19]
    v_pk_add_f32 v[20:21], v[20:21], s[18:19]
    v_pk_add_f32 v[22:23], v[22:23], s[18:19]
    v_rcp_f32 v16, v16
    v_rcp_f32 v17, v17
    v_rcp_f32 v18, v18
    v_rcp_f32 v19, v19
    v_rcp_f32 v20, v20
    v_rcp_f32 v21, v21
    v_rcp_f32 v22, v22
    v_rcp_f32 v23, v23
    s_nop 0
    v_pk_mul_f32 v[112:113], v[112:113], v[16:17]
    v_pk_mul_f32 v[114:115], v[114:115], v[18:19]
    v_pk_mul_f32 v[152:153], v[152:153], v[20:21]
    v_pk_mul_f32 v[154:155], v[154:155], v[22:23]
    v_cvt_pk_bf16_f32 v40, v112, v113
    v_cvt_pk_bf16_f32 v41, v114, v115
    v_cvt_pk_bf16_f32 v42, v152, v153
    v_cvt_pk_bf16_f32 v43, v154, v155
    s_nop 1
    v_permlane32_swap_b32 v40, v42
    v_permlane32_swap_b32 v41, v43
    buffer_store_dwordx4 v[40:43], v9, s[24:27], s68 offen sc1
    v_pk_mul_f32 v[24:25], v[116:117], s[74:75]
    v_pk_mul_f32 v[26:27], v[118:119], s[74:75]
    v_pk_mul_f32 v[28:29], v[156:157], s[74:75]
    v_pk_mul_f32 v[30:31], v[158:159], s[74:75]
    v_exp_f32 v24, v24
    v_exp_f32 v25, v25
    v_exp_f32 v26, v26
    v_exp_f32 v27, v27
    v_exp_f32 v28, v28
    v_exp_f32 v29, v29
    v_exp_f32 v30, v30
    v_exp_f32 v31, v31
    v_pk_mul_f32 v[116:117], v[116:117], v[124:125]
    v_pk_mul_f32 v[118:119], v[118:119], v[126:127]
    v_pk_mul_f32 v[156:157], v[156:157], v[164:165]
    v_pk_mul_f32 v[158:159], v[158:159], v[166:167]
    v_pk_add_f32 v[24:25], v[24:25], s[18:19]
    v_pk_add_f32 v[26:27], v[26:27], s[18:19]
    v_pk_add_f32 v[28:29], v[28:29], s[18:19]
    v_pk_add_f32 v[30:31], v[30:31], s[18:19]
    v_rcp_f32 v24, v24
    v_rcp_f32 v25, v25
    v_rcp_f32 v26, v26
    v_rcp_f32 v27, v27
    v_rcp_f32 v28, v28
    v_rcp_f32 v29, v29
    v_rcp_f32 v30, v30
    v_rcp_f32 v31, v31
    s_nop 0
    v_pk_mul_f32 v[116:117], v[116:117], v[24:25]
    v_pk_mul_f32 v[118:119], v[118:119], v[26:27]
    v_pk_mul_f32 v[156:157], v[156:157], v[28:29]
    v_pk_mul_f32 v[158:159], v[158:159], v[30:31]
    v_cvt_pk_bf16_f32 v44, v116, v117
    v_cvt_pk_bf16_f32 v45, v118, v119
    v_cvt_pk_bf16_f32 v46, v156, v157
    v_cvt_pk_bf16_f32 v47, v158, v159
    s_nop 1
    v_permlane32_swap_b32 v44, v46
    v_permlane32_swap_b32 v45, v47
    buffer_store_dwordx4 v[44:47], v9, s[24:27], s66 offen sc1
    s_add_u32 s3, s52, 1
    s_mul_i32 s3, s3, 136
    s_lshl_b32 s17, s16, 3
    s_add_u32 s3, s3, s17
    s_lshl_b32 s17, s70, 2
    s_add_u32 s3, s3, s17
    s_add_u32 s3, s3, 0
    s_lshl_b32 s3, s3, 10
    s_add_u32 s68, s3, 9437184
    s_add_u32 s66, s68, 1024
    v_pk_mul_f32 v[16:17], v[176:177], s[74:75]
    v_pk_mul_f32 v[18:19], v[178:179], s[74:75]
    v_pk_mul_f32 v[20:21], v[216:217], s[74:75]
    v_pk_mul_f32 v[22:23], v[218:219], s[74:75]
    v_exp_f32 v16, v16
    v_exp_f32 v17, v17
    v_exp_f32 v18, v18
    v_exp_f32 v19, v19
    v_exp_f32 v20, v20
    v_exp_f32 v21, v21
    v_exp_f32 v22, v22
    v_exp_f32 v23, v23
    v_pk_mul_f32 v[176:177], v[176:177], v[184:185]
    v_pk_mul_f32 v[178:179], v[178:179], v[186:187]
    v_pk_mul_f32 v[216:217], v[216:217], v[224:225]
    v_pk_mul_f32 v[218:219], v[218:219], v[226:227]
    v_pk_add_f32 v[16:17], v[16:17], s[18:19]
    v_pk_add_f32 v[18:19], v[18:19], s[18:19]
    v_pk_add_f32 v[20:21], v[20:21], s[18:19]
    v_pk_add_f32 v[22:23], v[22:23], s[18:19]
    v_rcp_f32 v16, v16
    v_rcp_f32 v17, v17
    v_rcp_f32 v18, v18
    v_rcp_f32 v19, v19
    v_rcp_f32 v20, v20
    v_rcp_f32 v21, v21
    v_rcp_f32 v22, v22
    v_rcp_f32 v23, v23
    s_nop 0
    v_pk_mul_f32 v[176:177], v[176:177], v[16:17]
    v_pk_mul_f32 v[178:179], v[178:179], v[18:19]
    v_pk_mul_f32 v[216:217], v[216:217], v[20:21]
    v_pk_mul_f32 v[218:219], v[218:219], v[22:23]
    v_cvt_pk_bf16_f32 v32, v176, v177
    v_cvt_pk_bf16_f32 v33, v178, v179
    v_cvt_pk_bf16_f32 v34, v216, v217
    v_cvt_pk_bf16_f32 v35, v218, v219
    s_nop 1
    v_permlane32_swap_b32 v32, v34
    v_permlane32_swap_b32 v33, v35
    buffer_store_dwordx4 v[32:35], v9, s[24:27], s68 offen sc1
    v_pk_mul_f32 v[24:25], v[180:181], s[74:75]
    v_pk_mul_f32 v[26:27], v[182:183], s[74:75]
    v_pk_mul_f32 v[28:29], v[220:221], s[74:75]
    v_pk_mul_f32 v[30:31], v[222:223], s[74:75]
    v_exp_f32 v24, v24
    v_exp_f32 v25, v25
    v_exp_f32 v26, v26
    v_exp_f32 v27, v27
    v_exp_f32 v28, v28
    v_exp_f32 v29, v29
    v_exp_f32 v30, v30
    v_exp_f32 v31, v31
    v_pk_mul_f32 v[180:181], v[180:181], v[188:189]
    v_pk_mul_f32 v[182:183], v[182:183], v[190:191]
    v_pk_mul_f32 v[220:221], v[220:221], v[228:229]
    v_pk_mul_f32 v[222:223], v[222:223], v[230:231]
    v_pk_add_f32 v[24:25], v[24:25], s[18:19]
    v_pk_add_f32 v[26:27], v[26:27], s[18:19]
    v_pk_add_f32 v[28:29], v[28:29], s[18:19]
    v_pk_add_f32 v[30:31], v[30:31], s[18:19]
    v_rcp_f32 v24, v24
    v_rcp_f32 v25, v25
    v_rcp_f32 v26, v26
    v_rcp_f32 v27, v27
    v_rcp_f32 v28, v28
    v_rcp_f32 v29, v29
    v_rcp_f32 v30, v30
    v_rcp_f32 v31, v31
    s_nop 0
    v_pk_mul_f32 v[180:181], v[180:181], v[24:25]
    v_pk_mul_f32 v[182:183], v[182:183], v[26:27]
    v_pk_mul_f32 v[220:221], v[220:221], v[28:29]
    v_pk_mul_f32 v[222:223], v[222:223], v[30:31]
    v_cvt_pk_bf16_f32 v36, v180, v181
    v_cvt_pk_bf16_f32 v37, v182, v183
    v_cvt_pk_bf16_f32 v38, v220, v221
    v_cvt_pk_bf16_f32 v39, v222, v223
    s_nop 1
    v_permlane32_swap_b32 v36, v38
    v_permlane32_swap_b32 v37, v39
    buffer_store_dwordx4 v[36:39], v9, s[24:27], s66 offen sc1
    s_add_u32 s3, s52, 1
    s_mul_i32 s3, s3, 136
    s_lshl_b32 s17, s16, 3
    s_add_u32 s3, s3, s17
    s_lshl_b32 s17, s70, 2
    s_add_u32 s3, s3, s17
    s_add_u32 s3, s3, 2
    s_lshl_b32 s3, s3, 10
    s_add_u32 s68, s3, 9437184
    s_add_u32 s66, s68, 1024
    v_pk_mul_f32 v[16:17], v[192:193], s[74:75]
    v_pk_mul_f32 v[18:19], v[194:195], s[74:75]
    v_pk_mul_f32 v[20:21], v[232:233], s[74:75]
    v_pk_mul_f32 v[22:23], v[234:235], s[74:75]
    v_exp_f32 v16, v16
    v_exp_f32 v17, v17
    v_exp_f32 v18, v18
    v_exp_f32 v19, v19
    v_exp_f32 v20, v20
    v_exp_f32 v21, v21
    v_exp_f32 v22, v22
    v_exp_f32 v23, v23
    v_pk_mul_f32 v[192:193], v[192:193], v[200:201]
    v_pk_mul_f32 v[194:195], v[194:195], v[202:203]
    v_pk_mul_f32 v[232:233], v[232:233], v[240:241]
    v_pk_mul_f32 v[234:235], v[234:235], v[242:243]
    v_pk_add_f32 v[16:17], v[16:17], s[18:19]
    v_pk_add_f32 v[18:19], v[18:19], s[18:19]
    v_pk_add_f32 v[20:21], v[20:21], s[18:19]
    v_pk_add_f32 v[22:23], v[22:23], s[18:19]
    v_rcp_f32 v16, v16
    v_rcp_f32 v17, v17
    v_rcp_f32 v18, v18
    v_rcp_f32 v19, v19
    v_rcp_f32 v20, v20
    v_rcp_f32 v21, v21
    v_rcp_f32 v22, v22
    v_rcp_f32 v23, v23
    s_nop 0
    v_pk_mul_f32 v[192:193], v[192:193], v[16:17]
    v_pk_mul_f32 v[194:195], v[194:195], v[18:19]
    v_pk_mul_f32 v[232:233], v[232:233], v[20:21]
    v_pk_mul_f32 v[234:235], v[234:235], v[22:23]
    v_cvt_pk_bf16_f32 v40, v192, v193
    v_cvt_pk_bf16_f32 v41, v194, v195
    v_cvt_pk_bf16_f32 v42, v232, v233
    v_cvt_pk_bf16_f32 v43, v234, v235
    s_nop 1
    v_permlane32_swap_b32 v40, v42
    v_permlane32_swap_b32 v41, v43
    buffer_store_dwordx4 v[40:43], v9, s[24:27], s68 offen sc1
    v_pk_mul_f32 v[24:25], v[196:197], s[74:75]
    v_pk_mul_f32 v[26:27], v[198:199], s[74:75]
    v_pk_mul_f32 v[28:29], v[236:237], s[74:75]
    v_pk_mul_f32 v[30:31], v[238:239], s[74:75]
    v_exp_f32 v24, v24
    v_exp_f32 v25, v25
    v_exp_f32 v26, v26
    v_exp_f32 v27, v27
    v_exp_f32 v28, v28
    v_exp_f32 v29, v29
    v_exp_f32 v30, v30
    v_exp_f32 v31, v31
    v_pk_mul_f32 v[196:197], v[196:197], v[204:205]
    v_pk_mul_f32 v[198:199], v[198:199], v[206:207]
    v_pk_mul_f32 v[236:237], v[236:237], v[244:245]
    v_pk_mul_f32 v[238:239], v[238:239], v[246:247]
    v_pk_add_f32 v[24:25], v[24:25], s[18:19]
    v_pk_add_f32 v[26:27], v[26:27], s[18:19]
    v_pk_add_f32 v[28:29], v[28:29], s[18:19]
    v_pk_add_f32 v[30:31], v[30:31], s[18:19]
    v_rcp_f32 v24, v24
    v_rcp_f32 v25, v25
    v_rcp_f32 v26, v26
    v_rcp_f32 v27, v27
    v_rcp_f32 v28, v28
    v_rcp_f32 v29, v29
    v_rcp_f32 v30, v30
    v_rcp_f32 v31, v31
    s_nop 0
    v_pk_mul_f32 v[196:197], v[196:197], v[24:25]
    v_pk_mul_f32 v[198:199], v[198:199], v[26:27]
    v_pk_mul_f32 v[236:237], v[236:237], v[28:29]
    v_pk_mul_f32 v[238:239], v[238:239], v[30:31]
    v_cvt_pk_bf16_f32 v44, v196, v197
    v_cvt_pk_bf16_f32 v45, v198, v199
    v_cvt_pk_bf16_f32 v46, v236, v237
    v_cvt_pk_bf16_f32 v47, v238, v239
    s_nop 1
    v_permlane32_swap_b32 v44, v46
    v_permlane32_swap_b32 v45, v47
    buffer_store_dwordx4 v[44:47], v9, s[24:27], s66 offen sc1
    s_cmp_lt_u32 s16, 10
    s_cbranch_scc0 K1_EPI_QK4
    s_lshl_b32 s3, s16, 6
    s_lshl_b32 s17, s70, 5
    s_add_u32 s3, s3, s17
    v_lshrrev_b32 v12, 5, v0
    v_lshl_add_u32 v12, v12, 4, v10
    v_add_u32 v12, s3, v12
    s_mov_b32 s17, 52429
    v_mul_u32_u24 v13, s17, v12
    v_lshrrev_b32 v13, 20, v13
    v_mul_u32_u24 v14, 20, v13
    v_sub_u32 v14, v12, v14
    s_mov_b32 s17, 163840
    v_mul_lo_u32 v13, v13, s17
    v_lshl_add_u32 v13, v14, 4, v13
    v_and_b32 v14, 1, v11
    v_mul_u32_u24 v14, 320, v14
    v_add_u32 v13, v13, v14
    s_add_u32 s3, s52, 0
    s_mul_i32 s3, s3, 2560
    s_add_u32 s68, s3, 3147008
    s_add_u32 s66, s68, 640
    v_cvt_pk_bf16_f32 v56, v128, v129
    v_cvt_pk_bf16_f32 v57, v130, v131
    v_cvt_pk_bf16_f32 v58, v132, v133
    v_cvt_pk_bf16_f32 v59, v134, v135
    s_nop 1
    v_permlane32_swap_b32 v56, v58
    v_permlane32_swap_b32 v57, v59
    buffer_store_dwordx4 v[56:59], v13, s[24:27], s68 offen sc1
    v_cvt_pk_bf16_f32 v60, v168, v169
    v_cvt_pk_bf16_f32 v61, v170, v171
    v_cvt_pk_bf16_f32 v62, v172, v173
    v_cvt_pk_bf16_f32 v63, v174, v175
    s_nop 1
    v_permlane32_swap_b32 v60, v62
    v_permlane32_swap_b32 v61, v63
    buffer_store_dwordx4 v[60:63], v13, s[24:27], s66 offen sc1
    s_add_u32 s3, s52, 1
    s_mul_i32 s3, s3, 2560
    s_add_u32 s68, s3, 3147008
    s_add_u32 s66, s68, 640
    v_cvt_pk_bf16_f32 v64, v208, v209
    v_cvt_pk_bf16_f32 v65, v210, v211
    v_cvt_pk_bf16_f32 v66, v212, v213
    v_cvt_pk_bf16_f32 v67, v214, v215
    s_nop 1
    v_permlane32_swap_b32 v64, v66
    v_permlane32_swap_b32 v65, v67
    buffer_store_dwordx4 v[64:67], v13, s[24:27], s68 offen sc1
    v_cvt_pk_bf16_f32 v68, v248, v249
    v_cvt_pk_bf16_f32 v69, v250, v251
    v_cvt_pk_bf16_f32 v70, v252, v253
    v_cvt_pk_bf16_f32 v71, v254, v255
    s_nop 1
    v_permlane32_swap_b32 v68, v70
    v_permlane32_swap_b32 v69, v71
    buffer_store_dwordx4 v[68:71], v13, s[24:27], s66 offen sc1
    s_branch K1_CEND
K1_EPI_QK4:
    s_mov_b32 s64, 0x3ea52b5c
    s_mov_b32 s53, 52429
    s_mov_b32 s67, s50
    s_mov_b32 s17, s70
    s_movk_i32 s69, 1280
    s_mov_b32 s71, 80640
    s_mov_b32 s68, 0
    s_cmp_ge_u32 s67, 10
    s_cselect_b32 s3, 10, 0
    s_cselect_b32 s69, 2560, s69
    s_cselect_b32 s71, 162560, s71
    s_cselect_b32 s68, 3145728, s68
    s_cselect_b32 s72, 1.0, s64
    s_mov_b32 s73, s72
    s_sub_u32 s3, s67, s3
    s_lshl_b32 s3, s3, 1
    s_add_u32 s3, s3, s17
    s_lshl_b32 s3, s3, 3
    s_mul_i32 s66, s52, s69
    s_add_u32 s68, s68, s66
    s_add_u32 s66, s68, s69
    v_add_u32 v12, s3, v11
    v_add_u32 v13, 0, v12
    v_mul_u32_u24 v14, s53, v13
    v_lshrrev_b32 v14, 18, v14
    v_mul_lo_u32 v14, v14, s71
    v_lshl_add_u32 v14, v13, 8, v14
    v_lshl_add_u32 v72, v10, 4, v14
    v_add_u32 v13, 4, v12
    v_mul_u32_u24 v14, s53, v13
    v_lshrrev_b32 v14, 18, v14
    v_mul_lo_u32 v14, v14, s71
    v_lshl_add_u32 v14, v13, 8, v14
    v_lshl_add_u32 v73, v10, 4, v14
    v_pk_mul_f32 v[128:129], v[128:129], s[72:73]
    v_pk_mul_f32 v[130:131], v[130:131], s[72:73]
    v_pk_mul_f32 v[168:169], v[168:169], s[72:73]
    v_pk_mul_f32 v[170:171], v[170:171], s[72:73]
    v_cvt_pk_bf16_f32 v56, v128, v129
    v_cvt_pk_bf16_f32 v57, v130, v131
    v_cvt_pk_bf16_f32 v58, v168, v169
    v_cvt_pk_bf16_f32 v59, v170, v171
    buffer_store_dwordx4 v[56:59], v72, s[24:27], s68 offen sc1
    v_pk_mul_f32 v[132:133], v[132:133], s[72:73]
    v_pk_mul_f32 v[134:135], v[134:135], s[72:73]
    v_pk_mul_f32 v[172:173], v[172:173], s[72:73]
    v_pk_mul_f32 v[174:175], v[174:175], s[72:73]
    v_cvt_pk_bf16_f32 v60, v132, v133
    v_cvt_pk_bf16_f32 v61, v134, v135
    v_cvt_pk_bf16_f32 v62, v172, v173
    v_cvt_pk_bf16_f32 v63, v174, v175
    buffer_store_dwordx4 v[60:63], v73, s[24:27], s68 offen sc1
    v_pk_mul_f32 v[208:209], v[208:209], s[72:73]
    v_pk_mul_f32 v[210:211], v[210:211], s[72:73]
    v_pk_mul_f32 v[248:249], v[248:249], s[72:73]
    v_pk_mul_f32 v[250:251], v[250:251], s[72:73]
    v_cvt_pk_bf16_f32 v64, v208, v209
    v_cvt_pk_bf16_f32 v65, v210, v211
    v_cvt_pk_bf16_f32 v66, v248, v249
    v_cvt_pk_bf16_f32 v67, v250, v251
    buffer_store_dwordx4 v[64:67], v72, s[24:27], s66 offen sc1
    v_pk_mul_f32 v[212:213], v[212:213], s[72:73]
    v_pk_mul_f32 v[214:215], v[214:215], s[72:73]
    v_pk_mul_f32 v[252:253], v[252:253], s[72:73]
    v_pk_mul_f32 v[254:255], v[254:255], s[72:73]
    v_cvt_pk_bf16_f32 v68, v212, v213
    v_cvt_pk_bf16_f32 v69, v214, v215
    v_cvt_pk_bf16_f32 v70, v252, v253
    v_cvt_pk_bf16_f32 v71, v254, v255
    buffer_store_dwordx4 v[68:71], v73, s[24:27], s66 offen sc1
    s_branch K1_CEND
K1_EPI_QONLY:
    s_mov_b32 s64, 0x3ea52b5c
    s_mov_b32 s53, 52429
    s_lshl_b32 s67, s70, 1
    s_add_u32 s67, s67, s49
    s_add_u32 s67, s67, 0
    s_mov_b32 s17, 0
    s_movk_i32 s69, 1280
    s_mov_b32 s71, 80640
    s_mov_b32 s68, 0
    s_cmp_ge_u32 s67, 10
    s_cselect_b32 s3, 10, 0
    s_cselect_b32 s69, 2560, s69
    s_cselect_b32 s71, 162560, s71
    s_cselect_b32 s68, 3145728, s68
    s_cselect_b32 s72, 1.0, s64
    s_mov_b32 s73, s72
    s_sub_u32 s3, s67, s3
    s_lshl_b32 s3, s3, 1
    s_add_u32 s3, s3, s17
    s_lshl_b32 s3, s3, 3
    s_mul_i32 s66, s52, s69
    s_add_u32 s68, s68, s66
    s_add_u32 s66, s68, s69
    v_add_u32 v12, s3, v11
    v_add_u32 v13, 0, v12
    v_mul_u32_u24 v14, s53, v13
    v_lshrrev_b32 v14, 18, v14
    v_mul_lo_u32 v14, v14, s71
    v_lshl_add_u32 v14, v13, 8, v14
    v_lshl_add_u32 v32, v10, 4, v14
    v_add_u32 v13, 4, v12
    v_mul_u32_u24 v14, s53, v13
    v_lshrrev_b32 v14, 18, v14
    v_mul_lo_u32 v14, v14, s71
    v_lshl_add_u32 v14, v13, 8, v14
    v_lshl_add_u32 v33, v10, 4, v14
    v_pk_mul_f32 v[96:97], v[96:97], s[72:73]
    v_pk_mul_f32 v[98:99], v[98:99], s[72:73]
    v_pk_mul_f32 v[136:137], v[136:137], s[72:73]
    v_pk_mul_f32 v[138:139], v[138:139], s[72:73]
    v_cvt_pk_bf16_f32 v16, v96, v97
    v_cvt_pk_bf16_f32 v17, v98, v99
    v_cvt_pk_bf16_f32 v18, v136, v137
    v_cvt_pk_bf16_f32 v19, v138, v139
    buffer_store_dwordx4 v[16:19], v32, s[24:27], s68 offen sc1
    v_pk_mul_f32 v[100:101], v[100:101], s[72:73]
    v_pk_mul_f32 v[102:103], v[102:103], s[72:73]
    v_pk_mul_f32 v[140:141], v[140:141], s[72:73]
    v_pk_mul_f32 v[142:143], v[142:143], s[72:73]
    v_cvt_pk_bf16_f32 v20, v100, v101
    v_cvt_pk_bf16_f32 v21, v102, v103
    v_cvt_pk_bf16_f32 v22, v140, v141
    v_cvt_pk_bf16_f32 v23, v142, v143
    buffer_store_dwordx4 v[20:23], v33, s[24:27], s68 offen sc1
    v_pk_mul_f32 v[176:177], v[176:177], s[72:73]
    v_pk_mul_f32 v[178:179], v[178:179], s[72:73]
    v_pk_mul_f32 v[216:217], v[216:217], s[72:73]
    v_pk_mul_f32 v[218:219], v[218:219], s[72:73]
    v_cvt_pk_bf16_f32 v24, v176, v177
    v_cvt_pk_bf16_f32 v25, v178, v179
    v_cvt_pk_bf16_f32 v26, v216, v217
    v_cvt_pk_bf16_f32 v27, v218, v219
    buffer_store_dwordx4 v[24:27], v32, s[24:27], s66 offen sc1
    v_pk_mul_f32 v[180:181], v[180:181], s[72:73]
    v_pk_mul_f32 v[182:183], v[182:183], s[72:73]
    v_pk_mul_f32 v[220:221], v[220:221], s[72:73]
    v_pk_mul_f32 v[222:223], v[222:223], s[72:73]
    v_cvt_pk_bf16_f32 v28, v180, v181
    v_cvt_pk_bf16_f32 v29, v182, v183
    v_cvt_pk_bf16_f32 v30, v220, v221
    v_cvt_pk_bf16_f32 v31, v222, v223
    buffer_store_dwordx4 v[28:31], v33, s[24:27], s66 offen sc1
    s_lshl_b32 s67, s70, 1
    s_add_u32 s67, s67, s49
    s_add_u32 s67, s67, 1
    s_mov_b32 s17, 0
    s_movk_i32 s69, 1280
    s_mov_b32 s71, 80640
    s_mov_b32 s68, 0
    s_cmp_ge_u32 s67, 10
    s_cselect_b32 s3, 10, 0
    s_cselect_b32 s69, 2560, s69
    s_cselect_b32 s71, 162560, s71
    s_cselect_b32 s68, 3145728, s68
    s_cselect_b32 s72, 1.0, s64
    s_mov_b32 s73, s72
    s_sub_u32 s3, s67, s3
    s_lshl_b32 s3, s3, 1
    s_add_u32 s3, s3, s17
    s_lshl_b32 s3, s3, 3
    s_mul_i32 s66, s52, s69
    s_add_u32 s68, s68, s66
    s_add_u32 s66, s68, s69
    v_add_u32 v12, s3, v11
    v_add_u32 v13, 0, v12
    v_mul_u32_u24 v14, s53, v13
    v_lshrrev_b32 v14, 18, v14
    v_mul_lo_u32 v14, v14, s71
    v_lshl_add_u32 v14, v13, 8, v14
    v_lshl_add_u32 v52, v10, 4, v14
    v_add_u32 v13, 4, v12
    v_mul_u32_u24 v14, s53, v13
    v_lshrrev_b32 v14, 18, v14
    v_mul_lo_u32 v14, v14, s71
    v_lshl_add_u32 v14, v13, 8, v14
    v_lshl_add_u32 v53, v10, 4, v14
    v_pk_mul_f32 v[104:105], v[104:105], s[72:73]
    v_pk_mul_f32 v[106:107], v[106:107], s[72:73]
    v_pk_mul_f32 v[144:145], v[144:145], s[72:73]
    v_pk_mul_f32 v[146:147], v[146:147], s[72:73]
    v_cvt_pk_bf16_f32 v36, v104, v105
    v_cvt_pk_bf16_f32 v37, v106, v107
    v_cvt_pk_bf16_f32 v38, v144, v145
    v_cvt_pk_bf16_f32 v39, v146, v147
    buffer_store_dwordx4 v[36:39], v52, s[24:27], s68 offen sc1
    v_pk_mul_f32 v[108:109], v[108:109], s[72:73]
    v_pk_mul_f32 v[110:111], v[110:111], s[72:73]
    v_pk_mul_f32 v[148:149], v[148:149], s[72:73]
    v_pk_mul_f32 v[150:151], v[150:151], s[72:73]
    v_cvt_pk_bf16_f32 v40, v108, v109
    v_cvt_pk_bf16_f32 v41, v110, v111
    v_cvt_pk_bf16_f32 v42, v148, v149
    v_cvt_pk_bf16_f32 v43, v150, v151
    buffer_store_dwordx4 v[40:43], v53, s[24:27], s68 offen sc1
    v_pk_mul_f32 v[184:185], v[184:185], s[72:73]
    v_pk_mul_f32 v[186:187], v[186:187], s[72:73]
    v_pk_mul_f32 v[224:225], v[224:225], s[72:73]
    v_pk_mul_f32 v[226:227], v[226:227], s[72:73]
    v_cvt_pk_bf16_f32 v44, v184, v185
    v_cvt_pk_bf16_f32 v45, v186, v187
    v_cvt_pk_bf16_f32 v46, v224, v225
    v_cvt_pk_bf16_f32 v47, v226, v227
    buffer_store_dwordx4 v[44:47], v52, s[24:27], s66 offen sc1
    v_pk_mul_f32 v[188:189], v[188:189], s[72:73]
    v_pk_mul_f32 v[190:191], v[190:191], s[72:73]
    v_pk_mul_f32 v[228:229], v[228:229], s[72:73]
    v_pk_mul_f32 v[230:231], v[230:231], s[72:73]
    v_cvt_pk_bf16_f32 v48, v188, v189
    v_cvt_pk_bf16_f32 v49, v190, v191
    v_cvt_pk_bf16_f32 v50, v228, v229
    v_cvt_pk_bf16_f32 v51, v230, v231
    buffer_store_dwordx4 v[48:51], v53, s[24:27], s66 offen sc1
    s_lshl_b32 s67, s70, 1
    s_add_u32 s67, s67, s49
    s_add_u32 s67, s67, 0
    s_mov_b32 s17, 1
    s_movk_i32 s69, 1280
    s_mov_b32 s71, 80640
    s_mov_b32 s68, 0
    s_cmp_ge_u32 s67, 10
    s_cselect_b32 s3, 10, 0
    s_cselect_b32 s69, 2560, s69
    s_cselect_b32 s71, 162560, s71
    s_cselect_b32 s68, 3145728, s68
    s_cselect_b32 s72, 1.0, s64
    s_mov_b32 s73, s72
    s_sub_u32 s3, s67, s3
    s_lshl_b32 s3, s3, 1
    s_add_u32 s3, s3, s17
    s_lshl_b32 s3, s3, 3
    s_mul_i32 s66, s52, s69
    s_add_u32 s68, s68, s66
    s_add_u32 s66, s68, s69
    v_add_u32 v12, s3, v11
    v_add_u32 v13, 0, v12
    v_mul_u32_u24 v14, s53, v13
    v_lshrrev_b32 v14, 18, v14
    v_mul_lo_u32 v14, v14, s71
    v_lshl_add_u32 v14, v13, 8, v14
    v_lshl_add_u32 v32, v10, 4, v14
    v_add_u32 v13, 4, v12
    v_mul_u32_u24 v14, s53, v13
    v_lshrrev_b32 v14, 18, v14
    v_mul_lo_u32 v14, v14, s71
    v_lshl_add_u32 v14, v13, 8, v14
    v_lshl_add_u32 v33, v10, 4, v14
    v_pk_mul_f32 v[112:113], v[112:113], s[72:73]
    v_pk_mul_f32 v[114:115], v[114:115], s[72:73]
    v_pk_mul_f32 v[152:153], v[152:153], s[72:73]
    v_pk_mul_f32 v[154:155], v[154:155], s[72:73]
    v_cvt_pk_bf16_f32 v16, v112, v113
    v_cvt_pk_bf16_f32 v17, v114, v115
    v_cvt_pk_bf16_f32 v18, v152, v153
    v_cvt_pk_bf16_f32 v19, v154, v155
    buffer_store_dwordx4 v[16:19], v32, s[24:27], s68 offen sc1
    v_pk_mul_f32 v[116:117], v[116:117], s[72:73]
    v_pk_mul_f32 v[118:119], v[118:119], s[72:73]
    v_pk_mul_f32 v[156:157], v[156:157], s[72:73]
    v_pk_mul_f32 v[158:159], v[158:159], s[72:73]
    v_cvt_pk_bf16_f32 v20, v116, v117
    v_cvt_pk_bf16_f32 v21, v118, v119
    v_cvt_pk_bf16_f32 v22, v156, v157
    v_cvt_pk_bf16_f32 v23, v158, v159
    buffer_store_dwordx4 v[20:23], v33, s[24:27], s68 offen sc1
    v_pk_mul_f32 v[192:193], v[192:193], s[72:73]
    v_pk_mul_f32 v[194:195], v[194:195], s[72:73]
    v_pk_mul_f32 v[232:233], v[232:233], s[72:73]
    v_pk_mul_f32 v[234:235], v[234:235], s[72:73]
    v_cvt_pk_bf16_f32 v24, v192, v193
    v_cvt_pk_bf16_f32 v25, v194, v195
    v_cvt_pk_bf16_f32 v26, v232, v233
    v_cvt_pk_bf16_f32 v27, v234, v235
    buffer_store_dwordx4 v[24:27], v32, s[24:27], s66 offen sc1
    v_pk_mul_f32 v[196:197], v[196:197], s[72:73]
    v_pk_mul_f32 v[198:199], v[198:199], s[72:73]
    v_pk_mul_f32 v[236:237], v[236:237], s[72:73]
    v_pk_mul_f32 v[238:239], v[238:239], s[72:73]
    v_cvt_pk_bf16_f32 v28, v196, v197
    v_cvt_pk_bf16_f32 v29, v198, v199
    v_cvt_pk_bf16_f32 v30, v236, v237
    v_cvt_pk_bf16_f32 v31, v238, v239
    buffer_store_dwordx4 v[28:31], v33, s[24:27], s66 offen sc1
    s_lshl_b32 s67, s70, 1
    s_add_u32 s67, s67, s49
    s_add_u32 s67, s67, 1
    s_mov_b32 s17, 1
    s_movk_i32 s69, 1280
    s_mov_b32 s71, 80640
    s_mov_b32 s68, 0
    s_cmp_ge_u32 s67, 10
    s_cselect_b32 s3, 10, 0
    s_cselect_b32 s69, 2560, s69
    s_cselect_b32 s71, 162560, s71
    s_cselect_b32 s68, 3145728, s68
    s_cselect_b32 s72, 1.0, s64
    s_mov_b32 s73, s72
    s_sub_u32 s3, s67, s3
    s_lshl_b32 s3, s3, 1
    s_add_u32 s3, s3, s17
    s_lshl_b32 s3, s3, 3
    s_mul_i32 s66, s52, s69
    s_add_u32 s68, s68, s66
    s_add_u32 s66, s68, s69
    v_add_u32 v12, s3, v11
    v_add_u32 v13, 0, v12
    v_mul_u32_u24 v14, s53, v13
    v_lshrrev_b32 v14, 18, v14
    v_mul_lo_u32 v14, v14, s71
    v_lshl_add_u32 v14, v13, 8, v14
    v_lshl_add_u32 v52, v10, 4, v14
    v_add_u32 v13, 4, v12
    v_mul_u32_u24 v14, s53, v13
    v_lshrrev_b32 v14, 18, v14
    v_mul_lo_u32 v14, v14, s71
    v_lshl_add_u32 v14, v13, 8, v14
    v_lshl_add_u32 v53, v10, 4, v14
    v_pk_mul_f32 v[120:121], v[120:121], s[72:73]
    v_pk_mul_f32 v[122:123], v[122:123], s[72:73]
    v_pk_mul_f32 v[160:161], v[160:161], s[72:73]
    v_pk_mul_f32 v[162:163], v[162:163], s[72:73]
    v_cvt_pk_bf16_f32 v36, v120, v121
    v_cvt_pk_bf16_f32 v37, v122, v123
    v_cvt_pk_bf16_f32 v38, v160, v161
    v_cvt_pk_bf16_f32 v39, v162, v163
    buffer_store_dwordx4 v[36:39], v52, s[24:27], s68 offen sc1
    v_pk_mul_f32 v[124:125], v[124:125], s[72:73]
    v_pk_mul_f32 v[126:127], v[126:127], s[72:73]
    v_pk_mul_f32 v[164:165], v[164:165], s[72:73]
    v_pk_mul_f32 v[166:167], v[166:167], s[72:73]
    v_cvt_pk_bf16_f32 v40, v124, v125
    v_cvt_pk_bf16_f32 v41, v126, v127
    v_cvt_pk_bf16_f32 v42, v164, v165
    v_cvt_pk_bf16_f32 v43, v166, v167
    buffer_store_dwordx4 v[40:43], v53, s[24:27], s68 offen sc1
    v_pk_mul_f32 v[200:201], v[200:201], s[72:73]
    v_pk_mul_f32 v[202:203], v[202:203], s[72:73]
    v_pk_mul_f32 v[240:241], v[240:241], s[72:73]
    v_pk_mul_f32 v[242:243], v[242:243], s[72:73]
    v_cvt_pk_bf16_f32 v44, v200, v201
    v_cvt_pk_bf16_f32 v45, v202, v203
    v_cvt_pk_bf16_f32 v46, v240, v241
    v_cvt_pk_bf16_f32 v47, v242, v243
    buffer_store_dwordx4 v[44:47], v52, s[24:27], s66 offen sc1
    v_pk_mul_f32 v[204:205], v[204:205], s[72:73]
    v_pk_mul_f32 v[206:207], v[206:207], s[72:73]
    v_pk_mul_f32 v[244:245], v[244:245], s[72:73]
    v_pk_mul_f32 v[246:247], v[246:247], s[72:73]
    v_cvt_pk_bf16_f32 v48, v204, v205
    v_cvt_pk_bf16_f32 v49, v206, v207
    v_cvt_pk_bf16_f32 v50, v244, v245
    v_cvt_pk_bf16_f32 v51, v246, v247
    buffer_store_dwordx4 v[48:51], v53, s[24:27], s66 offen sc1
    s_mov_b32 s67, s50
    s_mov_b32 s17, s70
    s_movk_i32 s69, 1280
    s_mov_b32 s71, 80640
    s_mov_b32 s68, 0
    s_cmp_ge_u32 s67, 10
    s_cselect_b32 s3, 10, 0
    s_cselect_b32 s69, 2560, s69
    s_cselect_b32 s71, 162560, s71
    s_cselect_b32 s68, 3145728, s68
    s_cselect_b32 s72, 1.0, s64
    s_mov_b32 s73, s72
    s_sub_u32 s3, s67, s3
    s_lshl_b32 s3, s3, 1
    s_add_u32 s3, s3, s17
    s_lshl_b32 s3, s3, 3
    s_mul_i32 s66, s52, s69
    s_add_u32 s68, s68, s66
    s_add_u32 s66, s68, s69
    v_add_u32 v12, s3, v11
    v_add_u32 v13, 0, v12
    v_mul_u32_u24 v14, s53, v13
    v_lshrrev_b32 v14, 18, v14
    v_mul_lo_u32 v14, v14, s71
    v_lshl_add_u32 v14, v13, 8, v14
    v_lshl_add_u32 v32, v10, 4, v14
    v_add_u32 v13, 4, v12
    v_mul_u32_u24 v14, s53, v13
    v_lshrrev_b32 v14, 18, v14
    v_mul_lo_u32 v14, v14, s71
    v_lshl_add_u32 v14, v13, 8, v14
    v_lshl_add_u32 v33, v10, 4, v14
    v_pk_mul_f32 v[128:129], v[128:129], s[72:73]
    v_pk_mul_f32 v[130:131], v[130:131], s[72:73]
    v_pk_mul_f32 v[168:169], v[168:169], s[72:73]
    v_pk_mul_f32 v[170:171], v[170:171], s[72:73]
    v_cvt_pk_bf16_f32 v16, v128, v129
    v_cvt_pk_bf16_f32 v17, v130, v131
    v_cvt_pk_bf16_f32 v18, v168, v169
    v_cvt_pk_bf16_f32 v19, v170, v171
    buffer_store_dwordx4 v[16:19], v32, s[24:27], s68 offen sc1
    v_pk_mul_f32 v[132:133], v[132:133], s[72:73]
    v_pk_mul_f32 v[134:135], v[134:135], s[72:73]
    v_pk_mul_f32 v[172:173], v[172:173], s[72:73]
    v_pk_mul_f32 v[174:175], v[174:175], s[72:73]
    v_cvt_pk_bf16_f32 v20, v132, v133
    v_cvt_pk_bf16_f32 v21, v134, v135
    v_cvt_pk_bf16_f32 v22, v172, v173
    v_cvt_pk_bf16_f32 v23, v174, v175
    buffer_store_dwordx4 v[20:23], v33, s[24:27], s68 offen sc1
    v_pk_mul_f32 v[208:209], v[208:209], s[72:73]
    v_pk_mul_f32 v[210:211], v[210:211], s[72:73]
    v_pk_mul_f32 v[248:249], v[248:249], s[72:73]
    v_pk_mul_f32 v[250:251], v[250:251], s[72:73]
    v_cvt_pk_bf16_f32 v24, v208, v209
    v_cvt_pk_bf16_f32 v25, v210, v211
    v_cvt_pk_bf16_f32 v26, v248, v249
    v_cvt_pk_bf16_f32 v27, v250, v251
    buffer_store_dwordx4 v[24:27], v32, s[24:27], s66 offen sc1
    v_pk_mul_f32 v[212:213], v[212:213], s[72:73]
    v_pk_mul_f32 v[214:215], v[214:215], s[72:73]
    v_pk_mul_f32 v[252:253], v[252:253], s[72:73]
    v_pk_mul_f32 v[254:255], v[254:255], s[72:73]
    v_cvt_pk_bf16_f32 v28, v212, v213
    v_cvt_pk_bf16_f32 v29, v214, v215
    v_cvt_pk_bf16_f32 v30, v252, v253
    v_cvt_pk_bf16_f32 v31, v254, v255
    buffer_store_dwordx4 v[28:31], v33, s[24:27], s66 offen sc1
K1_CEND:
    s_branch K1_END
K1_LOADER:
    s_sub_u32 s14, s14, 4
    v_lshrrev_b32 v9, 3, v0
    v_and_b32 v10, 7, v0
    v_mul_u32_u24 v11, 1280, v9
    v_lshl_add_u32 v2, v10, 4, v11
    s_lshl_b32 s3, s15, 7
    s_lshl_b32 s17, s14, 5
    s_add_u32 s3, s3, s17
    s_mul_i32 s60, s3, 1280
    s_add_u32 s61, s60, 10240
    s_add_u32 s62, s60, 20480
    s_add_u32 s63, s60, 30720
    s_waitcnt lgkmcnt(0)
    s_mov_b32 s20, s4
    s_and_b32 s21, s5, 0xffff
    s_mov_b32 s22, 2621440
    s_mov_b32 s23, 0x20000
    buffer_load_dwordx4 v[96:99], v2, s[20:23], s60 offen offset:0
    buffer_load_dwordx4 v[100:103], v2, s[20:23], s60 offen offset:128
    buffer_load_dwordx4 v[104:107], v2, s[20:23], s60 offen offset:256
    buffer_load_dwordx4 v[108:111], v2, s[20:23], s60 offen offset:384
    buffer_load_dwordx4 v[112:115], v2, s[20:23], s60 offen offset:512
    buffer_load_dwordx4 v[116:119], v2, s[20:23], s60 offen offset:640
    buffer_load_dwordx4 v[120:123], v2, s[20:23], s60 offen offset:768
    buffer_load_dwordx4 v[124:127], v2, s[20:23], s60 offen offset:896
    buffer_load_dwordx4 v[128:131], v2, s[20:23], s60 offen offset:1024
    buffer_load_dwordx4 v[132:135], v2, s[20:23], s60 offen offset:1152
    s_cmp_lt_u32 s16, 12
    s_cbranch_scc0 K1_SQ_L
    s_mov_b32 s51, 1
    s_movk_i32 s48, 3072
    s_lshl_b32 s17, s16, 8
    s_add_u32 s18, s17, 128
    s_add_u32 s28, s8, s17
    s_addc_u32 s29, s9, 0
    s_and_b32 s29, s29, 0xffff
    s_sub_u32 s30, 1966080, s17
    s_mov_b32 s31, 0x20000
    s_add_u32 s32, s10, s17
    s_addc_u32 s33, s11, 0
    s_and_b32 s33, s33, 0xffff
    s_sub_u32 s34, 1966080, s17
    s_mov_b32 s35, 0x20000
    s_add_u32 s36, s8, s18
    s_addc_u32 s37, s9, 0
    s_and_b32 s37, s37, 0xffff
    s_sub_u32 s38, 1966080, s18
    s_mov_b32 s39, 0x20000
    s_add_u32 s40, s10, s18
    s_addc_u32 s41, s11, 0
    s_and_b32 s41, s41, 0xffff
    s_sub_u32 s42, 1966080, s18
    s_mov_b32 s43, 0x20000
    s_add_u32 s50, s16, 20
    s_add_u32 s17, s16, 8
    s_cmp_lt_u32 s16, 10
    s_cselect_b32 s50, s50, s17
    s_mov_b32 s49, 0
    s_branch K1_SR4_L
K1_SQ_L:
    s_mov_b32 s51, 0
    s_movk_i32 s48, 3840
    s_sub_u32 s17, s16, 12
    s_mul_i32 s49, s17, 5
    s_sub_u32 s17, s49, 2
    s_cmp_eq_u32 s16, 15
    s_cselect_b32 s49, s17, s49
    s_add_u32 s17, s49, 0
    s_lshl_b32 s17, s17, 7
    s_add_u32 s28, s6, s17
    s_addc_u32 s29, s7, 0
    s_and_b32 s29, s29, 0xffff
    s_sub_u32 s30, 2457600, s17
    s_mov_b32 s31, 0x20000
    s_add_u32 s17, s49, 1
    s_lshl_b32 s17, s17, 7
    s_add_u32 s32, s6, s17
    s_addc_u32 s33, s7, 0
    s_and_b32 s33, s33, 0xffff
    s_sub_u32 s34, 2457600, s17
    s_mov_b32 s35, 0x20000
    s_add_u32 s17, s49, 2
    s_lshl_b32 s17, s17, 7
    s_add_u32 s36, s6, s17
    s_addc_u32 s37, s7, 0
    s_and_b32 s37, s37, 0xffff
    s_sub_u32 s38, 2457600, s17
    s_mov_b32 s39, 0x20000
    s_add_u32 s17, s49, 3
    s_lshl_b32 s17, s17, 7
    s_add_u32 s40, s6, s17
    s_addc_u32 s41, s7, 0
    s_and_b32 s41, s41, 0xffff
    s_sub_u32 s42, 2457600, s17
    s_mov_b32 s43, 0x20000
    s_add_u32 s50, s49, 4
K1_SR4_L:
    s_lshl_b32 s17, s50, 7
    s_add_u32 s44, s6, s17
    s_addc_u32 s45, s7, 0
    s_and_b32 s45, s45, 0xffff
    s_sub_u32 s46, 2457600, s17
    s_mov_b32 s47, 0x20000
    v_lshrrev_b32 v20, 3, v0
    v_and_b32 v21, 7, v0
    v_bfe_u32 v22, v20, 1, 1
    v_lshlrev_b32 v22, 1, v22
    v_xor_b32 v22, v22, v21
    v_lshlrev_b32 v22, 4, v22
    v_mul_lo_u32 v23, v20, s48
    v_add_u32 v3, v23, v22
    v_mul_u32_u24 v23, 3840, v20
    v_add_u32 v4, v23, v22
    v_xor_b32 v7, 64, v3
    v_xor_b32 v18, 64, v4
    s_lshl_b32 s17, s14, 4
    s_add_u32 s17, s17, 128
    s_mul_i32 s53, s17, s48
    s_lshl_b32 s3, s48, 3
    s_add_u32 s54, s53, s3
    s_mul_i32 s55, s17, 3840
    s_add_u32 s56, s55, 30720
    s_lshl_b32 s57, s14, 11
    s_lshl_b32 s65, s48, 6
    s_lshl_b32 s3, s14, 5
    v_add_u32 v11, s3, v9
    v_lshlrev_b32 v11, 7, v11
    v_lshrrev_b32 v12, 1, v9
    v_xor_b32 v13, v10, v12
    v_lshl_add_u32 v5, v13, 4, v11
    v_add_u32 v12, 4, v12
    v_xor_b32 v13, v10, v12
    v_lshl_add_u32 v6, v13, 4, v11
    v_add_u32 v6, 1024, v6
    s_mov_b32 s64, 0x3f803f80
    s_mov_b32 s66, 0x3acccccd
    s_mov_b32 s67, 0x3727c5ac
    v_mov_b32 v8, 0
    v_mov_b32 v12, 0
    v_mov_b32 v16, 0
    v_mov_b32 v17, 0
    s_waitcnt vmcnt(8)
    v_dot2_f32_bf16 v8, v96, s64, v8
    v_dot2_f32_bf16 v12, v96, v96, v12
    v_dot2_f32_bf16 v16, v97, s64, v16
    v_dot2_f32_bf16 v17, v97, v97, v17
    v_dot2_f32_bf16 v8, v98, s64, v8
    v_dot2_f32_bf16 v12, v98, v98, v12
    v_dot2_f32_bf16 v16, v99, s64, v16
    v_dot2_f32_bf16 v17, v99, v99, v17
    buffer_load_dwordx4 v[136:139], v2, s[20:23], s61 offen offset:0
    v_dot2_f32_bf16 v8, v100, s64, v8
    v_dot2_f32_bf16 v12, v100, v100, v12
    v_dot2_f32_bf16 v16, v101, s64, v16
    v_dot2_f32_bf16 v17, v101, v101, v17
    v_dot2_f32_bf16 v8, v102, s64, v8
    v_dot2_f32_bf16 v12, v102, v102, v12
    v_dot2_f32_bf16 v16, v103, s64, v16
    v_dot2_f32_bf16 v17, v103, v103, v17
    buffer_load_dwordx4 v[140:143], v2, s[20:23], s61 offen offset:128
    s_waitcnt vmcnt(8)
    v_dot2_f32_bf16 v8, v104, s64, v8
    v_dot2_f32_bf16 v12, v104, v104, v12
    v_dot2_f32_bf16 v16, v105, s64, v16
    v_dot2_f32_bf16 v17, v105, v105, v17
    v_dot2_f32_bf16 v8, v106, s64, v8
    v_dot2_f32_bf16 v12, v106, v106, v12
    v_dot2_f32_bf16 v16, v107, s64, v16
    v_dot2_f32_bf16 v17, v107, v107, v17
    buffer_load_dwordx4 v[144:147], v2, s[20:23], s61 offen offset:256
    v_dot2_f32_bf16 v8, v108, s64, v8
    v_dot2_f32_bf16 v12, v108, v108, v12
    v_dot2_f32_bf16 v16, v109, s64, v16
    v_dot2_f32_bf16 v17, v109, v109, v17
    v_dot2_f32_bf16 v8, v110, s64, v8
    v_dot2_f32_bf16 v12, v110, v110, v12
    v_dot2_f32_bf16 v16, v111, s64, v16
    v_dot2_f32_bf16 v17, v111, v111, v17
    buffer_load_dwordx4 v[148:151], v2, s[20:23], s61 offen offset:384
    s_waitcnt vmcnt(8)
    v_dot2_f32_bf16 v8, v112, s64, v8
    v_dot2_f32_bf16 v12, v112, v112, v12
    v_dot2_f32_bf16 v16, v113, s64, v16
    v_dot2_f32_bf16 v17, v113, v113, v17
    v_dot2_f32_bf16 v8, v114, s64, v8
    v_dot2_f32_bf16 v12, v114, v114, v12
    v_dot2_f32_bf16 v16, v115, s64, v16
    v_dot2_f32_bf16 v17, v115, v115, v17
    buffer_load_dwordx4 v[152:155], v2, s[20:23], s61 offen offset:512
    v_dot2_f32_bf16 v8, v116, s64, v8
    v_dot2_f32_bf16 v12, v116, v116, v12
    v_dot2_f32_bf16 v16, v117, s64, v16
    v_dot2_f32_bf16 v17, v117, v117, v17
    v_dot2_f32_bf16 v8, v118, s64, v8
    v_dot2_f32_bf16 v12, v118, v118, v12
    v_dot2_f32_bf16 v16, v119, s64, v16
    v_dot2_f32_bf16 v17, v119, v119, v17
    buffer_load_dwordx4 v[156:159], v2, s[20:23], s61 offen offset:640
    s_waitcnt vmcnt(8)
    v_dot2_f32_bf16 v8, v120, s64, v8
    v_dot2_f32_bf16 v12, v120, v120, v12
    v_dot2_f32_bf16 v16, v121, s64, v16
    v_dot2_f32_bf16 v17, v121, v121, v17
    v_dot2_f32_bf16 v8, v122, s64, v8
    v_dot2_f32_bf16 v12, v122, v122, v12
    v_dot2_f32_bf16 v16, v123, s64, v16
    v_dot2_f32_bf16 v17, v123, v123, v17
    buffer_load_dwordx4 v[160:163], v2, s[20:23], s61 offen offset:768
    v_dot2_f32_bf16 v8, v124, s64, v8
    v_dot2_f32_bf16 v12, v124, v124, v12
    v_dot2_f32_bf16 v16, v125, s64, v16
    v_dot2_f32_bf16 v17, v125, v125, v17
    v_dot2_f32_bf16 v8, v126, s64, v8
    v_dot2_f32_bf16 v12, v126, v126, v12
    v_dot2_f32_bf16 v16, v127, s64, v16
    v_dot2_f32_bf16 v17, v127, v127, v17
    buffer_load_dwordx4 v[164:167], v2, s[20:23], s61 offen offset:896
    s_waitcnt vmcnt(8)
    v_dot2_f32_bf16 v8, v128, s64, v8
    v_dot2_f32_bf16 v12, v128, v128, v12
    v_dot2_f32_bf16 v16, v129, s64, v16
    v_dot2_f32_bf16 v17, v129, v129, v17
    v_dot2_f32_bf16 v8, v130, s64, v8
    v_dot2_f32_bf16 v12, v130, v130, v12
    v_dot2_f32_bf16 v16, v131, s64, v16
    v_dot2_f32_bf16 v17, v131, v131, v17
    buffer_load_dwordx4 v[168:171], v2, s[20:23], s61 offen offset:1024
    v_dot2_f32_bf16 v8, v132, s64, v8
    v_dot2_f32_bf16 v12, v132, v132, v12
    v_dot2_f32_bf16 v16, v133, s64, v16
    v_dot2_f32_bf16 v17, v133, v133, v17
    v_dot2_f32_bf16 v8, v134, s64, v8
    v_dot2_f32_bf16 v12, v134, v134, v12
    v_dot2_f32_bf16 v16, v135, s64, v16
    v_dot2_f32_bf16 v17, v135, v135, v17
    buffer_load_dwordx4 v[172:175], v2, s[20:23], s61 offen offset:1152
    s_nop 2
    v_add_f32 v8, v8, v16
    v_add_f32 v12, v12, v17
    s_nop 0
    v_add_f32_dpp v8, v8, v8 quad_perm:[1,0,3,2] row_mask:0xf bank_mask:0xf
    v_add_f32_dpp v12, v12, v12 quad_perm:[1,0,3,2] row_mask:0xf bank_mask:0xf
    s_nop 0
    v_add_f32_dpp v8, v8, v8 quad_perm:[2,3,0,1] row_mask:0xf bank_mask:0xf
    v_add_f32_dpp v12, v12, v12 quad_perm:[2,3,0,1] row_mask:0xf bank_mask:0xf
    s_nop 0
    v_add_f32_dpp v8, v8, v8 row_half_mirror row_mask:0xf bank_mask:0xf
    v_add_f32_dpp v12, v12, v12 row_half_mirror row_mask:0xf bank_mask:0xf
    s_nop 0
    v_mul_f32 v8, s66, v8
    v_mul_f32 v12, s66, v12
    v_fma_f32 v12, -v8, v8, v12
    v_max_f32 v12, 0, v12
    v_add_f32 v12, s67, v12
    v_rsq_f32 v12, v12
    s_nop 0
    v_mul_f32 v8, v8, v12
    v_sub_f32 v8, 0, v8
    v_lshlrev_b32 v24, 16, v96
    v_and_b32 v25, 0xffff0000, v96
    v_lshlrev_b32 v26, 16, v97
    v_and_b32 v27, 0xffff0000, v97
    v_lshlrev_b32 v28, 16, v98
    v_and_b32 v29, 0xffff0000, v98
    v_lshlrev_b32 v30, 16, v99
    v_and_b32 v31, 0xffff0000, v99
    v_fma_f32 v24, v24, v12, v8
    v_fma_f32 v25, v25, v12, v8
    v_fma_f32 v26, v26, v12, v8
    v_fma_f32 v27, v27, v12, v8
    v_fma_f32 v28, v28, v12, v8
    v_fma_f32 v29, v29, v12, v8
    v_fma_f32 v30, v30, v12, v8
    v_fma_f32 v31, v31, v12, v8
    v_cvt_pk_bf16_f32 v96, v24, v25
    v_cvt_pk_bf16_f32 v97, v26, v27
    v_cvt_pk_bf16_f32 v98, v28, v29
    v_cvt_pk_bf16_f32 v99, v30, v31
    ds_write_b128 v5, v[96:99] offset:0
    v_mov_b32 v9, 0
    v_mov_b32 v13, 0
    v_mov_b32 v16, 0
    v_mov_b32 v17, 0
    s_waitcnt vmcnt(8)
    v_dot2_f32_bf16 v9, v136, s64, v9
    v_dot2_f32_bf16 v13, v136, v136, v13
    v_dot2_f32_bf16 v16, v137, s64, v16
    v_dot2_f32_bf16 v17, v137, v137, v17
    v_dot2_f32_bf16 v9, v138, s64, v9
    v_dot2_f32_bf16 v13, v138, v138, v13
    v_dot2_f32_bf16 v16, v139, s64, v16
    v_dot2_f32_bf16 v17, v139, v139, v17
    buffer_load_dwordx4 v[176:179], v2, s[20:23], s62 offen offset:0
    v_dot2_f32_bf16 v9, v140, s64, v9
    v_dot2_f32_bf16 v13, v140, v140, v13
    v_dot2_f32_bf16 v16, v141, s64, v16
    v_dot2_f32_bf16 v17, v141, v141, v17
    v_dot2_f32_bf16 v9, v142, s64, v9
    v_dot2_f32_bf16 v13, v142, v142, v13
    v_dot2_f32_bf16 v16, v143, s64, v16
    v_dot2_f32_bf16 v17, v143, v143, v17
    buffer_load_dwordx4 v[180:183], v2, s[20:23], s62 offen offset:128
    s_waitcnt vmcnt(8)
    v_dot2_f32_bf16 v9, v144, s64, v9
    v_dot2_f32_bf16 v13, v144, v144, v13
    v_dot2_f32_bf16 v16, v145, s64, v16
    v_dot2_f32_bf16 v17, v145, v145, v17
    v_dot2_f32_bf16 v9, v146, s64, v9
    v_dot2_f32_bf16 v13, v146, v146, v13
    v_dot2_f32_bf16 v16, v147, s64, v16
    v_dot2_f32_bf16 v17, v147, v147, v17
    buffer_load_dwordx4 v[184:187], v2, s[20:23], s62 offen offset:256
    v_dot2_f32_bf16 v9, v148, s64, v9
    v_dot2_f32_bf16 v13, v148, v148, v13
    v_dot2_f32_bf16 v16, v149, s64, v16
    v_dot2_f32_bf16 v17, v149, v149, v17
    v_dot2_f32_bf16 v9, v150, s64, v9
    v_dot2_f32_bf16 v13, v150, v150, v13
    v_dot2_f32_bf16 v16, v151, s64, v16
    v_dot2_f32_bf16 v17, v151, v151, v17
    buffer_load_dwordx4 v[188:191], v2, s[20:23], s62 offen offset:384
    s_waitcnt vmcnt(8)
    v_dot2_f32_bf16 v9, v152, s64, v9
    v_dot2_f32_bf16 v13, v152, v152, v13
    v_dot2_f32_bf16 v16, v153, s64, v16
    v_dot2_f32_bf16 v17, v153, v153, v17
    v_dot2_f32_bf16 v9, v154, s64, v9
    v_dot2_f32_bf16 v13, v154, v154, v13
    v_dot2_f32_bf16 v16, v155, s64, v16
    v_dot2_f32_bf16 v17, v155, v155, v17
    buffer_load_dwordx4 v[192:195], v2, s[20:23], s62 offen offset:512
    v_dot2_f32_bf16 v9, v156, s64, v9
    v_dot2_f32_bf16 v13, v156, v156, v13
    v_dot2_f32_bf16 v16, v157, s64, v16
    v_dot2_f32_bf16 v17, v157, v157, v17
    v_dot2_f32_bf16 v9, v158, s64, v9
    v_dot2_f32_bf16 v13, v158, v158, v13
    v_dot2_f32_bf16 v16, v159, s64, v16
    v_dot2_f32_bf16 v17, v159, v159, v17
    buffer_load_dwordx4 v[196:199], v2, s[20:23], s62 offen offset:640
    s_waitcnt vmcnt(8)
    v_dot2_f32_bf16 v9, v160, s64, v9
    v_dot2_f32_bf16 v13, v160, v160, v13
    v_dot2_f32_bf16 v16, v161, s64, v16
    v_dot2_f32_bf16 v17, v161, v161, v17
    v_dot2_f32_bf16 v9, v162, s64, v9
    v_dot2_f32_bf16 v13, v162, v162, v13
    v_dot2_f32_bf16 v16, v163, s64, v16
    v_dot2_f32_bf16 v17, v163, v163, v17
    buffer_load_dwordx4 v[200:203], v2, s[20:23], s62 offen offset:768
    v_dot2_f32_bf16 v9, v164, s64, v9
    v_dot2_f32_bf16 v13, v164, v164, v13
    v_dot2_f32_bf16 v16, v165, s64, v16
    v_dot2_f32_bf16 v17, v165, v165, v17
    v_dot2_f32_bf16 v9, v166, s64, v9
    v_dot2_f32_bf16 v13, v166, v166, v13
    v_dot2_f32_bf16 v16, v167, s64, v16
    v_dot2_f32_bf16 v17, v167, v167, v17
    buffer_load_dwordx4 v[204:207], v2, s[20:23], s62 offen offset:896
    s_waitcnt vmcnt(8)
    v_dot2_f32_bf16 v9, v168, s64, v9
    v_dot2_f32_bf16 v13, v168, v168, v13
    v_dot2_f32_bf16 v16, v169, s64, v16
    v_dot2_f32_bf16 v17, v169, v169, v17
    v_dot2_f32_bf16 v9, v170, s64, v9
    v_dot2_f32_bf16 v13, v170, v170, v13
    v_dot2_f32_bf16 v16, v171, s64, v16
    v_dot2_f32_bf16 v17, v171, v171, v17
    buffer_load_dwordx4 v[208:211], v2, s[20:23], s62 offen offset:1024
    v_dot2_f32_bf16 v9, v172, s64, v9
    v_dot2_f32_bf16 v13, v172, v172, v13
    v_dot2_f32_bf16 v16, v173, s64, v16
    v_dot2_f32_bf16 v17, v173, v173, v17
    v_dot2_f32_bf16 v9, v174, s64, v9
    v_dot2_f32_bf16 v13, v174, v174, v13
    v_dot2_f32_bf16 v16, v175, s64, v16
    v_dot2_f32_bf16 v17, v175, v175, v17
    buffer_load_dwordx4 v[212:215], v2, s[20:23], s62 offen offset:1152
    s_nop 2
    v_add_f32 v9, v9, v16
    v_add_f32 v13, v13, v17
    s_nop 0
    v_add_f32_dpp v9, v9, v9 quad_perm:[1,0,3,2] row_mask:0xf bank_mask:0xf
    v_add_f32_dpp v13, v13, v13 quad_perm:[1,0,3,2] row_mask:0xf bank_mask:0xf
    s_nop 0
    v_add_f32_dpp v9, v9, v9 quad_perm:[2,3,0,1] row_mask:0xf bank_mask:0xf
    v_add_f32_dpp v13, v13, v13 quad_perm:[2,3,0,1] row_mask:0xf bank_mask:0xf
    s_nop 0
    v_add_f32_dpp v9, v9, v9 row_half_mirror row_mask:0xf bank_mask:0xf
    v_add_f32_dpp v13, v13, v13 row_half_mirror row_mask:0xf bank_mask:0xf
    s_nop 0
    v_mul_f32 v9, s66, v9
    v_mul_f32 v13, s66, v13
    v_fma_f32 v13, -v9, v9, v13
    v_max_f32 v13, 0, v13
    v_add_f32 v13, s67, v13
    v_rsq_f32 v13, v13
    s_nop 0
    v_mul_f32 v9, v9, v13
    v_sub_f32 v9, 0, v9
    v_lshlrev_b32 v32, 16, v136
    v_and_b32 v33, 0xffff0000, v136
    v_lshlrev_b32 v34, 16, v137
    v_and_b32 v35, 0xffff0000, v137
    v_lshlrev_b32 v36, 16, v138
    v_and_b32 v37, 0xffff0000, v138
    v_lshlrev_b32 v38, 16, v139
    v_and_b32 v39, 0xffff0000, v139
    v_fma_f32 v32, v32, v13, v9
    v_fma_f32 v33, v33, v13, v9
    v_fma_f32 v34, v34, v13, v9
    v_fma_f32 v35, v35, v13, v9
    v_fma_f32 v36, v36, v13, v9
    v_fma_f32 v37, v37, v13, v9
    v_fma_f32 v38, v38, v13, v9
    v_fma_f32 v39, v39, v13, v9
    v_cvt_pk_bf16_f32 v136, v32, v33
    v_cvt_pk_bf16_f32 v137, v34, v35
    v_cvt_pk_bf16_f32 v138, v36, v37
    v_cvt_pk_bf16_f32 v139, v38, v39
    ds_write_b128 v6, v[136:139] offset:0
    v_mov_b32 v10, 0
    v_mov_b32 v14, 0
    v_mov_b32 v16, 0
    v_mov_b32 v17, 0
    s_waitcnt vmcnt(8)
    v_dot2_f32_bf16 v10, v176, s64, v10
    v_dot2_f32_bf16 v14, v176, v176, v14
    v_dot2_f32_bf16 v16, v177, s64, v16
    v_dot2_f32_bf16 v17, v177, v177, v17
    v_dot2_f32_bf16 v10, v178, s64, v10
    v_dot2_f32_bf16 v14, v178, v178, v14
    v_dot2_f32_bf16 v16, v179, s64, v16
    v_dot2_f32_bf16 v17, v179, v179, v17
    buffer_load_dwordx4 v[216:219], v2, s[20:23], s63 offen offset:0
    v_dot2_f32_bf16 v10, v180, s64, v10
    v_dot2_f32_bf16 v14, v180, v180, v14
    v_dot2_f32_bf16 v16, v181, s64, v16
    v_dot2_f32_bf16 v17, v181, v181, v17
    v_dot2_f32_bf16 v10, v182, s64, v10
    v_dot2_f32_bf16 v14, v182, v182, v14
    v_dot2_f32_bf16 v16, v183, s64, v16
    v_dot2_f32_bf16 v17, v183, v183, v17
    buffer_load_dwordx4 v[220:223], v2, s[20:23], s63 offen offset:128
    s_waitcnt vmcnt(8)
    v_dot2_f32_bf16 v10, v184, s64, v10
    v_dot2_f32_bf16 v14, v184, v184, v14
    v_dot2_f32_bf16 v16, v185, s64, v16
    v_dot2_f32_bf16 v17, v185, v185, v17
    v_dot2_f32_bf16 v10, v186, s64, v10
    v_dot2_f32_bf16 v14, v186, v186, v14
    v_dot2_f32_bf16 v16, v187, s64, v16
    v_dot2_f32_bf16 v17, v187, v187, v17
    buffer_load_dwordx4 v[224:227], v2, s[20:23], s63 offen offset:256
    v_dot2_f32_bf16 v10, v188, s64, v10
    v_dot2_f32_bf16 v14, v188, v188, v14
    v_dot2_f32_bf16 v16, v189, s64, v16
    v_dot2_f32_bf16 v17, v189, v189, v17
    v_dot2_f32_bf16 v10, v190, s64, v10
    v_dot2_f32_bf16 v14, v190, v190, v14
    v_dot2_f32_bf16 v16, v191, s64, v16
    v_dot2_f32_bf16 v17, v191, v191, v17
    buffer_load_dwordx4 v[228:231], v2, s[20:23], s63 offen offset:384
    s_waitcnt vmcnt(8)
    v_dot2_f32_bf16 v10, v192, s64, v10
    v_dot2_f32_bf16 v14, v192, v192, v14
    v_dot2_f32_bf16 v16, v193, s64, v16
    v_dot2_f32_bf16 v17, v193, v193, v17
    v_dot2_f32_bf16 v10, v194, s64, v10
    v_dot2_f32_bf16 v14, v194, v194, v14
    v_dot2_f32_bf16 v16, v195, s64, v16
    v_dot2_f32_bf16 v17, v195, v195, v17
    buffer_load_dwordx4 v[232:235], v2, s[20:23], s63 offen offset:512
    v_dot2_f32_bf16 v10, v196, s64, v10
    v_dot2_f32_bf16 v14, v196, v196, v14
    v_dot2_f32_bf16 v16, v197, s64, v16
    v_dot2_f32_bf16 v17, v197, v197, v17
    v_dot2_f32_bf16 v10, v198, s64, v10
    v_dot2_f32_bf16 v14, v198, v198, v14
    v_dot2_f32_bf16 v16, v199, s64, v16
    v_dot2_f32_bf16 v17, v199, v199, v17
    buffer_load_dwordx4 v[236:239], v2, s[20:23], s63 offen offset:640
    s_waitcnt vmcnt(8)
    v_dot2_f32_bf16 v10, v200, s64, v10
    v_dot2_f32_bf16 v14, v200, v200, v14
    v_dot2_f32_bf16 v16, v201, s64, v16
    v_dot2_f32_bf16 v17, v201, v201, v17
    v_dot2_f32_bf16 v10, v202, s64, v10
    v_dot2_f32_bf16 v14, v202, v202, v14
    v_dot2_f32_bf16 v16, v203, s64, v16
    v_dot2_f32_bf16 v17, v203, v203, v17
    buffer_load_dwordx4 v[240:243], v2, s[20:23], s63 offen offset:768
    v_dot2_f32_bf16 v10, v204, s64, v10
    v_dot2_f32_bf16 v14, v204, v204, v14
    v_dot2_f32_bf16 v16, v205, s64, v16
    v_dot2_f32_bf16 v17, v205, v205, v17
    v_dot2_f32_bf16 v10, v206, s64, v10
    v_dot2_f32_bf16 v14, v206, v206, v14
    v_dot2_f32_bf16 v16, v207, s64, v16
    v_dot2_f32_bf16 v17, v207, v207, v17
    buffer_load_dwordx4 v[244:247], v2, s[20:23], s63 offen offset:896
    s_waitcnt vmcnt(8)
    v_dot2_f32_bf16 v10, v208, s64, v10
    v_dot2_f32_bf16 v14, v208, v208, v14
    v_dot2_f32_bf16 v16, v209, s64, v16
    v_dot2_f32_bf16 v17, v209, v209, v17
    v_dot2_f32_bf16 v10, v210, s64, v10
    v_dot2_f32_bf16 v14, v210, v210, v14
    v_dot2_f32_bf16 v16, v211, s64, v16
    v_dot2_f32_bf16 v17, v211, v211, v17
    buffer_load_dwordx4 v[248:251], v2, s[20:23], s63 offen offset:1024
    v_dot2_f32_bf16 v10, v212, s64, v10
    v_dot2_f32_bf16 v14, v212, v212, v14
    v_dot2_f32_bf16 v16, v213, s64, v16
    v_dot2_f32_bf16 v17, v213, v213, v17
    v_dot2_f32_bf16 v10, v214, s64, v10
    v_dot2_f32_bf16 v14, v214, v214, v14
    v_dot2_f32_bf16 v16, v215, s64, v16
    v_dot2_f32_bf16 v17, v215, v215, v17
    buffer_load_dwordx4 v[252:255], v2, s[20:23], s63 offen offset:1152
    s_barrier
    s_nop 2
    v_add_f32 v10, v10, v16
    v_add_f32 v14, v14, v17
    s_nop 0
    v_add_f32_dpp v10, v10, v10 quad_perm:[1,0,3,2] row_mask:0xf bank_mask:0xf
    v_add_f32_dpp v14, v14, v14 quad_perm:[1,0,3,2] row_mask:0xf bank_mask:0xf
    s_nop 0
    v_add_f32_dpp v10, v10, v10 quad_perm:[2,3,0,1] row_mask:0xf bank_mask:0xf
    v_add_f32_dpp v14, v14, v14 quad_perm:[2,3,0,1] row_mask:0xf bank_mask:0xf
    s_nop 0
    v_add_f32_dpp v10, v10, v10 row_half_mirror row_mask:0xf bank_mask:0xf
    v_add_f32_dpp v14, v14, v14 row_half_mirror row_mask:0xf bank_mask:0xf
    s_nop 0
    v_mul_f32 v10, s66, v10
    v_mul_f32 v14, s66, v14
    v_fma_f32 v14, -v10, v10, v14
    v_max_f32 v14, 0, v14
    v_add_f32 v14, s67, v14
    v_rsq_f32 v14, v14
    s_nop 0
    v_mul_f32 v10, v10, v14
    v_sub_f32 v10, 0, v10
    v_lshlrev_b32 v24, 16, v176
    v_and_b32 v25, 0xffff0000, v176
    v_lshlrev_b32 v26, 16, v177
    v_and_b32 v27, 0xffff0000, v177
    v_lshlrev_b32 v28, 16, v178
    v_and_b32 v29, 0xffff0000, v178
    v_lshlrev_b32 v30, 16, v179
    v_and_b32 v31, 0xffff0000, v179
    v_fma_f32 v24, v24, v14, v10
    v_fma_f32 v25, v25, v14, v10
    v_fma_f32 v26, v26, v14, v10
    v_fma_f32 v27, v27, v14, v10
    v_fma_f32 v28, v28, v14, v10
    v_fma_f32 v29, v29, v14, v10
    v_fma_f32 v30, v30, v14, v10
    v_fma_f32 v31, v31, v14, v10
    v_cvt_pk_bf16_f32 v176, v24, v25
    v_cvt_pk_bf16_f32 v177, v26, v27
    v_cvt_pk_bf16_f32 v178, v28, v29
    v_cvt_pk_bf16_f32 v179, v30, v31
    ds_write_b128 v5, v[176:179] offset:2048
    v_mov_b32 v11, 0
    v_mov_b32 v15, 0
    v_mov_b32 v16, 0
    v_mov_b32 v17, 0
    s_waitcnt vmcnt(8)
    v_dot2_f32_bf16 v11, v216, s64, v11
    v_dot2_f32_bf16 v15, v216, v216, v15
    v_dot2_f32_bf16 v16, v217, s64, v16
    v_dot2_f32_bf16 v17, v217, v217, v17
    v_dot2_f32_bf16 v11, v218, s64, v11
    v_dot2_f32_bf16 v15, v218, v218, v15
    v_dot2_f32_bf16 v16, v219, s64, v16
    v_dot2_f32_bf16 v17, v219, v219, v17
    v_dot2_f32_bf16 v11, v220, s64, v11
    v_dot2_f32_bf16 v15, v220, v220, v15
    v_dot2_f32_bf16 v16, v221, s64, v16
    v_dot2_f32_bf16 v17, v221, v221, v17
    v_dot2_f32_bf16 v11, v222, s64, v11
    v_dot2_f32_bf16 v15, v222, v222, v15
    v_dot2_f32_bf16 v16, v223, s64, v16
    v_dot2_f32_bf16 v17, v223, v223, v17
    s_waitcnt vmcnt(6)
    v_dot2_f32_bf16 v11, v224, s64, v11
    v_dot2_f32_bf16 v15, v224, v224, v15
    v_dot2_f32_bf16 v16, v225, s64, v16
    v_dot2_f32_bf16 v17, v225, v225, v17
    v_dot2_f32_bf16 v11, v226, s64, v11
    v_dot2_f32_bf16 v15, v226, v226, v15
    v_dot2_f32_bf16 v16, v227, s64, v16
    v_dot2_f32_bf16 v17, v227, v227, v17
    v_dot2_f32_bf16 v11, v228, s64, v11
    v_dot2_f32_bf16 v15, v228, v228, v15
    v_dot2_f32_bf16 v16, v229, s64, v16
    v_dot2_f32_bf16 v17, v229, v229, v17
    v_dot2_f32_bf16 v11, v230, s64, v11
    v_dot2_f32_bf16 v15, v230, v230, v15
    v_dot2_f32_bf16 v16, v231, s64, v16
    v_dot2_f32_bf16 v17, v231, v231, v17
    s_waitcnt vmcnt(4)
    v_dot2_f32_bf16 v11, v232, s64, v11
    v_dot2_f32_bf16 v15, v232, v232, v15
    v_dot2_f32_bf16 v16, v233, s64, v16
    v_dot2_f32_bf16 v17, v233, v233, v17
    v_dot2_f32_bf16 v11, v234, s64, v11
    v_dot2_f32_bf16 v15, v234, v234, v15
    v_dot2_f32_bf16 v16, v235, s64, v16
    v_dot2_f32_bf16 v17, v235, v235, v17
    v_dot2_f32_bf16 v11, v236, s64, v11
    v_dot2_f32_bf16 v15, v236, v236, v15
    v_dot2_f32_bf16 v16, v237, s64, v16
    v_dot2_f32_bf16 v17, v237, v237, v17
    v_dot2_f32_bf16 v11, v238, s64, v11
    v_dot2_f32_bf16 v15, v238, v238, v15
    v_dot2_f32_bf16 v16, v239, s64, v16
    v_dot2_f32_bf16 v17, v239, v239, v17
    s_waitcnt vmcnt(2)
    v_dot2_f32_bf16 v11, v240, s64, v11
    v_dot2_f32_bf16 v15, v240, v240, v15
    v_dot2_f32_bf16 v16, v241, s64, v16
    v_dot2_f32_bf16 v17, v241, v241, v17
    v_dot2_f32_bf16 v11, v242, s64, v11
    v_dot2_f32_bf16 v15, v242, v242, v15
    v_dot2_f32_bf16 v16, v243, s64, v16
    v_dot2_f32_bf16 v17, v243, v243, v17
    v_dot2_f32_bf16 v11, v244, s64, v11
    v_dot2_f32_bf16 v15, v244, v244, v15
    v_dot2_f32_bf16 v16, v245, s64, v16
    v_dot2_f32_bf16 v17, v245, v245, v17
    v_dot2_f32_bf16 v11, v246, s64, v11
    v_dot2_f32_bf16 v15, v246, v246, v15
    v_dot2_f32_bf16 v16, v247, s64, v16
    v_dot2_f32_bf16 v17, v247, v247, v17
    s_waitcnt vmcnt(0)
    v_dot2_f32_bf16 v11, v248, s64, v11
    v_dot2_f32_bf16 v15, v248, v248, v15
    v_dot2_f32_bf16 v16, v249, s64, v16
    v_dot2_f32_bf16 v17, v249, v249, v17
    v_dot2_f32_bf16 v11, v250, s64, v11
    v_dot2_f32_bf16 v15, v250, v250, v15
    v_dot2_f32_bf16 v16, v251, s64, v16
    v_dot2_f32_bf16 v17, v251, v251, v17
    v_dot2_f32_bf16 v11, v252, s64, v11
    v_dot2_f32_bf16 v15, v252, v252, v15
    v_dot2_f32_bf16 v16, v253, s64, v16
    v_dot2_f32_bf16 v17, v253, v253, v17
    v_dot2_f32_bf16 v11, v254, s64, v11
    v_dot2_f32_bf16 v15, v254, v254, v15
    v_dot2_f32_bf16 v16, v255, s64, v16
    v_dot2_f32_bf16 v17, v255, v255, v17
    s_nop 2
    v_add_f32 v11, v11, v16
    v_add_f32 v15, v15, v17
    s_nop 0
    v_add_f32_dpp v11, v11, v11 quad_perm:[1,0,3,2] row_mask:0xf bank_mask:0xf
    v_add_f32_dpp v15, v15, v15 quad_perm:[1,0,3,2] row_mask:0xf bank_mask:0xf
    s_nop 0
    v_add_f32_dpp v11, v11, v11 quad_perm:[2,3,0,1] row_mask:0xf bank_mask:0xf
    v_add_f32_dpp v15, v15, v15 quad_perm:[2,3,0,1] row_mask:0xf bank_mask:0xf
    s_nop 0
    v_add_f32_dpp v11, v11, v11 row_half_mirror row_mask:0xf bank_mask:0xf
    v_add_f32_dpp v15, v15, v15 row_half_mirror row_mask:0xf bank_mask:0xf
    s_nop 0
    v_mul_f32 v11, s66, v11
    v_mul_f32 v15, s66, v15
    v_fma_f32 v15, -v11, v11, v15
    v_max_f32 v15, 0, v15
    v_add_f32 v15, s67, v15
    v_rsq_f32 v15, v15
    s_nop 0
    v_mul_f32 v11, v11, v15
    v_sub_f32 v11, 0, v11
    v_lshlrev_b32 v32, 16, v216
    v_and_b32 v33, 0xffff0000, v216
    v_lshlrev_b32 v34, 16, v217
    v_and_b32 v35, 0xffff0000, v217
    v_lshlrev_b32 v36, 16, v218
    v_and_b32 v37, 0xffff0000, v218
    v_lshlrev_b32 v38, 16, v219
    v_and_b32 v39, 0xffff0000, v219
    v_fma_f32 v32, v32, v15, v11
    v_fma_f32 v33, v33, v15, v11
    v_fma_f32 v34, v34, v15, v11
    v_fma_f32 v35, v35, v15, v11
    v_fma_f32 v36, v36, v15, v11
    v_fma_f32 v37, v37, v15, v11
    v_fma_f32 v38, v38, v15, v11
    v_fma_f32 v39, v39, v15, v11
    v_cvt_pk_bf16_f32 v216, v32, v33
    v_cvt_pk_bf16_f32 v217, v34, v35
    v_cvt_pk_bf16_f32 v218, v36, v37
    v_cvt_pk_bf16_f32 v219, v38, v39
    ds_write_b128 v6, v[216:219] offset:2048
    s_waitcnt lgkmcnt(0)
    s_barrier
    s_add_u32 m0, s57, 114688
    v_lshlrev_b32 v24, 16, v100
    buffer_load_dwordx4 v3, s[28:31], s53 offen lds
    v_and_b32 v25, 0xffff0000, v100
    v_lshlrev_b32 v26, 16, v101
    v_and_b32 v27, 0xffff0000, v101
    v_lshlrev_b32 v28, 16, v102
    v_and_b32 v29, 0xffff0000, v102
    v_lshlrev_b32 v30, 16, v103
    v_and_b32 v31, 0xffff0000, v103
    s_add_u32 m0, s57, 115712
    v_fma_f32 v24, v24, v12, v8
    buffer_load_dwordx4 v7, s[28:31], s54 offen lds
    v_fma_f32 v25, v25, v12, v8
    v_fma_f32 v26, v26, v12, v8
    v_fma_f32 v27, v27, v12, v8
    v_fma_f32 v28, v28, v12, v8
    v_fma_f32 v29, v29, v12, v8
    v_fma_f32 v30, v30, v12, v8
    v_fma_f32 v31, v31, v12, v8
    s_add_u32 m0, s57, 122880
    v_cvt_pk_bf16_f32 v100, v24, v25
    buffer_load_dwordx4 v3, s[32:35], s53 offen lds
    v_cvt_pk_bf16_f32 v101, v26, v27
    v_cvt_pk_bf16_f32 v102, v28, v29
    v_cvt_pk_bf16_f32 v103, v30, v31
    ds_write_b128 v5, v[100:103] offset:16384
    v_lshlrev_b32 v32, 16, v140
    v_and_b32 v33, 0xffff0000, v140
    v_lshlrev_b32 v34, 16, v141
    s_add_u32 m0, s57, 123904
    v_and_b32 v35, 0xffff0000, v141
    buffer_load_dwordx4 v7, s[32:35], s54 offen lds
    v_lshlrev_b32 v36, 16, v142
    v_and_b32 v37, 0xffff0000, v142
    v_lshlrev_b32 v38, 16, v143
    v_and_b32 v39, 0xffff0000, v143
    v_fma_f32 v32, v32, v13, v9
    v_fma_f32 v33, v33, v13, v9
    v_fma_f32 v34, v34, v13, v9
    s_add_u32 m0, s57, 131072
    v_fma_f32 v35, v35, v13, v9
    buffer_load_dwordx4 v3, s[36:39], s53 offen lds
    v_fma_f32 v36, v36, v13, v9
    v_fma_f32 v37, v37, v13, v9
    v_fma_f32 v38, v38, v13, v9
    v_fma_f32 v39, v39, v13, v9
    v_cvt_pk_bf16_f32 v140, v32, v33
    v_cvt_pk_bf16_f32 v141, v34, v35
    v_cvt_pk_bf16_f32 v142, v36, v37
    s_add_u32 m0, s57, 132096
    v_cvt_pk_bf16_f32 v143, v38, v39
    buffer_load_dwordx4 v7, s[36:39], s54 offen lds
    ds_write_b128 v6, v[140:143] offset:16384
    v_lshlrev_b32 v24, 16, v180
    v_and_b32 v25, 0xffff0000, v180
    v_lshlrev_b32 v26, 16, v181
    v_and_b32 v27, 0xffff0000, v181
    v_lshlrev_b32 v28, 16, v182
    v_and_b32 v29, 0xffff0000, v182
    s_add_u32 m0, s57, 139264
    v_lshlrev_b32 v30, 16, v183
    buffer_load_dwordx4 v3, s[40:43], s53 offen lds
    v_and_b32 v31, 0xffff0000, v183
    v_fma_f32 v24, v24, v14, v10
    v_fma_f32 v25, v25, v14, v10
    v_fma_f32 v26, v26, v14, v10
    v_fma_f32 v27, v27, v14, v10
    v_fma_f32 v28, v28, v14, v10
    v_fma_f32 v29, v29, v14, v10
    s_add_u32 m0, s57, 140288
    v_fma_f32 v30, v30, v14, v10
    buffer_load_dwordx4 v7, s[40:43], s54 offen lds
    v_fma_f32 v31, v31, v14, v10
    v_cvt_pk_bf16_f32 v180, v24, v25
    v_cvt_pk_bf16_f32 v181, v26, v27
    v_cvt_pk_bf16_f32 v182, v28, v29
    v_cvt_pk_bf16_f32 v183, v30, v31
    ds_write_b128 v5, v[180:183] offset:18432
    v_lshlrev_b32 v32, 16, v220
    s_add_u32 m0, s57, 147456
    v_and_b32 v33, 0xffff0000, v220
    buffer_load_dwordx4 v4, s[44:47], s55 offen lds
    v_lshlrev_b32 v34, 16, v221
    v_and_b32 v35, 0xffff0000, v221
    v_lshlrev_b32 v36, 16, v222
    v_and_b32 v37, 0xffff0000, v222
    v_lshlrev_b32 v38, 16, v223
    v_and_b32 v39, 0xffff0000, v223
    v_fma_f32 v32, v32, v15, v11
    s_add_u32 m0, s57, 148480
    v_fma_f32 v33, v33, v15, v11
    buffer_load_dwordx4 v18, s[44:47], s56 offen lds
    v_fma_f32 v34, v34, v15, v11
    v_fma_f32 v35, v35, v15, v11
    v_fma_f32 v36, v36, v15, v11
    v_fma_f32 v37, v37, v15, v11
    v_fma_f32 v38, v38, v15, v11
    v_fma_f32 v39, v39, v15, v11
    v_cvt_pk_bf16_f32 v220, v32, v33
    v_cvt_pk_bf16_f32 v221, v34, v35
    v_cvt_pk_bf16_f32 v222, v36, v37
    v_cvt_pk_bf16_f32 v223, v38, v39
    ds_write_b128 v6, v[220:223] offset:18432
    s_add_u32 s53, s53, s65
    s_add_u32 s54, s54, s65
    s_add_u32 s55, s55, 245760
    s_add_u32 s56, s56, 245760
    s_waitcnt vmcnt(10) lgkmcnt(0)
    s_barrier
    s_add_u32 m0, s57, 32768
    v_lshlrev_b32 v24, 16, v104
    buffer_load_dwordx4 v3, s[28:31], s53 offen lds
    v_and_b32 v25, 0xffff0000, v104
    v_lshlrev_b32 v26, 16, v105
    v_and_b32 v27, 0xffff0000, v105
    v_lshlrev_b32 v28, 16, v106
    v_and_b32 v29, 0xffff0000, v106
    v_lshlrev_b32 v30, 16, v107
    v_and_b32 v31, 0xffff0000, v107
    s_add_u32 m0, s57, 33792
    v_fma_f32 v24, v24, v12, v8
    buffer_load_dwordx4 v7, s[28:31], s54 offen lds
    v_fma_f32 v25, v25, v12, v8
    v_fma_f32 v26, v26, v12, v8
    v_fma_f32 v27, v27, v12, v8
    v_fma_f32 v28, v28, v12, v8
    v_fma_f32 v29, v29, v12, v8
    v_fma_f32 v30, v30, v12, v8
    v_fma_f32 v31, v31, v12, v8
    s_add_u32 m0, s57, 40960
    v_cvt_pk_bf16_f32 v104, v24, v25
    buffer_load_dwordx4 v3, s[32:35], s53 offen lds
    v_cvt_pk_bf16_f32 v105, v26, v27
    v_cvt_pk_bf16_f32 v106, v28, v29
    v_cvt_pk_bf16_f32 v107, v30, v31
    ds_write_b128 v5, v[104:107] offset:0
    v_lshlrev_b32 v32, 16, v144
    v_and_b32 v33, 0xffff0000, v144
    v_lshlrev_b32 v34, 16, v145
    s_add_u32 m0, s57, 41984
    v_and_b32 v35, 0xffff0000, v145
    buffer_load_dwordx4 v7, s[32:35], s54 offen lds
    v_lshlrev_b32 v36, 16, v146
    v_and_b32 v37, 0xffff0000, v146
    v_lshlrev_b32 v38, 16, v147
    v_and_b32 v39, 0xffff0000, v147
    v_fma_f32 v32, v32, v13, v9
    v_fma_f32 v33, v33, v13, v9
    v_fma_f32 v34, v34, v13, v9
    s_add_u32 m0, s57, 49152
    v_fma_f32 v35, v35, v13, v9
    buffer_load_dwordx4 v3, s[36:39], s53 offen lds
    v_fma_f32 v36, v36, v13, v9
    v_fma_f32 v37, v37, v13, v9
    v_fma_f32 v38, v38, v13, v9
    v_fma_f32 v39, v39, v13, v9
    v_cvt_pk_bf16_f32 v144, v32, v33
    v_cvt_pk_bf16_f32 v145, v34, v35
    v_cvt_pk_bf16_f32 v146, v36, v37
    s_add_u32 m0, s57, 50176
    v_cvt_pk_bf16_f32 v147, v38, v39
    buffer_load_dwordx4 v7, s[36:39], s54 offen lds
    ds_write_b128 v6, v[144:147] offset:0
    v_lshlrev_b32 v24, 16, v184
    v_and_b32 v25, 0xffff0000, v184
    v_lshlrev_b32 v26, 16, v185
    v_and_b32 v27, 0xffff0000, v185
    v_lshlrev_b32 v28, 16, v186
    v_and_b32 v29, 0xffff0000, v186
    s_add_u32 m0, s57, 57344
    v_lshlrev_b32 v30, 16, v187
    buffer_load_dwordx4 v3, s[40:43], s53 offen lds
    v_and_b32 v31, 0xffff0000, v187
    v_fma_f32 v24, v24, v14, v10
    v_fma_f32 v25, v25, v14, v10
    v_fma_f32 v26, v26, v14, v10
    v_fma_f32 v27, v27, v14, v10
    v_fma_f32 v28, v28, v14, v10
    v_fma_f32 v29, v29, v14, v10
    s_add_u32 m0, s57, 58368
    v_fma_f32 v30, v30, v14, v10
    buffer_load_dwordx4 v7, s[40:43], s54 offen lds
    v_fma_f32 v31, v31, v14, v10
    v_cvt_pk_bf16_f32 v184, v24, v25
    v_cvt_pk_bf16_f32 v185, v26, v27
    v_cvt_pk_bf16_f32 v186, v28, v29
    v_cvt_pk_bf16_f32 v187, v30, v31
    ds_write_b128 v5, v[184:187] offset:2048
    v_lshlrev_b32 v32, 16, v224
    s_add_u32 m0, s57, 65536
    v_and_b32 v33, 0xffff0000, v224
    buffer_load_dwordx4 v4, s[44:47], s55 offen lds
    v_lshlrev_b32 v34, 16, v225
    v_and_b32 v35, 0xffff0000, v225
    v_lshlrev_b32 v36, 16, v226
    v_and_b32 v37, 0xffff0000, v226
    v_lshlrev_b32 v38, 16, v227
    v_and_b32 v39, 0xffff0000, v227
    v_fma_f32 v32, v32, v15, v11
    s_add_u32 m0, s57, 66560
    v_fma_f32 v33, v33, v15, v11
    buffer_load_dwordx4 v18, s[44:47], s56 offen lds
    v_fma_f32 v34, v34, v15, v11
    v_fma_f32 v35, v35, v15, v11
    v_fma_f32 v36, v36, v15, v11
    v_fma_f32 v37, v37, v15, v11
    v_fma_f32 v38, v38, v15, v11
    v_fma_f32 v39, v39, v15, v11
    v_cvt_pk_bf16_f32 v224, v32, v33
    v_cvt_pk_bf16_f32 v225, v34, v35
    v_cvt_pk_bf16_f32 v226, v36, v37
    v_cvt_pk_bf16_f32 v227, v38, v39
    ds_write_b128 v6, v[224:227] offset:2048
    s_add_u32 s53, s53, s65
    s_add_u32 s54, s54, s65
    s_add_u32 s55, s55, 245760
    s_add_u32 s56, s56, 245760
    s_waitcnt vmcnt(10) lgkmcnt(0)
    s_barrier
    s_add_u32 m0, s57, 73728
    v_lshlrev_b32 v24, 16, v108
    buffer_load_dwordx4 v3, s[28:31], s53 offen lds
    v_and_b32 v25, 0xffff0000, v108
    v_lshlrev_b32 v26, 16, v109
    v_and_b32 v27, 0xffff0000, v109
    v_lshlrev_b32 v28, 16, v110
    v_and_b32 v29, 0xffff0000, v110
    v_lshlrev_b32 v30, 16, v111
    v_and_b32 v31, 0xffff0000, v111
    s_add_u32 m0, s57, 74752
    v_fma_f32 v24, v24, v12, v8
    buffer_load_dwordx4 v7, s[28:31], s54 offen lds
    v_fma_f32 v25, v25, v12, v8
    v_fma_f32 v26, v26, v12, v8
    v_fma_f32 v27, v27, v12, v8
    v_fma_f32 v28, v28, v12, v8
    v_fma_f32 v29, v29, v12, v8
    v_fma_f32 v30, v30, v12, v8
    v_fma_f32 v31, v31, v12, v8
    s_add_u32 m0, s57, 81920
    v_cvt_pk_bf16_f32 v108, v24, v25
    buffer_load_dwordx4 v3, s[32:35], s53 offen lds
    v_cvt_pk_bf16_f32 v109, v26, v27
    v_cvt_pk_bf16_f32 v110, v28, v29
    v_cvt_pk_bf16_f32 v111, v30, v31
    ds_write_b128 v5, v[108:111] offset:16384
    v_lshlrev_b32 v32, 16, v148
    v_and_b32 v33, 0xffff0000, v148
    v_lshlrev_b32 v34, 16, v149
    s_add_u32 m0, s57, 82944
    v_and_b32 v35, 0xffff0000, v149
    buffer_load_dwordx4 v7, s[32:35], s54 offen lds
    v_lshlrev_b32 v36, 16, v150
    v_and_b32 v37, 0xffff0000, v150
    v_lshlrev_b32 v38, 16, v151
    v_and_b32 v39, 0xffff0000, v151
    v_fma_f32 v32, v32, v13, v9
    v_fma_f32 v33, v33, v13, v9
    v_fma_f32 v34, v34, v13, v9
    s_add_u32 m0, s57, 90112
    v_fma_f32 v35, v35, v13, v9
    buffer_load_dwordx4 v3, s[36:39], s53 offen lds
    v_fma_f32 v36, v36, v13, v9
    v_fma_f32 v37, v37, v13, v9
    v_fma_f32 v38, v38, v13, v9
    v_fma_f32 v39, v39, v13, v9
    v_cvt_pk_bf16_f32 v148, v32, v33
    v_cvt_pk_bf16_f32 v149, v34, v35
    v_cvt_pk_bf16_f32 v150, v36, v37
    s_add_u32 m0, s57, 91136
    v_cvt_pk_bf16_f32 v151, v38, v39
    buffer_load_dwordx4 v7, s[36:39], s54 offen lds
    ds_write_b128 v6, v[148:151] offset:16384
    v_lshlrev_b32 v24, 16, v188
    v_and_b32 v25, 0xffff0000, v188
    v_lshlrev_b32 v26, 16, v189
    v_and_b32 v27, 0xffff0000, v189
    v_lshlrev_b32 v28, 16, v190
    v_and_b32 v29, 0xffff0000, v190
    s_add_u32 m0, s57, 98304
    v_lshlrev_b32 v30, 16, v191
    buffer_load_dwordx4 v3, s[40:43], s53 offen lds
    v_and_b32 v31, 0xffff0000, v191
    v_fma_f32 v24, v24, v14, v10
    v_fma_f32 v25, v25, v14, v10
    v_fma_f32 v26, v26, v14, v10
    v_fma_f32 v27, v27, v14, v10
    v_fma_f32 v28, v28, v14, v10
    v_fma_f32 v29, v29, v14, v10
    s_add_u32 m0, s57, 99328
    v_fma_f32 v30, v30, v14, v10
    buffer_load_dwordx4 v7, s[40:43], s54 offen lds
    v_fma_f32 v31, v31, v14, v10
    v_cvt_pk_bf16_f32 v188, v24, v25
    v_cvt_pk_bf16_f32 v189, v26, v27
    v_cvt_pk_bf16_f32 v190, v28, v29
    v_cvt_pk_bf16_f32 v191, v30, v31
    ds_write_b128 v5, v[188:191] offset:18432
    v_lshlrev_b32 v32, 16, v228
    s_add_u32 m0, s57, 106496
    v_and_b32 v33, 0xffff0000, v228
    buffer_load_dwordx4 v4, s[44:47], s55 offen lds
    v_lshlrev_b32 v34, 16, v229
    v_and_b32 v35, 0xffff0000, v229
    v_lshlrev_b32 v36, 16, v230
    v_and_b32 v37, 0xffff0000, v230
    v_lshlrev_b32 v38, 16, v231
    v_and_b32 v39, 0xffff0000, v231
    v_fma_f32 v32, v32, v15, v11
    s_add_u32 m0, s57, 107520
    v_fma_f32 v33, v33, v15, v11
    buffer_load_dwordx4 v18, s[44:47], s56 offen lds
    v_fma_f32 v34, v34, v15, v11
    v_fma_f32 v35, v35, v15, v11
    v_fma_f32 v36, v36, v15, v11
    v_fma_f32 v37, v37, v15, v11
    v_fma_f32 v38, v38, v15, v11
    v_fma_f32 v39, v39, v15, v11
    v_cvt_pk_bf16_f32 v228, v32, v33
    v_cvt_pk_bf16_f32 v229, v34, v35
    v_cvt_pk_bf16_f32 v230, v36, v37
    v_cvt_pk_bf16_f32 v231, v38, v39
    ds_write_b128 v6, v[228:231] offset:18432
    s_add_u32 s53, s53, s65
    s_add_u32 s54, s54, s65
    s_add_u32 s55, s55, 245760
    s_add_u32 s56, s56, 245760
    s_waitcnt vmcnt(10) lgkmcnt(0)
    s_barrier
    s_add_u32 m0, s57, 114688
    v_lshlrev_b32 v24, 16, v112
    buffer_load_dwordx4 v3, s[28:31], s53 offen lds
    v_and_b32 v25, 0xffff0000, v112
    v_lshlrev_b32 v26, 16, v113
    v_and_b32 v27, 0xffff0000, v113
    v_lshlrev_b32 v28, 16, v114
    v_and_b32 v29, 0xffff0000, v114
    v_lshlrev_b32 v30, 16, v115
    v_and_b32 v31, 0xffff0000, v115
    s_add_u32 m0, s57, 115712
    v_fma_f32 v24, v24, v12, v8
    buffer_load_dwordx4 v7, s[28:31], s54 offen lds
    v_fma_f32 v25, v25, v12, v8
    v_fma_f32 v26, v26, v12, v8
    v_fma_f32 v27, v27, v12, v8
    v_fma_f32 v28, v28, v12, v8
    v_fma_f32 v29, v29, v12, v8
    v_fma_f32 v30, v30, v12, v8
    v_fma_f32 v31, v31, v12, v8
    s_add_u32 m0, s57, 122880
    v_cvt_pk_bf16_f32 v112, v24, v25
    buffer_load_dwordx4 v3, s[32:35], s53 offen lds
    v_cvt_pk_bf16_f32 v113, v26, v27
    v_cvt_pk_bf16_f32 v114, v28, v29
    v_cvt_pk_bf16_f32 v115, v30, v31
    ds_write_b128 v5, v[112:115] offset:0
    v_lshlrev_b32 v32, 16, v152
    v_and_b32 v33, 0xffff0000, v152
    v_lshlrev_b32 v34, 16, v153
    s_add_u32 m0, s57, 123904
    v_and_b32 v35, 0xffff0000, v153
    buffer_load_dwordx4 v7, s[32:35], s54 offen lds
    v_lshlrev_b32 v36, 16, v154
    v_and_b32 v37, 0xffff0000, v154
    v_lshlrev_b32 v38, 16, v155
    v_and_b32 v39, 0xffff0000, v155
    v_fma_f32 v32, v32, v13, v9
    v_fma_f32 v33, v33, v13, v9
    v_fma_f32 v34, v34, v13, v9
    s_add_u32 m0, s57, 131072
    v_fma_f32 v35, v35, v13, v9
    buffer_load_dwordx4 v3, s[36:39], s53 offen lds
    v_fma_f32 v36, v36, v13, v9
    v_fma_f32 v37, v37, v13, v9
    v_fma_f32 v38, v38, v13, v9
    v_fma_f32 v39, v39, v13, v9
    v_cvt_pk_bf16_f32 v152, v32, v33
    v_cvt_pk_bf16_f32 v153, v34, v35
    v_cvt_pk_bf16_f32 v154, v36, v37
    s_add_u32 m0, s57, 132096
    v_cvt_pk_bf16_f32 v155, v38, v39
    buffer_load_dwordx4 v7, s[36:39], s54 offen lds
    ds_write_b128 v6, v[152:155] offset:0
    v_lshlrev_b32 v24, 16, v192
    v_and_b32 v25, 0xffff0000, v192
    v_lshlrev_b32 v26, 16, v193
    v_and_b32 v27, 0xffff0000, v193
    v_lshlrev_b32 v28, 16, v194
    v_and_b32 v29, 0xffff0000, v194
    s_add_u32 m0, s57, 139264
    v_lshlrev_b32 v30, 16, v195
    buffer_load_dwordx4 v3, s[40:43], s53 offen lds
    v_and_b32 v31, 0xffff0000, v195
    v_fma_f32 v24, v24, v14, v10
    v_fma_f32 v25, v25, v14, v10
    v_fma_f32 v26, v26, v14, v10
    v_fma_f32 v27, v27, v14, v10
    v_fma_f32 v28, v28, v14, v10
    v_fma_f32 v29, v29, v14, v10
    s_add_u32 m0, s57, 140288
    v_fma_f32 v30, v30, v14, v10
    buffer_load_dwordx4 v7, s[40:43], s54 offen lds
    v_fma_f32 v31, v31, v14, v10
    v_cvt_pk_bf16_f32 v192, v24, v25
    v_cvt_pk_bf16_f32 v193, v26, v27
    v_cvt_pk_bf16_f32 v194, v28, v29
    v_cvt_pk_bf16_f32 v195, v30, v31
    ds_write_b128 v5, v[192:195] offset:2048
    v_lshlrev_b32 v32, 16, v232
    s_add_u32 m0, s57, 147456
    v_and_b32 v33, 0xffff0000, v232
    buffer_load_dwordx4 v4, s[44:47], s55 offen lds
    v_lshlrev_b32 v34, 16, v233
    v_and_b32 v35, 0xffff0000, v233
    v_lshlrev_b32 v36, 16, v234
    v_and_b32 v37, 0xffff0000, v234
    v_lshlrev_b32 v38, 16, v235
    v_and_b32 v39, 0xffff0000, v235
    v_fma_f32 v32, v32, v15, v11
    s_add_u32 m0, s57, 148480
    v_fma_f32 v33, v33, v15, v11
    buffer_load_dwordx4 v18, s[44:47], s56 offen lds
    v_fma_f32 v34, v34, v15, v11
    v_fma_f32 v35, v35, v15, v11
    v_fma_f32 v36, v36, v15, v11
    v_fma_f32 v37, v37, v15, v11
    v_fma_f32 v38, v38, v15, v11
    v_fma_f32 v39, v39, v15, v11
    v_cvt_pk_bf16_f32 v232, v32, v33
    v_cvt_pk_bf16_f32 v233, v34, v35
    v_cvt_pk_bf16_f32 v234, v36, v37
    v_cvt_pk_bf16_f32 v235, v38, v39
    ds_write_b128 v6, v[232:235] offset:2048
    s_add_u32 s53, s53, s65
    s_add_u32 s54, s54, s65
    s_add_u32 s55, s55, 245760
    s_add_u32 s56, s56, 245760
    s_waitcnt vmcnt(10) lgkmcnt(0)
    s_barrier
    s_add_u32 m0, s57, 32768
    v_lshlrev_b32 v24, 16, v116
    buffer_load_dwordx4 v3, s[28:31], s53 offen lds
    v_and_b32 v25, 0xffff0000, v116
    v_lshlrev_b32 v26, 16, v117
    v_and_b32 v27, 0xffff0000, v117
    v_lshlrev_b32 v28, 16, v118
    v_and_b32 v29, 0xffff0000, v118
    v_lshlrev_b32 v30, 16, v119
    v_and_b32 v31, 0xffff0000, v119
    s_add_u32 m0, s57, 33792
    v_fma_f32 v24, v24, v12, v8
    buffer_load_dwordx4 v7, s[28:31], s54 offen lds
    v_fma_f32 v25, v25, v12, v8
    v_fma_f32 v26, v26, v12, v8
    v_fma_f32 v27, v27, v12, v8
    v_fma_f32 v28, v28, v12, v8
    v_fma_f32 v29, v29, v12, v8
    v_fma_f32 v30, v30, v12, v8
    v_fma_f32 v31, v31, v12, v8
    s_add_u32 m0, s57, 40960
    v_cvt_pk_bf16_f32 v116, v24, v25
    buffer_load_dwordx4 v3, s[32:35], s53 offen lds
    v_cvt_pk_bf16_f32 v117, v26, v27
    v_cvt_pk_bf16_f32 v118, v28, v29
    v_cvt_pk_bf16_f32 v119, v30, v31
    ds_write_b128 v5, v[116:119] offset:16384
    v_lshlrev_b32 v32, 16, v156
    v_and_b32 v33, 0xffff0000, v156
    v_lshlrev_b32 v34, 16, v157
    s_add_u32 m0, s57, 41984
    v_and_b32 v35, 0xffff0000, v157
    buffer_load_dwordx4 v7, s[32:35], s54 offen lds
    v_lshlrev_b32 v36, 16, v158
    v_and_b32 v37, 0xffff0000, v158
    v_lshlrev_b32 v38, 16, v159
    v_and_b32 v39, 0xffff0000, v159
    v_fma_f32 v32, v32, v13, v9
    v_fma_f32 v33, v33, v13, v9
    v_fma_f32 v34, v34, v13, v9
    s_add_u32 m0, s57, 49152
    v_fma_f32 v35, v35, v13, v9
    buffer_load_dwordx4 v3, s[36:39], s53 offen lds
    v_fma_f32 v36, v36, v13, v9
    v_fma_f32 v37, v37, v13, v9
    v_fma_f32 v38, v38, v13, v9
    v_fma_f32 v39, v39, v13, v9
    v_cvt_pk_bf16_f32 v156, v32, v33
    v_cvt_pk_bf16_f32 v157, v34, v35
    v_cvt_pk_bf16_f32 v158, v36, v37
    s_add_u32 m0, s57, 50176
    v_cvt_pk_bf16_f32 v159, v38, v39
    buffer_load_dwordx4 v7, s[36:39], s54 offen lds
    ds_write_b128 v6, v[156:159] offset:16384
    v_lshlrev_b32 v24, 16, v196
    v_and_b32 v25, 0xffff0000, v196
    v_lshlrev_b32 v26, 16, v197
    v_and_b32 v27, 0xffff0000, v197
    v_lshlrev_b32 v28, 16, v198
    v_and_b32 v29, 0xffff0000, v198
    s_add_u32 m0, s57, 57344
    v_lshlrev_b32 v30, 16, v199
    buffer_load_dwordx4 v3, s[40:43], s53 offen lds
    v_and_b32 v31, 0xffff0000, v199
    v_fma_f32 v24, v24, v14, v10
    v_fma_f32 v25, v25, v14, v10
    v_fma_f32 v26, v26, v14, v10
    v_fma_f32 v27, v27, v14, v10
    v_fma_f32 v28, v28, v14, v10
    v_fma_f32 v29, v29, v14, v10
    s_add_u32 m0, s57, 58368
    v_fma_f32 v30, v30, v14, v10
    buffer_load_dwordx4 v7, s[40:43], s54 offen lds
    v_fma_f32 v31, v31, v14, v10
    v_cvt_pk_bf16_f32 v196, v24, v25
    v_cvt_pk_bf16_f32 v197, v26, v27
    v_cvt_pk_bf16_f32 v198, v28, v29
    v_cvt_pk_bf16_f32 v199, v30, v31
    ds_write_b128 v5, v[196:199] offset:18432
    v_lshlrev_b32 v32, 16, v236
    s_add_u32 m0, s57, 65536
    v_and_b32 v33, 0xffff0000, v236
    buffer_load_dwordx4 v4, s[44:47], s55 offen lds
    v_lshlrev_b32 v34, 16, v237
    v_and_b32 v35, 0xffff0000, v237
    v_lshlrev_b32 v36, 16, v238
    v_and_b32 v37, 0xffff0000, v238
    v_lshlrev_b32 v38, 16, v239
    v_and_b32 v39, 0xffff0000, v239
    v_fma_f32 v32, v32, v15, v11
    s_add_u32 m0, s57, 66560
    v_fma_f32 v33, v33, v15, v11
    buffer_load_dwordx4 v18, s[44:47], s56 offen lds
    v_fma_f32 v34, v34, v15, v11
    v_fma_f32 v35, v35, v15, v11
    v_fma_f32 v36, v36, v15, v11
    v_fma_f32 v37, v37, v15, v11
    v_fma_f32 v38, v38, v15, v11
    v_fma_f32 v39, v39, v15, v11
    v_cvt_pk_bf16_f32 v236, v32, v33
    v_cvt_pk_bf16_f32 v237, v34, v35
    v_cvt_pk_bf16_f32 v238, v36, v37
    v_cvt_pk_bf16_f32 v239, v38, v39
    ds_write_b128 v6, v[236:239] offset:18432
    s_add_u32 s53, s53, s65
    s_add_u32 s54, s54, s65
    s_add_u32 s55, s55, 245760
    s_add_u32 s56, s56, 245760
    s_waitcnt vmcnt(10) lgkmcnt(0)
    s_barrier
    s_add_u32 m0, s57, 73728
    v_lshlrev_b32 v24, 16, v120
    buffer_load_dwordx4 v3, s[28:31], s53 offen lds
    v_and_b32 v25, 0xffff0000, v120
    v_lshlrev_b32 v26, 16, v121
    v_and_b32 v27, 0xffff0000, v121
    v_lshlrev_b32 v28, 16, v122
    v_and_b32 v29, 0xffff0000, v122
    v_lshlrev_b32 v30, 16, v123
    v_and_b32 v31, 0xffff0000, v123
    s_add_u32 m0, s57, 74752
    v_fma_f32 v24, v24, v12, v8
    buffer_load_dwordx4 v7, s[28:31], s54 offen lds
    v_fma_f32 v25, v25, v12, v8
    v_fma_f32 v26, v26, v12, v8
    v_fma_f32 v27, v27, v12, v8
    v_fma_f32 v28, v28, v12, v8
    v_fma_f32 v29, v29, v12, v8
    v_fma_f32 v30, v30, v12, v8
    v_fma_f32 v31, v31, v12, v8
    s_add_u32 m0, s57, 81920
    v_cvt_pk_bf16_f32 v120, v24, v25
    buffer_load_dwordx4 v3, s[32:35], s53 offen lds
    v_cvt_pk_bf16_f32 v121, v26, v27
    v_cvt_pk_bf16_f32 v122, v28, v29
    v_cvt_pk_bf16_f32 v123, v30, v31
    ds_write_b128 v5, v[120:123] offset:0
    v_lshlrev_b32 v32, 16, v160
    v_and_b32 v33, 0xffff0000, v160
    v_lshlrev_b32 v34, 16, v161
    s_add_u32 m0, s57, 82944
    v_and_b32 v35, 0xffff0000, v161
    buffer_load_dwordx4 v7, s[32:35], s54 offen lds
    v_lshlrev_b32 v36, 16, v162
    v_and_b32 v37, 0xffff0000, v162
    v_lshlrev_b32 v38, 16, v163
    v_and_b32 v39, 0xffff0000, v163
    v_fma_f32 v32, v32, v13, v9
    v_fma_f32 v33, v33, v13, v9
    v_fma_f32 v34, v34, v13, v9
    s_add_u32 m0, s57, 90112
    v_fma_f32 v35, v35, v13, v9
    buffer_load_dwordx4 v3, s[36:39], s53 offen lds
    v_fma_f32 v36, v36, v13, v9
    v_fma_f32 v37, v37, v13, v9
    v_fma_f32 v38, v38, v13, v9
    v_fma_f32 v39, v39, v13, v9
    v_cvt_pk_bf16_f32 v160, v32, v33
    v_cvt_pk_bf16_f32 v161, v34, v35
    v_cvt_pk_bf16_f32 v162, v36, v37
    s_add_u32 m0, s57, 91136
    v_cvt_pk_bf16_f32 v163, v38, v39
    buffer_load_dwordx4 v7, s[36:39], s54 offen lds
    ds_write_b128 v6, v[160:163] offset:0
    v_lshlrev_b32 v24, 16, v200
    v_and_b32 v25, 0xffff0000, v200
    v_lshlrev_b32 v26, 16, v201
    v_and_b32 v27, 0xffff0000, v201
    v_lshlrev_b32 v28, 16, v202
    v_and_b32 v29, 0xffff0000, v202
    s_add_u32 m0, s57, 98304
    v_lshlrev_b32 v30, 16, v203
    buffer_load_dwordx4 v3, s[40:43], s53 offen lds
    v_and_b32 v31, 0xffff0000, v203
    v_fma_f32 v24, v24, v14, v10
    v_fma_f32 v25, v25, v14, v10
    v_fma_f32 v26, v26, v14, v10
    v_fma_f32 v27, v27, v14, v10
    v_fma_f32 v28, v28, v14, v10
    v_fma_f32 v29, v29, v14, v10
    s_add_u32 m0, s57, 99328
    v_fma_f32 v30, v30, v14, v10
    buffer_load_dwordx4 v7, s[40:43], s54 offen lds
    v_fma_f32 v31, v31, v14, v10
    v_cvt_pk_bf16_f32 v200, v24, v25
    v_cvt_pk_bf16_f32 v201, v26, v27
    v_cvt_pk_bf16_f32 v202, v28, v29
    v_cvt_pk_bf16_f32 v203, v30, v31
    ds_write_b128 v5, v[200:203] offset:2048
    v_lshlrev_b32 v32, 16, v240
    s_add_u32 m0, s57, 106496
    v_and_b32 v33, 0xffff0000, v240
    buffer_load_dwordx4 v4, s[44:47], s55 offen lds
    v_lshlrev_b32 v34, 16, v241
    v_and_b32 v35, 0xffff0000, v241
    v_lshlrev_b32 v36, 16, v242
    v_and_b32 v37, 0xffff0000, v242
    v_lshlrev_b32 v38, 16, v243
    v_and_b32 v39, 0xffff0000, v243
    v_fma_f32 v32, v32, v15, v11
    s_add_u32 m0, s57, 107520
    v_fma_f32 v33, v33, v15, v11
    buffer_load_dwordx4 v18, s[44:47], s56 offen lds
    v_fma_f32 v34, v34, v15, v11
    v_fma_f32 v35, v35, v15, v11
    v_fma_f32 v36, v36, v15, v11
    v_fma_f32 v37, v37, v15, v11
    v_fma_f32 v38, v38, v15, v11
    v_fma_f32 v39, v39, v15, v11
    v_cvt_pk_bf16_f32 v240, v32, v33
    v_cvt_pk_bf16_f32 v241, v34, v35
    v_cvt_pk_bf16_f32 v242, v36, v37
    v_cvt_pk_bf16_f32 v243, v38, v39
    ds_write_b128 v6, v[240:243] offset:2048
    s_add_u32 s53, s53, s65
    s_add_u32 s54, s54, s65
    s_add_u32 s55, s55, 245760
    s_add_u32 s56, s56, 245760
    s_waitcnt vmcnt(10) lgkmcnt(0)
    s_barrier
    s_add_u32 m0, s57, 114688
    v_lshlrev_b32 v24, 16, v124
    buffer_load_dwordx4 v3, s[28:31], s53 offen lds
    v_and_b32 v25, 0xffff0000, v124
    v_lshlrev_b32 v26, 16, v125
    v_and_b32 v27, 0xffff0000, v125
    v_lshlrev_b32 v28, 16, v126
    v_and_b32 v29, 0xffff0000, v126
    v_lshlrev_b32 v30, 16, v127
    v_and_b32 v31, 0xffff0000, v127
    s_add_u32 m0, s57, 115712
    v_fma_f32 v24, v24, v12, v8
    buffer_load_dwordx4 v7, s[28:31], s54 offen lds
    v_fma_f32 v25, v25, v12, v8
    v_fma_f32 v26, v26, v12, v8
    v_fma_f32 v27, v27, v12, v8
    v_fma_f32 v28, v28, v12, v8
    v_fma_f32 v29, v29, v12, v8
    v_fma_f32 v30, v30, v12, v8
    v_fma_f32 v31, v31, v12, v8
    s_add_u32 m0, s57, 122880
    v_cvt_pk_bf16_f32 v124, v24, v25
    buffer_load_dwordx4 v3, s[32:35], s53 offen lds
    v_cvt_pk_bf16_f32 v125, v26, v27
    v_cvt_pk_bf16_f32 v126, v28, v29
    v_cvt_pk_bf16_f32 v127, v30, v31
    ds_write_b128 v5, v[124:127] offset:16384
    v_lshlrev_b32 v32, 16, v164
    v_and_b32 v33, 0xffff0000, v164
    v_lshlrev_b32 v34, 16, v165
    s_add_u32 m0, s57, 123904
    v_and_b32 v35, 0xffff0000, v165
    buffer_load_dwordx4 v7, s[32:35], s54 offen lds
    v_lshlrev_b32 v36, 16, v166
    v_and_b32 v37, 0xffff0000, v166
    v_lshlrev_b32 v38, 16, v167
    v_and_b32 v39, 0xffff0000, v167
    v_fma_f32 v32, v32, v13, v9
    v_fma_f32 v33, v33, v13, v9
    v_fma_f32 v34, v34, v13, v9
    s_add_u32 m0, s57, 131072
    v_fma_f32 v35, v35, v13, v9
    buffer_load_dwordx4 v3, s[36:39], s53 offen lds
    v_fma_f32 v36, v36, v13, v9
    v_fma_f32 v37, v37, v13, v9
    v_fma_f32 v38, v38, v13, v9
    v_fma_f32 v39, v39, v13, v9
    v_cvt_pk_bf16_f32 v164, v32, v33
    v_cvt_pk_bf16_f32 v165, v34, v35
    v_cvt_pk_bf16_f32 v166, v36, v37
    s_add_u32 m0, s57, 132096
    v_cvt_pk_bf16_f32 v167, v38, v39
    buffer_load_dwordx4 v7, s[36:39], s54 offen lds
    ds_write_b128 v6, v[164:167] offset:16384
    v_lshlrev_b32 v24, 16, v204
    v_and_b32 v25, 0xffff0000, v204
    v_lshlrev_b32 v26, 16, v205
    v_and_b32 v27, 0xffff0000, v205
    v_lshlrev_b32 v28, 16, v206
    v_and_b32 v29, 0xffff0000, v206
    s_add_u32 m0, s57, 139264
    v_lshlrev_b32 v30, 16, v207
    buffer_load_dwordx4 v3, s[40:43], s53 offen lds
    v_and_b32 v31, 0xffff0000, v207
    v_fma_f32 v24, v24, v14, v10
    v_fma_f32 v25, v25, v14, v10
    v_fma_f32 v26, v26, v14, v10
    v_fma_f32 v27, v27, v14, v10
    v_fma_f32 v28, v28, v14, v10
    v_fma_f32 v29, v29, v14, v10
    s_add_u32 m0, s57, 140288
    v_fma_f32 v30, v30, v14, v10
    buffer_load_dwordx4 v7, s[40:43], s54 offen lds
    v_fma_f32 v31, v31, v14, v10
    v_cvt_pk_bf16_f32 v204, v24, v25
    v_cvt_pk_bf16_f32 v205, v26, v27
    v_cvt_pk_bf16_f32 v206, v28, v29
    v_cvt_pk_bf16_f32 v207, v30, v31
    ds_write_b128 v5, v[204:207] offset:18432
    v_lshlrev_b32 v32, 16, v244
    s_add_u32 m0, s57, 147456
    v_and_b32 v33, 0xffff0000, v244
    buffer_load_dwordx4 v4, s[44:47], s55 offen lds
    v_lshlrev_b32 v34, 16, v245
    v_and_b32 v35, 0xffff0000, v245
    v_lshlrev_b32 v36, 16, v246
    v_and_b32 v37, 0xffff0000, v246
    v_lshlrev_b32 v38, 16, v247
    v_and_b32 v39, 0xffff0000, v247
    v_fma_f32 v32, v32, v15, v11
    s_add_u32 m0, s57, 148480
    v_fma_f32 v33, v33, v15, v11
    buffer_load_dwordx4 v18, s[44:47], s56 offen lds
    v_fma_f32 v34, v34, v15, v11
    v_fma_f32 v35, v35, v15, v11
    v_fma_f32 v36, v36, v15, v11
    v_fma_f32 v37, v37, v15, v11
    v_fma_f32 v38, v38, v15, v11
    v_fma_f32 v39, v39, v15, v11
    v_cvt_pk_bf16_f32 v244, v32, v33
    v_cvt_pk_bf16_f32 v245, v34, v35
    v_cvt_pk_bf16_f32 v246, v36, v37
    v_cvt_pk_bf16_f32 v247, v38, v39
    ds_write_b128 v6, v[244:247] offset:18432
    s_add_u32 s53, s53, s65
    s_add_u32 s54, s54, s65
    s_add_u32 s55, s55, 245760
    s_add_u32 s56, s56, 245760
    s_waitcnt vmcnt(10) lgkmcnt(0)
    s_barrier
    s_add_u32 m0, s57, 32768
    v_lshlrev_b32 v24, 16, v128
    buffer_load_dwordx4 v3, s[28:31], s53 offen lds
    v_and_b32 v25, 0xffff0000, v128
    v_lshlrev_b32 v26, 16, v129
    v_and_b32 v27, 0xffff0000, v129
    v_lshlrev_b32 v28, 16, v130
    v_and_b32 v29, 0xffff0000, v130
    v_lshlrev_b32 v30, 16, v131
    v_and_b32 v31, 0xffff0000, v131
    s_add_u32 m0, s57, 33792
    v_fma_f32 v24, v24, v12, v8
    buffer_load_dwordx4 v7, s[28:31], s54 offen lds
    v_fma_f32 v25, v25, v12, v8
    v_fma_f32 v26, v26, v12, v8
    v_fma_f32 v27, v27, v12, v8
    v_fma_f32 v28, v28, v12, v8
    v_fma_f32 v29, v29, v12, v8
    v_fma_f32 v30, v30, v12, v8
    v_fma_f32 v31, v31, v12, v8
    s_add_u32 m0, s57, 40960
    v_cvt_pk_bf16_f32 v128, v24, v25
    buffer_load_dwordx4 v3, s[32:35], s53 offen lds
    v_cvt_pk_bf16_f32 v129, v26, v27
    v_cvt_pk_bf16_f32 v130, v28, v29
    v_cvt_pk_bf16_f32 v131, v30, v31
    ds_write_b128 v5, v[128:131] offset:0
    v_lshlrev_b32 v32, 16, v168
    v_and_b32 v33, 0xffff0000, v168
    v_lshlrev_b32 v34, 16, v169
    s_add_u32 m0, s57, 41984
    v_and_b32 v35, 0xffff0000, v169
    buffer_load_dwordx4 v7, s[32:35], s54 offen lds
    v_lshlrev_b32 v36, 16, v170
    v_and_b32 v37, 0xffff0000, v170
    v_lshlrev_b32 v38, 16, v171
    v_and_b32 v39, 0xffff0000, v171
    v_fma_f32 v32, v32, v13, v9
    v_fma_f32 v33, v33, v13, v9
    v_fma_f32 v34, v34, v13, v9
    s_add_u32 m0, s57, 49152
    v_fma_f32 v35, v35, v13, v9
    buffer_load_dwordx4 v3, s[36:39], s53 offen lds
    v_fma_f32 v36, v36, v13, v9
    v_fma_f32 v37, v37, v13, v9
    v_fma_f32 v38, v38, v13, v9
    v_fma_f32 v39, v39, v13, v9
    v_cvt_pk_bf16_f32 v168, v32, v33
    v_cvt_pk_bf16_f32 v169, v34, v35
    v_cvt_pk_bf16_f32 v170, v36, v37
    s_add_u32 m0, s57, 50176
    v_cvt_pk_bf16_f32 v171, v38, v39
    buffer_load_dwordx4 v7, s[36:39], s54 offen lds
    ds_write_b128 v6, v[168:171] offset:0
    v_lshlrev_b32 v24, 16, v208
    v_and_b32 v25, 0xffff0000, v208
    v_lshlrev_b32 v26, 16, v209
    v_and_b32 v27, 0xffff0000, v209
    v_lshlrev_b32 v28, 16, v210
    v_and_b32 v29, 0xffff0000, v210
    s_add_u32 m0, s57, 57344
    v_lshlrev_b32 v30, 16, v211
    buffer_load_dwordx4 v3, s[40:43], s53 offen lds
    v_and_b32 v31, 0xffff0000, v211
    v_fma_f32 v24, v24, v14, v10
    v_fma_f32 v25, v25, v14, v10
    v_fma_f32 v26, v26, v14, v10
    v_fma_f32 v27, v27, v14, v10
    v_fma_f32 v28, v28, v14, v10
    v_fma_f32 v29, v29, v14, v10
    s_add_u32 m0, s57, 58368
    v_fma_f32 v30, v30, v14, v10
    buffer_load_dwordx4 v7, s[40:43], s54 offen lds
    v_fma_f32 v31, v31, v14, v10
    v_cvt_pk_bf16_f32 v208, v24, v25
    v_cvt_pk_bf16_f32 v209, v26, v27
    v_cvt_pk_bf16_f32 v210, v28, v29
    v_cvt_pk_bf16_f32 v211, v30, v31
    ds_write_b128 v5, v[208:211] offset:2048
    v_lshlrev_b32 v32, 16, v248
    s_add_u32 m0, s57, 65536
    v_and_b32 v33, 0xffff0000, v248
    buffer_load_dwordx4 v4, s[44:47], s55 offen lds
    v_lshlrev_b32 v34, 16, v249
    v_and_b32 v35, 0xffff0000, v249
    v_lshlrev_b32 v36, 16, v250
    v_and_b32 v37, 0xffff0000, v250
    v_lshlrev_b32 v38, 16, v251
    v_and_b32 v39, 0xffff0000, v251
    v_fma_f32 v32, v32, v15, v11
    s_add_u32 m0, s57, 66560
    v_fma_f32 v33, v33, v15, v11
    buffer_load_dwordx4 v18, s[44:47], s56 offen lds
    v_fma_f32 v34, v34, v15, v11
    v_fma_f32 v35, v35, v15, v11
    v_fma_f32 v36, v36, v15, v11
    v_fma_f32 v37, v37, v15, v11
    v_fma_f32 v38, v38, v15, v11
    v_fma_f32 v39, v39, v15, v11
    v_cvt_pk_bf16_f32 v248, v32, v33
    v_cvt_pk_bf16_f32 v249, v34, v35
    v_cvt_pk_bf16_f32 v250, v36, v37
    v_cvt_pk_bf16_f32 v251, v38, v39
    ds_write_b128 v6, v[248:251] offset:2048
    s_add_u32 s53, s53, s65
    s_add_u32 s54, s54, s65
    s_add_u32 s55, s55, 245760
    s_add_u32 s56, s56, 245760
    s_waitcnt vmcnt(10) lgkmcnt(0)
    s_barrier
    v_lshlrev_b32 v24, 16, v132
    v_and_b32 v25, 0xffff0000, v132
    v_lshlrev_b32 v26, 16, v133
    v_and_b32 v27, 0xffff0000, v133
    v_lshlrev_b32 v28, 16, v134
    v_and_b32 v29, 0xffff0000, v134
    v_lshlrev_b32 v30, 16, v135
    v_and_b32 v31, 0xffff0000, v135
    v_fma_f32 v24, v24, v12, v8
    v_fma_f32 v25, v25, v12, v8
    v_fma_f32 v26, v26, v12, v8
    v_fma_f32 v27, v27, v12, v8
    v_fma_f32 v28, v28, v12, v8
    v_fma_f32 v29, v29, v12, v8
    v_fma_f32 v30, v30, v12, v8
    v_fma_f32 v31, v31, v12, v8
    v_cvt_pk_bf16_f32 v132, v24, v25
    v_cvt_pk_bf16_f32 v133, v26, v27
    v_cvt_pk_bf16_f32 v134, v28, v29
    v_cvt_pk_bf16_f32 v135, v30, v31
    ds_write_b128 v5, v[132:135] offset:16384
    v_lshlrev_b32 v32, 16, v172
    v_and_b32 v33, 0xffff0000, v172
    v_lshlrev_b32 v34, 16, v173
    v_and_b32 v35, 0xffff0000, v173
    v_lshlrev_b32 v36, 16, v174
    v_and_b32 v37, 0xffff0000, v174
    v_lshlrev_b32 v38, 16, v175
    v_and_b32 v39, 0xffff0000, v175
    v_fma_f32 v32, v32, v13, v9
    v_fma_f32 v33, v33, v13, v9
    v_fma_f32 v34, v34, v13, v9
    v_fma_f32 v35, v35, v13, v9
    v_fma_f32 v36, v36, v13, v9
    v_fma_f32 v37, v37, v13, v9
    v_fma_f32 v38, v38, v13, v9
    v_fma_f32 v39, v39, v13, v9
    v_cvt_pk_bf16_f32 v172, v32, v33
    v_cvt_pk_bf16_f32 v173, v34, v35
    v_cvt_pk_bf16_f32 v174, v36, v37
    v_cvt_pk_bf16_f32 v175, v38, v39
    ds_write_b128 v6, v[172:175] offset:16384
    v_lshlrev_b32 v24, 16, v212
    v_and_b32 v25, 0xffff0000, v212
    v_lshlrev_b32 v26, 16, v213
    v_and_b32 v27, 0xffff0000, v213
    v_lshlrev_b32 v28, 16, v214
    v_and_b32 v29, 0xffff0000, v214
    v_lshlrev_b32 v30, 16, v215
    v_and_b32 v31, 0xffff0000, v215
    v_fma_f32 v24, v24, v14, v10
    v_fma_f32 v25, v25, v14, v10
    v_fma_f32 v26, v26, v14, v10
    v_fma_f32 v27, v27, v14, v10
    v_fma_f32 v28, v28, v14, v10
    v_fma_f32 v29, v29, v14, v10
    v_fma_f32 v30, v30, v14, v10
    v_fma_f32 v31, v31, v14, v10
    v_cvt_pk_bf16_f32 v212, v24, v25
    v_cvt_pk_bf16_f32 v213, v26, v27
    v_cvt_pk_bf16_f32 v214, v28, v29
    v_cvt_pk_bf16_f32 v215, v30, v31
    ds_write_b128 v5, v[212:215] offset:18432
    v_lshlrev_b32 v32, 16, v252
    v_and_b32 v33, 0xffff0000, v252
    v_lshlrev_b32 v34, 16, v253
    v_and_b32 v35, 0xffff0000, v253
    v_lshlrev_b32 v36, 16, v254
    v_and_b32 v37, 0xffff0000, v254
    v_lshlrev_b32 v38, 16, v255
    v_and_b32 v39, 0xffff0000, v255
    v_fma_f32 v32, v32, v15, v11
    v_fma_f32 v33, v33, v15, v11
    v_fma_f32 v34, v34, v15, v11
    v_fma_f32 v35, v35, v15, v11
    v_fma_f32 v36, v36, v15, v11
    v_fma_f32 v37, v37, v15, v11
    v_fma_f32 v38, v38, v15, v11
    v_fma_f32 v39, v39, v15, v11
    v_cvt_pk_bf16_f32 v252, v32, v33
    v_cvt_pk_bf16_f32 v253, v34, v35
    v_cvt_pk_bf16_f32 v254, v36, v37
    v_cvt_pk_bf16_f32 v255, v38, v39
    ds_write_b128 v6, v[252:255] offset:18432
    s_waitcnt vmcnt(0) lgkmcnt(0)
    s_barrier
    s_mov_b32 s24, s12
    s_and_b32 s25, s13, 0xffff
    s_mov_b32 s26, 25165824
    s_mov_b32 s27, 0x20000
    v_mov_b32 v40, -1
    v_mov_b32 v41, -1
    v_mov_b32 v42, -1
    v_mov_b32 v43, -1
    v_lshlrev_b32 v44, 4, v0
    s_mul_i32 s66, s16, 10
    s_add_u32 s66, s66, s14
    s_mul_hi_u32 s3, s66, 107374183
    s_mul_i32 s17, s3, 40
    s_sub_u32 s17, s66, s17
    s_lshl_b32 s67, s15, 2
    s_add_u32 s3, s3, s67
    s_mul_i32 s3, s3, 136
    s_add_u32 s3, s3, s17
    s_add_u32 s3, s3, 96
    s_lshl_b32 s3, s3, 10
    s_add_u32 s3, s3, 9437184
    buffer_store_dwordx4 v[40:43], v44, s[24:27], s3 offen sc1
    s_add_u32 s66, s66, 4
    s_mul_hi_u32 s3, s66, 107374183
    s_mul_i32 s17, s3, 40
    s_sub_u32 s17, s66, s17
    s_lshl_b32 s67, s15, 2
    s_add_u32 s3, s3, s67
    s_mul_i32 s3, s3, 136
    s_add_u32 s3, s3, s17
    s_add_u32 s3, s3, 96
    s_lshl_b32 s3, s3, 10
    s_add_u32 s3, s3, 9437184
    buffer_store_dwordx4 v[40:43], v44, s[24:27], s3 offen sc1
    s_add_u32 s66, s66, 4
    s_cmp_lt_u32 s14, 2
    s_cbranch_scc0 K1_NOSENT
    s_mul_hi_u32 s3, s66, 107374183
    s_mul_i32 s17, s3, 40
    s_sub_u32 s17, s66, s17
    s_lshl_b32 s67, s15, 2
    s_add_u32 s3, s3, s67
    s_mul_i32 s3, s3, 136
    s_add_u32 s3, s3, s17
    s_add_u32 s3, s3, 96
    s_lshl_b32 s3, s3, 10
    s_add_u32 s3, s3, 9437184
    buffer_store_dwordx4 v[40:43], v44, s[24:27], s3 offen sc1
    s_add_u32 s66, s66, 4
K1_NOSENT:
    v_lshlrev_b32 v46, 4, v0
    s_lshr_b32 s66, s2, 3
    s_and_b32 s66, s66, 31
    s_cmp_eq_u32 s14, 3
    s_cbranch_scc0 K1_NONPF
    s_getpc_b64 s[96:97]
K1NPF_PC:
    s_add_u32 s96, s96, k2_attn_kernel-K1NPF_PC
    s_addc_u32 s97, s97, 0
    s_and_b32 s97, s97, 0xffff
    s_mov_b32 s98, K2_END-k2_attn_kernel
    s_mov_b32 s99, 0x20000
    s_lshl_b32 s66, s66, 10
    buffer_load_dwordx4 v[48:51], v46, s[96:99], s66 offen
K1_NONPF:
    s_barrier
K1_END:
    s_endpgm
.globl k2_attn_kernel
.p2align 8
.type k2_attn_kernel,@function
k2_attn_kernel:
    s_cmp_ge_u32 s2, 256
    s_cbranch_scc1 K2_END
    s_load_dwordx2 s[4:5], s[0:1], 72
    v_lshrrev_b32 v1, 6, v0
    v_and_b32 v0, 63, v0
    s_nop 0
    v_readfirstlane_b32 s14, v1
    s_cmp_ge_u32 s14, 8
    s_cbranch_scc1 K2_DOWN
    s_and_b32 s3, s2, 7
    s_lshr_b32 s23, s2, 3
    s_lshl_b32 s15, s3, 2
    s_lshr_b32 s3, s23, 3
    s_add_u32 s15, s15, s3
    s_and_b32 s23, s23, 7
    s_lshl_b32 s16, s23, 3
    s_and_b32 s3, s14, 3
    s_lshl_b32 s3, s3, 1
    s_add_u32 s16, s16, s3
    s_lshr_b32 s17, s14, 2
    s_waitcnt lgkmcnt(0)
    s_mov_b32 s8, s4
    s_and_b32 s9, s5, 0xffff
    s_mov_b32 s10, 25165824
    s_mov_b32 s11, 0x20000
    s_mul_i32 s25, s15, 163840
    s_add_u32 s25, s25, 3145728
    s_lshl_b32 s26, s14, 10
    v_lshlrev_b32 v136, 4, v0
    s_add_u32 s20, s25, s26
    s_add_u32 s21, s20, 8192
    s_add_u32 s22, s20, 88064
    s_add_u32 s23, s21, 71680
    s_cmp_ge_u32 s14, 2
    s_cselect_b32 s21, s23, s21
    v_and_b32 v147, 31, v0
    v_lshrrev_b32 v138, 5, v0
    v_and_b32 v139, 15, v0
    v_lshlrev_b32 v139, 4, v139
    v_bfe_u32 v140, v0, 4, 1
    v_lshl_add_u32 v139, v140, 3, v139
    v_lshl_add_u32 v5, v138, 9, v139
    s_mul_i32 s28, s15, 64
    s_add_u32 s28, s28, s16
    s_mul_i32 s28, s28, 1280
    s_add_u32 s28, s28, 0
    s_add_u32 s23, s28, 1280
    s_mov_b32 s24, s20
    s_add_u32 m0, s26, 0
    s_add_u32 s20, s20, 10240
    buffer_load_dwordx4 v136, s[8:11], s24 offen lds
    s_mov_b32 s24, s21
    s_add_u32 m0, s26, 8192
    s_add_u32 s21, s21, 10240
    buffer_load_dwordx4 v136, s[8:11], s24 offen lds
    s_cmp_lt_u32 s14, 4
    s_cbranch_scc0 K2_D0
    s_mov_b32 s24, s22
    s_add_u32 m0, s26, 16384
    s_add_u32 s22, s22, 10240
    buffer_load_dwordx4 v136, s[8:11], s24 offen lds
K2_D0:
    buffer_load_dwordx2 v[8:9], v5, s[8:11], s28 offen
    buffer_load_dwordx2 v[10:11], v5, s[8:11], s28 offen offset:256
    buffer_load_dwordx2 v[16:17], v139, s[8:11], s28 offen offset:1024
    buffer_load_dwordx2 v[12:13], v5, s[8:11], s23 offen
    buffer_load_dwordx2 v[14:15], v5, s[8:11], s23 offen offset:256
    buffer_load_dwordx2 v[20:21], v139, s[8:11], s23 offen offset:1024
    s_mul_i32 s23, s17, 10240
    v_mov_b32 v140, v147
    v_cmp_lt_u32 vcc, 20, v147
    v_mul_u32_u24 v141, 320, v138
    v_mov_b32 v148, v5
    v_cndmask_b32 v140, v140, 0, vcc
    v_cmp_lt_u32 vcc, 27, v147
    v_add_u32 v5, s23, v5
    s_nop 0
    v_cndmask_b32 v140, v140, 4, vcc
    v_lshl_add_u32 v6, v140, 4, v141
    s_add_u32 s23, s23, 1280
    v_add_u32 v6, s23, v6
    v_cmp_eq_u32 vcc, 20, v147
    v_mov_b32 v7, 1
    v_mov_b32 v141, 61568
    v_cndmask_b32 v6, v6, v141, vcc
    v_cndmask_b32 v7, v7, 0, vcc
    v_mov_b32 v142, 0x3f803f80
    v_mov_b32 v143, 0x3f803f80
    v_mov_b32 v144, 0x3f803f80
    v_mov_b32 v145, 0x3f803f80
    v_lshrrev_b32 v146, 1, v0
    v_mul_u32_u24 v146, 2560, v146
    v_and_b32 v141, 1, v0
    v_mul_u32_u24 v141, 640, v141
    v_add_u32 v146, v146, v141
    v_add_u32 v146, 61568, v146
    s_mov_b64 exec, 0xff
    ds_write_b128 v146, v[142:145]
    s_mov_b64 exec, -1
    v_cmp_lt_u32 vcc, 20, v147
    v_mov_b32 v141, 61584
    s_nop 0
    v_cndmask_b32 v6, v6, v141, vcc
    v_cndmask_b32 v7, v7, 0, vcc
    v_cmp_lt_u32 vcc, 27, v147
    v_mov_b32 v141, 61632
    s_nop 0
    v_cndmask_b32 v6, v6, v141, vcc
    v_cmp_lt_u32 vcc, 59, v0
    v_mov_b32 v141, 61456
    s_nop 0
    v_cndmask_b32 v6, v6, v141, vcc
    v_mov_b32 v142, 0
    v_mov_b32 v143, 0
    v_mov_b32 v144, 0
    v_mov_b32 v145, 0
    v_and_b32 v141, 7, v0
    v_lshrrev_b32 v146, 1, v141
    v_mul_u32_u24 v146, 2560, v146
    v_and_b32 v141, 1, v141
    v_mul_u32_u24 v141, 640, v141
    v_add_u32 v146, v146, v141
    v_lshrrev_b32 v141, 3, v0
    v_mul_u32_u24 v140, 48, v141
    v_add_u32 v140, 144, v140
    v_cmp_eq_u32 vcc, 2, v141
    s_nop 1
    v_cndmask_b32 v140, v140, 16, vcc
    v_add_u32 v146, v146, v140
    v_add_u32 v146, 61440, v146
    s_mov_b64 exec, 0xffffff
    ds_write_b128 v146, v[142:145]
    s_mov_b64 exec, -1
    v_mov_b32 v30, 0x3f803f80
    v_mov_b32 v31, 0x00003f80
    v_mov_b32 v38, 0x3f803f80
    v_mov_b32 v39, 0x00003f80
    v_mov_b32 v104, 0
    v_mov_b32 v105, 0
    v_mov_b32 v106, 0
    v_mov_b32 v107, 0
    v_mov_b32 v108, 0
    v_mov_b32 v109, 0
    v_mov_b32 v110, 0
    v_mov_b32 v111, 0
    v_mov_b32 v112, 0
    v_mov_b32 v113, 0
    v_mov_b32 v114, 0
    v_mov_b32 v115, 0
    v_mov_b32 v116, 0
    v_mov_b32 v117, 0
    v_mov_b32 v118, 0
    v_mov_b32 v119, 0
    v_mov_b32 v120, 0
    v_mov_b32 v121, 0
    v_mov_b32 v122, 0
    v_mov_b32 v123, 0
    v_mov_b32 v124, 0
    v_mov_b32 v125, 0
    v_mov_b32 v126, 0
    v_mov_b32 v127, 0
    v_mov_b32 v128, 0
    v_mov_b32 v129, 0
    v_mov_b32 v130, 0
    v_mov_b32 v131, 0
    v_mov_b32 v132, 0
    v_mov_b32 v133, 0
    v_mov_b32 v134, 0
    v_mov_b32 v135, 0
    v_lshlrev_b32 v155, 3, v0
    s_lshl_b32 s23, s14, 9
    s_add_u32 s23, s23, 70656
    v_add_u32 v154, s23, v155
    s_xor_b32 s3, s14, 4
    s_lshl_b32 s3, s3, 9
    s_add_u32 s3, s3, 70656
    v_add_u32 v155, s3, v155
    v_mov_b32 v142, 0
    v_mov_b32 v143, 74752
    ds_write_b32 v143, v142
    s_waitcnt vmcnt(0)
    s_add_u32 s26, s26, 20480
    s_mov_b32 s24, s20
    s_add_u32 m0, s26, 0
    s_add_u32 s20, s20, 10240
    buffer_load_dwordx4 v136, s[8:11], s24 offen lds
    s_mov_b32 s24, s21
    s_add_u32 m0, s26, 8192
    s_add_u32 s21, s21, 10240
    buffer_load_dwordx4 v136, s[8:11], s24 offen lds
    s_cmp_lt_u32 s14, 4
    s_cbranch_scc0 K2_D1
    s_mov_b32 s24, s22
    s_add_u32 m0, s26, 16384
    s_add_u32 s22, s22, 10240
    buffer_load_dwordx4 v136, s[8:11], s24 offen lds
K2_D1:
    v_cmp_gt_u32 vcc, 32, v0
    v_mov_b32 v18, 0
    v_mov_b32 v19, 0
    v_cndmask_b32 v16, 0, v16, vcc
    v_cndmask_b32 v17, 0, v17, vcc
    v_mov_b32 v22, 0
    v_mov_b32 v23, 0
    v_cndmask_b32 v20, 0, v20, vcc
    v_cndmask_b32 v21, 0, v21, vcc
    s_waitcnt lgkmcnt(0)
    s_barrier
    ds_read_b64 v[24:25], v5 offset:0
    ds_read_b64 v[26:27], v5 offset:256
    ds_read_b64 v[28:29], v5 offset:1024
    ds_read_b64 v[32:33], v5 offset:2560
    ds_read_b64 v[34:35], v5 offset:2816
    ds_read_b64 v[36:37], v5 offset:3584
    v_mov_b32 v150, 0xff800000
    v_mov_b32 v151, 0xff800000
    s_waitcnt lgkmcnt(0)
    v_mfma_f32_32x32x16_bf16 v[72:87], v[24:27], v[8:11], 0
    v_mfma_f32_32x32x16_bf16 v[72:87], v[28:31], v[16:19], v[72:87]
    v_mfma_f32_32x32x16_bf16 v[88:103], v[24:27], v[12:15], 0
    v_mfma_f32_32x32x16_bf16 v[88:103], v[28:31], v[20:23], v[88:103]
    v_mfma_f32_32x32x16_bf16 v[56:71], v[32:35], v[8:11], 0
    v_mfma_f32_32x32x16_bf16 v[56:71], v[36:39], v[16:19], v[56:71]
    v_mfma_f32_32x32x16_bf16 v[40:55], v[32:35], v[12:15], 0
    v_mfma_f32_32x32x16_bf16 v[40:55], v[36:39], v[20:23], v[40:55]
    s_nop 7
    v_max3_f32 v150, v72, v73, v150
    v_max3_f32 v150, v74, v75, v150
    v_max3_f32 v150, v76, v77, v150
    v_max3_f32 v150, v78, v79, v150
    v_max3_f32 v150, v80, v81, v150
    v_max3_f32 v150, v82, v83, v150
    v_max3_f32 v150, v84, v85, v150
    v_max3_f32 v150, v86, v87, v150
    v_max3_f32 v151, v88, v89, v151
    v_max3_f32 v151, v90, v91, v151
    v_max3_f32 v151, v92, v93, v151
    v_max3_f32 v151, v94, v95, v151
    v_max3_f32 v151, v96, v97, v151
    v_max3_f32 v151, v98, v99, v151
    v_max3_f32 v151, v100, v101, v151
    v_max3_f32 v151, v102, v103, v151
    v_max3_f32 v150, v56, v57, v150
    v_max3_f32 v150, v58, v59, v150
    v_max3_f32 v150, v60, v61, v150
    v_max3_f32 v150, v62, v63, v150
    v_max3_f32 v150, v64, v65, v150
    v_max3_f32 v150, v66, v67, v150
    v_max3_f32 v150, v68, v69, v150
    v_max3_f32 v150, v70, v71, v150
    v_max3_f32 v151, v40, v41, v151
    v_max3_f32 v151, v42, v43, v151
    v_max3_f32 v151, v44, v45, v151
    v_max3_f32 v151, v46, v47, v151
    v_max3_f32 v151, v48, v49, v151
    v_max3_f32 v151, v50, v51, v151
    v_max3_f32 v151, v52, v53, v151
    v_max3_f32 v151, v54, v55, v151
    v_mov_b32 v138, v150
    v_mov_b32 v139, v151
    s_nop 1
    v_permlane32_swap_b32 v138, v150
    v_permlane32_swap_b32 v139, v151
    s_nop 1
    v_max_f32 v150, v150, v138
    v_max_f32 v151, v151, v139
    ds_write_b64 v154, v[150:151]
    s_waitcnt lgkmcnt(0)
    s_barrier
    ds_read_b64 v[142:143], v155
    v_mov_b32 v64, 0
    v_mov_b32 v65, 0
    v_mov_b32 v66, 0
    v_mov_b32 v67, 0
    v_mov_b32 v68, 0
    v_mov_b32 v69, 0
    v_mov_b32 v70, 0
    v_mov_b32 v71, 0
    v_mov_b32 v48, 0
    v_mov_b32 v49, 0
    v_mov_b32 v50, 0
    v_mov_b32 v51, 0
    v_mov_b32 v52, 0
    v_mov_b32 v53, 0
    v_mov_b32 v54, 0
    v_mov_b32 v55, 0
    s_waitcnt lgkmcnt(0)
    v_max_f32 v150, v150, v142
    v_max_f32 v151, v151, v143
    s_mov_b32 s23, 0xc2a00000
    v_sub_f32 v150, s23, v150
    v_sub_f32 v151, s23, v151
    v_cvt_pk_bf16_f32 v140, v150, v150
    v_cvt_pk_bf16_f32 v141, v151, v151
    v_and_b32 v142, 0xffff0000, v140
    v_and_b32 v143, 0xffff0000, v141
    v_sub_f32 v150, v150, v142
    v_sub_f32 v151, v151, v143
    v_cvt_pk_bf16_f32 v144, v150, v150
    v_cvt_pk_bf16_f32 v145, v151, v151
    v_and_b32 v146, 0xffff0000, v144
    v_and_b32 v147, 0xffff0000, v145
    v_sub_f32 v150, v150, v146
    v_sub_f32 v151, v151, v147
    v_cvt_pk_bf16_f32 v148, v150, v150
    v_cvt_pk_bf16_f32 v149, v151, v151
    v_cmp_gt_u32 vcc, 32, v0
    v_lshrrev_b32 v142, 16, v142
    v_lshrrev_b32 v143, 16, v143
    v_or_b32 v142, v142, v146
    v_or_b32 v143, v143, v147
    v_and_b32 v148, 0xffff, v148
    v_and_b32 v149, 0xffff, v149
    v_cndmask_b32 v18, 0, v142, vcc
    v_cndmask_b32 v19, 0, v148, vcc
    v_cndmask_b32 v22, 0, v143, vcc
    v_cndmask_b32 v23, 0, v149, vcc
    s_setprio 1
    v_mfma_f32_32x32x16_bf16 v[72:87], v[24:27], v[8:11], 0
    v_mfma_f32_32x32x16_bf16 v[72:87], v[28:31], v[16:19], v[72:87]
    v_mov_b32 v1, v5
    v_mov_b32 v2, v4
    v_mov_b32 v3, v6
    s_mov_b32 s29, 0
    s_mov_b32 s18, 61440
    s_mov_b32 s19, 0
    s_nop 7
    s_cmp_lt_u32 s14, 4
    s_cselect_b64 vcc, -1, 0
    s_lshl_b32 s26, s14, 10
    s_mov_b32 s30, 20480
    s_mov_b32 s31, 40960
    v_mfma_f32_32x32x16_bf16 v[88:103], v[24:27], v[12:15], 0
    ds_read_b128 v[40:43], v3 offset:0
    v_exp_f32 v72, v72
    v_exp_f32 v73, v73
    v_exp_f32 v74, v74
    v_exp_f32 v75, v75
    v_mfma_f32_32x32x16_bf16 v[88:103], v[28:31], v[20:23], v[88:103]
    ds_read_b128 v[44:47], v3 offset:640
    v_exp_f32 v76, v76
    v_exp_f32 v77, v77
    v_cvt_pk_bf16_f32 v56, v72, v73
    v_exp_f32 v78, v78
    v_exp_f32 v79, v79
    v_cvt_pk_bf16_f32 v57, v74, v75
    v_mfma_f32_32x32x16_bf16 v[120:135], v[48:51], v[64:67], v[120:135]
    v_exp_f32 v80, v80
    v_exp_f32 v81, v81
    v_cvt_pk_bf16_f32 v58, v76, v77
    v_exp_f32 v82, v82
    v_exp_f32 v83, v83
    v_cvt_pk_bf16_f32 v59, v78, v79
    v_mfma_f32_32x32x16_bf16 v[120:135], v[52:55], v[68:71], v[120:135]
    s_waitcnt lgkmcnt(0)
    v_exp_f32 v84, v84
    v_exp_f32 v85, v85
    v_cvt_pk_bf16_f32 v60, v80, v81
    v_exp_f32 v86, v86
    v_exp_f32 v87, v87
    v_cvt_pk_bf16_f32 v61, v82, v83
    v_cvt_pk_bf16_f32 v62, v84, v85
    v_cvt_pk_bf16_f32 v63, v86, v87
    v_mfma_f32_32x32x16_bf16 v[72:87], v[32:35], v[8:11], 0
    ds_read_b64 v[24:25], v5 offset:5120
    v_exp_f32 v88, v88
    v_exp_f32 v89, v89
    v_exp_f32 v90, v90
    v_exp_f32 v91, v91
    v_mfma_f32_32x32x16_bf16 v[72:87], v[36:39], v[16:19], v[72:87]
    ds_read_b64 v[26:27], v5 offset:5376
    v_exp_f32 v92, v92
    v_exp_f32 v93, v93
    v_cvt_pk_bf16_f32 v64, v88, v89
    v_exp_f32 v94, v94
    v_exp_f32 v95, v95
    v_cvt_pk_bf16_f32 v65, v90, v91
    v_mfma_f32_32x32x16_bf16 v[104:119], v[40:43], v[56:59], v[104:119]
    ds_read_b64 v[28:29], v5 offset:6144
    v_exp_f32 v96, v96
    v_exp_f32 v97, v97
    v_cvt_pk_bf16_f32 v66, v92, v93
    v_exp_f32 v98, v98
    v_exp_f32 v99, v99
    v_cvt_pk_bf16_f32 v67, v94, v95
    v_mfma_f32_32x32x16_bf16 v[104:119], v[44:47], v[60:63], v[104:119]
    v_exp_f32 v100, v100
    v_exp_f32 v101, v101
    v_cvt_pk_bf16_f32 v68, v96, v97
    v_exp_f32 v102, v102
    v_exp_f32 v103, v103
    v_cvt_pk_bf16_f32 v69, v98, v99
    v_cvt_pk_bf16_f32 v70, v100, v101
    v_cvt_pk_bf16_f32 v71, v102, v103
    v_mfma_f32_32x32x16_bf16 v[88:103], v[32:35], v[12:15], 0
    ds_read_b128 v[48:51], v3 offset:2560
    v_exp_f32 v72, v72
    v_exp_f32 v73, v73
    v_exp_f32 v74, v74
    v_exp_f32 v75, v75
    v_mfma_f32_32x32x16_bf16 v[88:103], v[36:39], v[20:23], v[88:103]
    ds_read_b128 v[52:55], v3 offset:3200
    v_exp_f32 v76, v76
    v_exp_f32 v77, v77
    v_cvt_pk_bf16_f32 v56, v72, v73
    v_exp_f32 v78, v78
    v_exp_f32 v79, v79
    v_cvt_pk_bf16_f32 v57, v74, v75
    v_mfma_f32_32x32x16_bf16 v[120:135], v[40:43], v[64:67], v[120:135]
    v_exp_f32 v80, v80
    v_exp_f32 v81, v81
    v_cvt_pk_bf16_f32 v58, v76, v77
    v_exp_f32 v82, v82
    v_exp_f32 v83, v83
    v_cvt_pk_bf16_f32 v59, v78, v79
    v_mfma_f32_32x32x16_bf16 v[120:135], v[44:47], v[68:71], v[120:135]
    s_waitcnt lgkmcnt(0)
    v_exp_f32 v84, v84
    v_exp_f32 v85, v85
    v_cvt_pk_bf16_f32 v60, v80, v81
    v_exp_f32 v86, v86
    v_exp_f32 v87, v87
    v_cvt_pk_bf16_f32 v61, v82, v83
    v_cvt_pk_bf16_f32 v62, v84, v85
    v_cvt_pk_bf16_f32 v63, v86, v87
    v_mfma_f32_32x32x16_bf16 v[72:87], v[24:27], v[8:11], 0
    ds_read_b64 v[32:33], v5 offset:7680
    v_exp_f32 v88, v88
    v_exp_f32 v89, v89
    v_exp_f32 v90, v90
    v_exp_f32 v91, v91
    v_mfma_f32_32x32x16_bf16 v[72:87], v[28:31], v[16:19], v[72:87]
    ds_read_b64 v[34:35], v5 offset:7936
    v_exp_f32 v92, v92
    v_exp_f32 v93, v93
    v_cvt_pk_bf16_f32 v64, v88, v89
    v_exp_f32 v94, v94
    v_exp_f32 v95, v95
    v_cvt_pk_bf16_f32 v65, v90, v91
    v_mfma_f32_32x32x16_bf16 v[104:119], v[48:51], v[56:59], v[104:119]
    ds_read_b64 v[36:37], v5 offset:8704
    v_exp_f32 v96, v96
    v_exp_f32 v97, v97
    v_cvt_pk_bf16_f32 v66, v92, v93
    v_exp_f32 v98, v98
    v_exp_f32 v99, v99
    v_cvt_pk_bf16_f32 v67, v94, v95
    v_mfma_f32_32x32x16_bf16 v[104:119], v[52:55], v[60:63], v[104:119]
    v_exp_f32 v100, v100
    v_exp_f32 v101, v101
    v_cvt_pk_bf16_f32 v68, v96, v97
    v_exp_f32 v102, v102
    v_exp_f32 v103, v103
    v_cvt_pk_bf16_f32 v69, v98, v99
    v_cvt_pk_bf16_f32 v70, v100, v101
    v_cvt_pk_bf16_f32 v71, v102, v103
    v_mfma_f32_32x32x16_bf16 v[88:103], v[24:27], v[12:15], 0
    ds_read_b128 v[40:43], v3 offset:5120
    v_exp_f32 v72, v72
    v_exp_f32 v73, v73
    v_exp_f32 v74, v74
    v_exp_f32 v75, v75
    v_mfma_f32_32x32x16_bf16 v[88:103], v[28:31], v[20:23], v[88:103]
    ds_read_b128 v[44:47], v3 offset:5760
    v_exp_f32 v76, v76
    v_exp_f32 v77, v77
    v_cvt_pk_bf16_f32 v56, v72, v73
    v_exp_f32 v78, v78
    v_exp_f32 v79, v79
    v_cvt_pk_bf16_f32 v57, v74, v75
    v_mfma_f32_32x32x16_bf16 v[120:135], v[48:51], v[64:67], v[120:135]
    v_exp_f32 v80, v80
    v_exp_f32 v81, v81
    v_cvt_pk_bf16_f32 v58, v76, v77
    v_exp_f32 v82, v82
    v_exp_f32 v83, v83
    v_cvt_pk_bf16_f32 v59, v78, v79
    v_mfma_f32_32x32x16_bf16 v[120:135], v[52:55], v[68:71], v[120:135]
    s_waitcnt vmcnt(0) lgkmcnt(0)
    s_barrier
    v_exp_f32 v84, v84
    v_exp_f32 v85, v85
    v_cvt_pk_bf16_f32 v60, v80, v81
    v_exp_f32 v86, v86
    v_exp_f32 v87, v87
    v_cvt_pk_bf16_f32 v61, v82, v83
    v_cvt_pk_bf16_f32 v62, v84, v85
    v_cvt_pk_bf16_f32 v63, v86, v87
    v_mfma_f32_32x32x16_bf16 v[72:87], v[32:35], v[8:11], 0
    ds_read_b64 v[24:25], v5 offset:20480
    v_exp_f32 v88, v88
    v_exp_f32 v89, v89
    v_exp_f32 v90, v90
    v_exp_f32 v91, v91
    v_mfma_f32_32x32x16_bf16 v[72:87], v[36:39], v[16:19], v[72:87]
    ds_read_b64 v[26:27], v5 offset:20736
    v_exp_f32 v92, v92
    v_exp_f32 v93, v93
    v_cvt_pk_bf16_f32 v64, v88, v89
    v_exp_f32 v94, v94
    v_exp_f32 v95, v95
    v_cvt_pk_bf16_f32 v65, v90, v91
    v_mfma_f32_32x32x16_bf16 v[104:119], v[40:43], v[56:59], v[104:119]
    ds_read_b64 v[28:29], v5 offset:21504
    s_add_u32 m0, s26, 40960
    v_exp_f32 v96, v96
    v_exp_f32 v97, v97
    v_cvt_pk_bf16_f32 v66, v92, v93
    v_exp_f32 v98, v98
    v_exp_f32 v99, v99
    v_cvt_pk_bf16_f32 v67, v94, v95
    v_mfma_f32_32x32x16_bf16 v[104:119], v[44:47], v[60:63], v[104:119]
    buffer_load_dwordx4 v136, s[8:11], s20 offen lds
    s_add_u32 s20, s20, 10240
    v_exp_f32 v100, v100
    v_exp_f32 v101, v101
    v_cvt_pk_bf16_f32 v68, v96, v97
    v_exp_f32 v102, v102
    v_exp_f32 v103, v103
    v_cvt_pk_bf16_f32 v69, v98, v99
    v_cvt_pk_bf16_f32 v70, v100, v101
    v_cvt_pk_bf16_f32 v71, v102, v103
    v_mfma_f32_32x32x16_bf16 v[88:103], v[32:35], v[12:15], 0
    ds_read_b128 v[48:51], v3 offset:7680
    v_exp_f32 v72, v72
    v_exp_f32 v73, v73
    v_exp_f32 v74, v74
    v_exp_f32 v75, v75
    v_mfma_f32_32x32x16_bf16 v[88:103], v[36:39], v[20:23], v[88:103]
    ds_read_b128 v[52:55], v3 offset:8320
    v_exp_f32 v76, v76
    v_exp_f32 v77, v77
    v_cvt_pk_bf16_f32 v56, v72, v73
    v_exp_f32 v78, v78
    v_exp_f32 v79, v79
    v_cvt_pk_bf16_f32 v57, v74, v75
    v_mfma_f32_32x32x16_bf16 v[120:135], v[40:43], v[64:67], v[120:135]
    s_add_u32 m0, s26, 49152
    v_exp_f32 v80, v80
    v_exp_f32 v81, v81
    v_cvt_pk_bf16_f32 v58, v76, v77
    v_exp_f32 v82, v82
    v_exp_f32 v83, v83
    v_cvt_pk_bf16_f32 v59, v78, v79
    v_mfma_f32_32x32x16_bf16 v[120:135], v[44:47], v[68:71], v[120:135]
    buffer_load_dwordx4 v136, s[8:11], s21 offen lds
    s_add_u32 s21, s21, 10240
    s_waitcnt lgkmcnt(0)
    v_exp_f32 v84, v84
    v_exp_f32 v85, v85
    v_cvt_pk_bf16_f32 v60, v80, v81
    v_exp_f32 v86, v86
    v_exp_f32 v87, v87
    v_cvt_pk_bf16_f32 v61, v82, v83
    v_cvt_pk_bf16_f32 v62, v84, v85
    v_cvt_pk_bf16_f32 v63, v86, v87
    v_mfma_f32_32x32x16_bf16 v[72:87], v[24:27], v[8:11], 0
    ds_read_b64 v[32:33], v5 offset:23040
    v_exp_f32 v88, v88
    v_exp_f32 v89, v89
    v_exp_f32 v90, v90
    v_exp_f32 v91, v91
    v_mfma_f32_32x32x16_bf16 v[72:87], v[28:31], v[16:19], v[72:87]
    ds_read_b64 v[34:35], v5 offset:23296
    v_exp_f32 v92, v92
    v_exp_f32 v93, v93
    v_cvt_pk_bf16_f32 v64, v88, v89
    v_exp_f32 v94, v94
    v_exp_f32 v95, v95
    v_cvt_pk_bf16_f32 v65, v90, v91
    v_mfma_f32_32x32x16_bf16 v[104:119], v[48:51], v[56:59], v[104:119]
    ds_read_b64 v[36:37], v5 offset:24064
    s_add_u32 m0, s26, 57344
    v_exp_f32 v96, v96
    v_exp_f32 v97, v97
    v_cvt_pk_bf16_f32 v66, v92, v93
    v_exp_f32 v98, v98
    v_exp_f32 v99, v99
    v_cvt_pk_bf16_f32 v67, v94, v95
    v_mfma_f32_32x32x16_bf16 v[104:119], v[52:55], v[60:63], v[104:119]
    s_cbranch_vccz K2_SK0
    buffer_load_dwordx4 v136, s[8:11], s22 offen lds
K2_SK0:
    s_add_u32 s22, s22, 10240
    v_exp_f32 v100, v100
    v_exp_f32 v101, v101
    v_cvt_pk_bf16_f32 v68, v96, v97
    v_exp_f32 v102, v102
    v_exp_f32 v103, v103
    v_cvt_pk_bf16_f32 v69, v98, v99
    v_cvt_pk_bf16_f32 v70, v100, v101
    v_cvt_pk_bf16_f32 v71, v102, v103
    v_mad_u32_u24 v3, v7, s30, v6
    v_mfma_f32_32x32x16_bf16 v[88:103], v[24:27], v[12:15], 0
    ds_read_b128 v[40:43], v3 offset:0
    v_exp_f32 v72, v72
    v_exp_f32 v73, v73
    v_exp_f32 v74, v74
    v_exp_f32 v75, v75
    v_mfma_f32_32x32x16_bf16 v[88:103], v[28:31], v[20:23], v[88:103]
    ds_read_b128 v[44:47], v3 offset:640
    v_exp_f32 v76, v76
    v_exp_f32 v77, v77
    v_cvt_pk_bf16_f32 v56, v72, v73
    v_exp_f32 v78, v78
    v_exp_f32 v79, v79
    v_cvt_pk_bf16_f32 v57, v74, v75
    v_mfma_f32_32x32x16_bf16 v[120:135], v[48:51], v[64:67], v[120:135]
    v_exp_f32 v80, v80
    v_exp_f32 v81, v81
    v_cvt_pk_bf16_f32 v58, v76, v77
    v_exp_f32 v82, v82
    v_exp_f32 v83, v83
    v_cvt_pk_bf16_f32 v59, v78, v79
    v_mfma_f32_32x32x16_bf16 v[120:135], v[52:55], v[68:71], v[120:135]
    s_waitcnt lgkmcnt(0)
    v_exp_f32 v84, v84
    v_exp_f32 v85, v85
    v_cvt_pk_bf16_f32 v60, v80, v81
    v_exp_f32 v86, v86
    v_exp_f32 v87, v87
    v_cvt_pk_bf16_f32 v61, v82, v83
    v_cvt_pk_bf16_f32 v62, v84, v85
    v_cvt_pk_bf16_f32 v63, v86, v87
    v_mfma_f32_32x32x16_bf16 v[72:87], v[32:35], v[8:11], 0
    ds_read_b64 v[24:25], v5 offset:25600
    v_exp_f32 v88, v88
    v_exp_f32 v89, v89
    v_exp_f32 v90, v90
    v_exp_f32 v91, v91
    v_mfma_f32_32x32x16_bf16 v[72:87], v[36:39], v[16:19], v[72:87]
    ds_read_b64 v[26:27], v5 offset:25856
    v_exp_f32 v92, v92
    v_exp_f32 v93, v93
    v_cvt_pk_bf16_f32 v64, v88, v89
    v_exp_f32 v94, v94
    v_exp_f32 v95, v95
    v_cvt_pk_bf16_f32 v65, v90, v91
    v_mfma_f32_32x32x16_bf16 v[104:119], v[40:43], v[56:59], v[104:119]
    ds_read_b64 v[28:29], v5 offset:26624
    v_exp_f32 v96, v96
    v_exp_f32 v97, v97
    v_cvt_pk_bf16_f32 v66, v92, v93
    v_exp_f32 v98, v98
    v_exp_f32 v99, v99
    v_cvt_pk_bf16_f32 v67, v94, v95
    v_mfma_f32_32x32x16_bf16 v[104:119], v[44:47], v[60:63], v[104:119]
    v_exp_f32 v100, v100
    v_exp_f32 v101, v101
    v_cvt_pk_bf16_f32 v68, v96, v97
    v_exp_f32 v102, v102
    v_exp_f32 v103, v103
    v_cvt_pk_bf16_f32 v69, v98, v99
    v_cvt_pk_bf16_f32 v70, v100, v101
    v_cvt_pk_bf16_f32 v71, v102, v103
    v_mfma_f32_32x32x16_bf16 v[88:103], v[32:35], v[12:15], 0
    ds_read_b128 v[48:51], v3 offset:2560
    v_exp_f32 v72, v72
    v_exp_f32 v73, v73
    v_exp_f32 v74, v74
    v_exp_f32 v75, v75
    v_mfma_f32_32x32x16_bf16 v[88:103], v[36:39], v[20:23], v[88:103]
    ds_read_b128 v[52:55], v3 offset:3200
    v_exp_f32 v76, v76
    v_exp_f32 v77, v77
    v_cvt_pk_bf16_f32 v56, v72, v73
    v_exp_f32 v78, v78
    v_exp_f32 v79, v79
    v_cvt_pk_bf16_f32 v57, v74, v75
    v_mfma_f32_32x32x16_bf16 v[120:135], v[40:43], v[64:67], v[120:135]
    v_exp_f32 v80, v80
    v_exp_f32 v81, v81
    v_cvt_pk_bf16_f32 v58, v76, v77
    v_exp_f32 v82, v82
    v_exp_f32 v83, v83
    v_cvt_pk_bf16_f32 v59, v78, v79
    v_mfma_f32_32x32x16_bf16 v[120:135], v[44:47], v[68:71], v[120:135]
    s_waitcnt lgkmcnt(0)
    v_exp_f32 v84, v84
    v_exp_f32 v85, v85
    v_cvt_pk_bf16_f32 v60, v80, v81
    v_exp_f32 v86, v86
    v_exp_f32 v87, v87
    v_cvt_pk_bf16_f32 v61, v82, v83
    v_cvt_pk_bf16_f32 v62, v84, v85
    v_cvt_pk_bf16_f32 v63, v86, v87
    v_mfma_f32_32x32x16_bf16 v[72:87], v[24:27], v[8:11], 0
    ds_read_b64 v[32:33], v5 offset:28160
    v_exp_f32 v88, v88
    v_exp_f32 v89, v89
    v_exp_f32 v90, v90
    v_exp_f32 v91, v91
    v_mfma_f32_32x32x16_bf16 v[72:87], v[28:31], v[16:19], v[72:87]
    ds_read_b64 v[34:35], v5 offset:28416
    v_exp_f32 v92, v92
    v_exp_f32 v93, v93
    v_cvt_pk_bf16_f32 v64, v88, v89
    v_exp_f32 v94, v94
    v_exp_f32 v95, v95
    v_cvt_pk_bf16_f32 v65, v90, v91
    v_mfma_f32_32x32x16_bf16 v[104:119], v[48:51], v[56:59], v[104:119]
    ds_read_b64 v[36:37], v5 offset:29184
    v_exp_f32 v96, v96
    v_exp_f32 v97, v97
    v_cvt_pk_bf16_f32 v66, v92, v93
    v_exp_f32 v98, v98
    v_exp_f32 v99, v99
    v_cvt_pk_bf16_f32 v67, v94, v95
    v_mfma_f32_32x32x16_bf16 v[104:119], v[52:55], v[60:63], v[104:119]
    v_exp_f32 v100, v100
    v_exp_f32 v101, v101
    v_cvt_pk_bf16_f32 v68, v96, v97
    v_exp_f32 v102, v102
    v_exp_f32 v103, v103
    v_cvt_pk_bf16_f32 v69, v98, v99
    v_cvt_pk_bf16_f32 v70, v100, v101
    v_cvt_pk_bf16_f32 v71, v102, v103
    v_mfma_f32_32x32x16_bf16 v[88:103], v[24:27], v[12:15], 0
    ds_read_b128 v[40:43], v3 offset:5120
    v_exp_f32 v72, v72
    v_exp_f32 v73, v73
    v_exp_f32 v74, v74
    v_exp_f32 v75, v75
    v_mfma_f32_32x32x16_bf16 v[88:103], v[28:31], v[20:23], v[88:103]
    ds_read_b128 v[44:47], v3 offset:5760
    v_exp_f32 v76, v76
    v_exp_f32 v77, v77
    v_cvt_pk_bf16_f32 v56, v72, v73
    v_exp_f32 v78, v78
    v_exp_f32 v79, v79
    v_cvt_pk_bf16_f32 v57, v74, v75
    v_mfma_f32_32x32x16_bf16 v[120:135], v[48:51], v[64:67], v[120:135]
    v_exp_f32 v80, v80
    v_exp_f32 v81, v81
    v_cvt_pk_bf16_f32 v58, v76, v77
    v_exp_f32 v82, v82
    v_exp_f32 v83, v83
    v_cvt_pk_bf16_f32 v59, v78, v79
    v_mfma_f32_32x32x16_bf16 v[120:135], v[52:55], v[68:71], v[120:135]
    s_waitcnt vmcnt(0) lgkmcnt(0)
    s_barrier
    v_exp_f32 v84, v84
    v_exp_f32 v85, v85
    v_cvt_pk_bf16_f32 v60, v80, v81
    v_exp_f32 v86, v86
    v_exp_f32 v87, v87
    v_cvt_pk_bf16_f32 v61, v82, v83
    v_cvt_pk_bf16_f32 v62, v84, v85
    v_cvt_pk_bf16_f32 v63, v86, v87
    v_mfma_f32_32x32x16_bf16 v[72:87], v[32:35], v[8:11], 0
    ds_read_b64 v[24:25], v5 offset:40960
    v_exp_f32 v88, v88
    v_exp_f32 v89, v89
    v_exp_f32 v90, v90
    v_exp_f32 v91, v91
    v_mfma_f32_32x32x16_bf16 v[72:87], v[36:39], v[16:19], v[72:87]
    ds_read_b64 v[26:27], v5 offset:41216
    v_exp_f32 v92, v92
    v_exp_f32 v93, v93
    v_cvt_pk_bf16_f32 v64, v88, v89
    v_exp_f32 v94, v94
    v_exp_f32 v95, v95
    v_cvt_pk_bf16_f32 v65, v90, v91
    v_mfma_f32_32x32x16_bf16 v[104:119], v[40:43], v[56:59], v[104:119]
    ds_read_b64 v[28:29], v5 offset:41984
    s_add_u32 m0, s26, 0
    v_exp_f32 v96, v96
    v_exp_f32 v97, v97
    v_cvt_pk_bf16_f32 v66, v92, v93
    v_exp_f32 v98, v98
    v_exp_f32 v99, v99
    v_cvt_pk_bf16_f32 v67, v94, v95
    v_mfma_f32_32x32x16_bf16 v[104:119], v[44:47], v[60:63], v[104:119]
    buffer_load_dwordx4 v136, s[8:11], s20 offen lds
    s_add_u32 s20, s20, 10240
    v_exp_f32 v100, v100
    v_exp_f32 v101, v101
    v_cvt_pk_bf16_f32 v68, v96, v97
    v_exp_f32 v102, v102
    v_exp_f32 v103, v103
    v_cvt_pk_bf16_f32 v69, v98, v99
    v_cvt_pk_bf16_f32 v70, v100, v101
    v_cvt_pk_bf16_f32 v71, v102, v103
    v_mfma_f32_32x32x16_bf16 v[88:103], v[32:35], v[12:15], 0
    ds_read_b128 v[48:51], v3 offset:7680
    v_exp_f32 v72, v72
    v_exp_f32 v73, v73
    v_exp_f32 v74, v74
    v_exp_f32 v75, v75
    v_mfma_f32_32x32x16_bf16 v[88:103], v[36:39], v[20:23], v[88:103]
    ds_read_b128 v[52:55], v3 offset:8320
    v_exp_f32 v76, v76
    v_exp_f32 v77, v77
    v_cvt_pk_bf16_f32 v56, v72, v73
    v_exp_f32 v78, v78
    v_exp_f32 v79, v79
    v_cvt_pk_bf16_f32 v57, v74, v75
    v_mfma_f32_32x32x16_bf16 v[120:135], v[40:43], v[64:67], v[120:135]
    s_add_u32 m0, s26, 8192
    v_exp_f32 v80, v80
    v_exp_f32 v81, v81
    v_cvt_pk_bf16_f32 v58, v76, v77
    v_exp_f32 v82, v82
    v_exp_f32 v83, v83
    v_cvt_pk_bf16_f32 v59, v78, v79
    v_mfma_f32_32x32x16_bf16 v[120:135], v[44:47], v[68:71], v[120:135]
    buffer_load_dwordx4 v136, s[8:11], s21 offen lds
    s_add_u32 s21, s21, 10240
    s_waitcnt lgkmcnt(0)
    v_exp_f32 v84, v84
    v_exp_f32 v85, v85
    v_cvt_pk_bf16_f32 v60, v80, v81
    v_exp_f32 v86, v86
    v_exp_f32 v87, v87
    v_cvt_pk_bf16_f32 v61, v82, v83
    v_cvt_pk_bf16_f32 v62, v84, v85
    v_cvt_pk_bf16_f32 v63, v86, v87
    v_mfma_f32_32x32x16_bf16 v[72:87], v[24:27], v[8:11], 0
    ds_read_b64 v[32:33], v5 offset:43520
    v_exp_f32 v88, v88
    v_exp_f32 v89, v89
    v_exp_f32 v90, v90
    v_exp_f32 v91, v91
    v_mfma_f32_32x32x16_bf16 v[72:87], v[28:31], v[16:19], v[72:87]
    ds_read_b64 v[34:35], v5 offset:43776
    v_exp_f32 v92, v92
    v_exp_f32 v93, v93
    v_cvt_pk_bf16_f32 v64, v88, v89
    v_exp_f32 v94, v94
    v_exp_f32 v95, v95
    v_cvt_pk_bf16_f32 v65, v90, v91
    v_mfma_f32_32x32x16_bf16 v[104:119], v[48:51], v[56:59], v[104:119]
    ds_read_b64 v[36:37], v5 offset:44544
    s_add_u32 m0, s26, 16384
    v_exp_f32 v96, v96
    v_exp_f32 v97, v97
    v_cvt_pk_bf16_f32 v66, v92, v93
    v_exp_f32 v98, v98
    v_exp_f32 v99, v99
    v_cvt_pk_bf16_f32 v67, v94, v95
    v_mfma_f32_32x32x16_bf16 v[104:119], v[52:55], v[60:63], v[104:119]
    s_cbranch_vccz K2_SK1
    buffer_load_dwordx4 v136, s[8:11], s22 offen lds
K2_SK1:
    s_add_u32 s22, s22, 10240
    v_exp_f32 v100, v100
    v_exp_f32 v101, v101
    v_cvt_pk_bf16_f32 v68, v96, v97
    v_exp_f32 v102, v102
    v_exp_f32 v103, v103
    v_cvt_pk_bf16_f32 v69, v98, v99
    v_cvt_pk_bf16_f32 v70, v100, v101
    v_cvt_pk_bf16_f32 v71, v102, v103
    v_mad_u32_u24 v3, v7, s31, v6
    v_mfma_f32_32x32x16_bf16 v[88:103], v[24:27], v[12:15], 0
    ds_read_b128 v[40:43], v3 offset:0
    v_exp_f32 v72, v72
    v_exp_f32 v73, v73
    v_exp_f32 v74, v74
    v_exp_f32 v75, v75
    v_mfma_f32_32x32x16_bf16 v[88:103], v[28:31], v[20:23], v[88:103]
    ds_read_b128 v[44:47], v3 offset:640
    v_exp_f32 v76, v76
    v_exp_f32 v77, v77
    v_cvt_pk_bf16_f32 v56, v72, v73
    v_exp_f32 v78, v78
    v_exp_f32 v79, v79
    v_cvt_pk_bf16_f32 v57, v74, v75
    v_mfma_f32_32x32x16_bf16 v[120:135], v[48:51], v[64:67], v[120:135]
    v_exp_f32 v80, v80
    v_exp_f32 v81, v81
    v_cvt_pk_bf16_f32 v58, v76, v77
    v_exp_f32 v82, v82
    v_exp_f32 v83, v83
    v_cvt_pk_bf16_f32 v59, v78, v79
    v_mfma_f32_32x32x16_bf16 v[120:135], v[52:55], v[68:71], v[120:135]
    s_waitcnt lgkmcnt(0)
    v_exp_f32 v84, v84
    v_exp_f32 v85, v85
    v_cvt_pk_bf16_f32 v60, v80, v81
    v_exp_f32 v86, v86
    v_exp_f32 v87, v87
    v_cvt_pk_bf16_f32 v61, v82, v83
    v_cvt_pk_bf16_f32 v62, v84, v85
    v_cvt_pk_bf16_f32 v63, v86, v87
    v_mfma_f32_32x32x16_bf16 v[72:87], v[32:35], v[8:11], 0
    ds_read_b64 v[24:25], v5 offset:46080
    v_exp_f32 v88, v88
    v_exp_f32 v89, v89
    v_exp_f32 v90, v90
    v_exp_f32 v91, v91
    v_mfma_f32_32x32x16_bf16 v[72:87], v[36:39], v[16:19], v[72:87]
    ds_read_b64 v[26:27], v5 offset:46336
    v_exp_f32 v92, v92
    v_exp_f32 v93, v93
    v_cvt_pk_bf16_f32 v64, v88, v89
    v_exp_f32 v94, v94
    v_exp_f32 v95, v95
    v_cvt_pk_bf16_f32 v65, v90, v91
    v_mfma_f32_32x32x16_bf16 v[104:119], v[40:43], v[56:59], v[104:119]
    ds_read_b64 v[28:29], v5 offset:47104
    v_exp_f32 v96, v96
    v_exp_f32 v97, v97
    v_cvt_pk_bf16_f32 v66, v92, v93
    v_exp_f32 v98, v98
    v_exp_f32 v99, v99
    v_cvt_pk_bf16_f32 v67, v94, v95
    v_mfma_f32_32x32x16_bf16 v[104:119], v[44:47], v[60:63], v[104:119]
    v_exp_f32 v100, v100
    v_exp_f32 v101, v101
    v_cvt_pk_bf16_f32 v68, v96, v97
    v_exp_f32 v102, v102
    v_exp_f32 v103, v103
    v_cvt_pk_bf16_f32 v69, v98, v99
    v_cvt_pk_bf16_f32 v70, v100, v101
    v_cvt_pk_bf16_f32 v71, v102, v103
    v_mfma_f32_32x32x16_bf16 v[88:103], v[32:35], v[12:15], 0
    ds_read_b128 v[48:51], v3 offset:2560
    v_exp_f32 v72, v72
    v_exp_f32 v73, v73
    v_exp_f32 v74, v74
    v_exp_f32 v75, v75
    v_mfma_f32_32x32x16_bf16 v[88:103], v[36:39], v[20:23], v[88:103]
    ds_read_b128 v[52:55], v3 offset:3200
    v_exp_f32 v76, v76
    v_exp_f32 v77, v77
    v_cvt_pk_bf16_f32 v56, v72, v73
    v_exp_f32 v78, v78
    v_exp_f32 v79, v79
    v_cvt_pk_bf16_f32 v57, v74, v75
    v_mfma_f32_32x32x16_bf16 v[120:135], v[40:43], v[64:67], v[120:135]
    v_exp_f32 v80, v80
    v_exp_f32 v81, v81
    v_cvt_pk_bf16_f32 v58, v76, v77
    v_exp_f32 v82, v82
    v_exp_f32 v83, v83
    v_cvt_pk_bf16_f32 v59, v78, v79
    v_mfma_f32_32x32x16_bf16 v[120:135], v[44:47], v[68:71], v[120:135]
    s_waitcnt lgkmcnt(0)
    v_exp_f32 v84, v84
    v_exp_f32 v85, v85
    v_cvt_pk_bf16_f32 v60, v80, v81
    v_exp_f32 v86, v86
    v_exp_f32 v87, v87
    v_cvt_pk_bf16_f32 v61, v82, v83
    v_cvt_pk_bf16_f32 v62, v84, v85
    v_cvt_pk_bf16_f32 v63, v86, v87
    v_mfma_f32_32x32x16_bf16 v[72:87], v[24:27], v[8:11], 0
    ds_read_b64 v[32:33], v5 offset:48640
    v_exp_f32 v88, v88
    v_exp_f32 v89, v89
    v_exp_f32 v90, v90
    v_exp_f32 v91, v91
    v_mfma_f32_32x32x16_bf16 v[72:87], v[28:31], v[16:19], v[72:87]
    ds_read_b64 v[34:35], v5 offset:48896
    v_exp_f32 v92, v92
    v_exp_f32 v93, v93
    v_cvt_pk_bf16_f32 v64, v88, v89
    v_exp_f32 v94, v94
    v_exp_f32 v95, v95
    v_cvt_pk_bf16_f32 v65, v90, v91
    v_mfma_f32_32x32x16_bf16 v[104:119], v[48:51], v[56:59], v[104:119]
    ds_read_b64 v[36:37], v5 offset:49664
    v_exp_f32 v96, v96
    v_exp_f32 v97, v97
    v_cvt_pk_bf16_f32 v66, v92, v93
    v_exp_f32 v98, v98
    v_exp_f32 v99, v99
    v_cvt_pk_bf16_f32 v67, v94, v95
    v_mfma_f32_32x32x16_bf16 v[104:119], v[52:55], v[60:63], v[104:119]
    v_exp_f32 v100, v100
    v_exp_f32 v101, v101
    v_cvt_pk_bf16_f32 v68, v96, v97
    v_exp_f32 v102, v102
    v_exp_f32 v103, v103
    v_cvt_pk_bf16_f32 v69, v98, v99
    v_cvt_pk_bf16_f32 v70, v100, v101
    v_cvt_pk_bf16_f32 v71, v102, v103
    v_mfma_f32_32x32x16_bf16 v[88:103], v[24:27], v[12:15], 0
    ds_read_b128 v[40:43], v3 offset:5120
    v_exp_f32 v72, v72
    v_exp_f32 v73, v73
    v_exp_f32 v74, v74
    v_exp_f32 v75, v75
    v_mfma_f32_32x32x16_bf16 v[88:103], v[28:31], v[20:23], v[88:103]
    ds_read_b128 v[44:47], v3 offset:5760
    v_exp_f32 v76, v76
    v_exp_f32 v77, v77
    v_cvt_pk_bf16_f32 v56, v72, v73
    v_exp_f32 v78, v78
    v_exp_f32 v79, v79
    v_cvt_pk_bf16_f32 v57, v74, v75
    v_mfma_f32_32x32x16_bf16 v[120:135], v[48:51], v[64:67], v[120:135]
    v_exp_f32 v80, v80
    v_exp_f32 v81, v81
    v_cvt_pk_bf16_f32 v58, v76, v77
    v_exp_f32 v82, v82
    v_exp_f32 v83, v83
    v_cvt_pk_bf16_f32 v59, v78, v79
    v_mfma_f32_32x32x16_bf16 v[120:135], v[52:55], v[68:71], v[120:135]
    s_waitcnt vmcnt(0) lgkmcnt(0)
    s_barrier
    v_exp_f32 v84, v84
    v_exp_f32 v85, v85
    v_cvt_pk_bf16_f32 v60, v80, v81
    v_exp_f32 v86, v86
    v_exp_f32 v87, v87
    v_cvt_pk_bf16_f32 v61, v82, v83
    v_cvt_pk_bf16_f32 v62, v84, v85
    v_cvt_pk_bf16_f32 v63, v86, v87
    v_mfma_f32_32x32x16_bf16 v[72:87], v[32:35], v[8:11], 0
    ds_read_b64 v[24:25], v5 offset:0
    v_exp_f32 v88, v88
    v_exp_f32 v89, v89
    v_exp_f32 v90, v90
    v_exp_f32 v91, v91
    v_mfma_f32_32x32x16_bf16 v[72:87], v[36:39], v[16:19], v[72:87]
    ds_read_b64 v[26:27], v5 offset:256
    v_exp_f32 v92, v92
    v_exp_f32 v93, v93
    v_cvt_pk_bf16_f32 v64, v88, v89
    v_exp_f32 v94, v94
    v_exp_f32 v95, v95
    v_cvt_pk_bf16_f32 v65, v90, v91
    v_mfma_f32_32x32x16_bf16 v[104:119], v[40:43], v[56:59], v[104:119]
    ds_read_b64 v[28:29], v5 offset:1024
    s_add_u32 m0, s26, 20480
    v_exp_f32 v96, v96
    v_exp_f32 v97, v97
    v_cvt_pk_bf16_f32 v66, v92, v93
    v_exp_f32 v98, v98
    v_exp_f32 v99, v99
    v_cvt_pk_bf16_f32 v67, v94, v95
    v_mfma_f32_32x32x16_bf16 v[104:119], v[44:47], v[60:63], v[104:119]
    buffer_load_dwordx4 v136, s[8:11], s20 offen lds
    s_add_u32 s20, s20, 10240
    v_exp_f32 v100, v100
    v_exp_f32 v101, v101
    v_cvt_pk_bf16_f32 v68, v96, v97
    v_exp_f32 v102, v102
    v_exp_f32 v103, v103
    v_cvt_pk_bf16_f32 v69, v98, v99
    v_cvt_pk_bf16_f32 v70, v100, v101
    v_cvt_pk_bf16_f32 v71, v102, v103
    v_mfma_f32_32x32x16_bf16 v[88:103], v[32:35], v[12:15], 0
    ds_read_b128 v[48:51], v3 offset:7680
    v_exp_f32 v72, v72
    v_exp_f32 v73, v73
    v_exp_f32 v74, v74
    v_exp_f32 v75, v75
    v_mfma_f32_32x32x16_bf16 v[88:103], v[36:39], v[20:23], v[88:103]
    ds_read_b128 v[52:55], v3 offset:8320
    v_exp_f32 v76, v76
    v_exp_f32 v77, v77
    v_cvt_pk_bf16_f32 v56, v72, v73
    v_exp_f32 v78, v78
    v_exp_f32 v79, v79
    v_cvt_pk_bf16_f32 v57, v74, v75
    v_mfma_f32_32x32x16_bf16 v[120:135], v[40:43], v[64:67], v[120:135]
    s_add_u32 m0, s26, 28672
    v_exp_f32 v80, v80
    v_exp_f32 v81, v81
    v_cvt_pk_bf16_f32 v58, v76, v77
    v_exp_f32 v82, v82
    v_exp_f32 v83, v83
    v_cvt_pk_bf16_f32 v59, v78, v79
    v_mfma_f32_32x32x16_bf16 v[120:135], v[44:47], v[68:71], v[120:135]
    buffer_load_dwordx4 v136, s[8:11], s21 offen lds
    s_add_u32 s21, s21, 10240
    s_waitcnt lgkmcnt(0)
    v_exp_f32 v84, v84
    v_exp_f32 v85, v85
    v_cvt_pk_bf16_f32 v60, v80, v81
    v_exp_f32 v86, v86
    v_exp_f32 v87, v87
    v_cvt_pk_bf16_f32 v61, v82, v83
    v_cvt_pk_bf16_f32 v62, v84, v85
    v_cvt_pk_bf16_f32 v63, v86, v87
    v_mfma_f32_32x32x16_bf16 v[72:87], v[24:27], v[8:11], 0
    ds_read_b64 v[32:33], v5 offset:2560
    v_exp_f32 v88, v88
    v_exp_f32 v89, v89
    v_exp_f32 v90, v90
    v_exp_f32 v91, v91
    v_mfma_f32_32x32x16_bf16 v[72:87], v[28:31], v[16:19], v[72:87]
    ds_read_b64 v[34:35], v5 offset:2816
    v_exp_f32 v92, v92
    v_exp_f32 v93, v93
    v_cvt_pk_bf16_f32 v64, v88, v89
    v_exp_f32 v94, v94
    v_exp_f32 v95, v95
    v_cvt_pk_bf16_f32 v65, v90, v91
    v_mfma_f32_32x32x16_bf16 v[104:119], v[48:51], v[56:59], v[104:119]
    ds_read_b64 v[36:37], v5 offset:3584
    s_add_u32 m0, s26, 36864
    v_exp_f32 v96, v96
    v_exp_f32 v97, v97
    v_cvt_pk_bf16_f32 v66, v92, v93
    v_exp_f32 v98, v98
    v_exp_f32 v99, v99
    v_cvt_pk_bf16_f32 v67, v94, v95
    v_mfma_f32_32x32x16_bf16 v[104:119], v[52:55], v[60:63], v[104:119]
    s_cbranch_vccz K2_SK2
    buffer_load_dwordx4 v136, s[8:11], s22 offen lds
K2_SK2:
    s_add_u32 s22, s22, 10240
    v_exp_f32 v100, v100
    v_exp_f32 v101, v101
    v_cvt_pk_bf16_f32 v68, v96, v97
    v_exp_f32 v102, v102
    v_exp_f32 v103, v103
    v_cvt_pk_bf16_f32 v69, v98, v99
    v_cvt_pk_bf16_f32 v70, v100, v101
    v_cvt_pk_bf16_f32 v71, v102, v103
    v_mov_b32 v3, v6
    v_mfma_f32_32x32x16_bf16 v[88:103], v[24:27], v[12:15], 0
    ds_read_b128 v[40:43], v3 offset:0
    v_exp_f32 v72, v72
    v_exp_f32 v73, v73
    v_exp_f32 v74, v74
    v_exp_f32 v75, v75
    v_mfma_f32_32x32x16_bf16 v[88:103], v[28:31], v[20:23], v[88:103]
    ds_read_b128 v[44:47], v3 offset:640
    v_exp_f32 v76, v76
    v_exp_f32 v77, v77
    v_cvt_pk_bf16_f32 v56, v72, v73
    v_exp_f32 v78, v78
    v_exp_f32 v79, v79
    v_cvt_pk_bf16_f32 v57, v74, v75
    v_mfma_f32_32x32x16_bf16 v[120:135], v[48:51], v[64:67], v[120:135]
    v_exp_f32 v80, v80
    v_exp_f32 v81, v81
    v_cvt_pk_bf16_f32 v58, v76, v77
    v_exp_f32 v82, v82
    v_exp_f32 v83, v83
    v_cvt_pk_bf16_f32 v59, v78, v79
    v_mfma_f32_32x32x16_bf16 v[120:135], v[52:55], v[68:71], v[120:135]
    s_waitcnt lgkmcnt(0)
    v_exp_f32 v84, v84
    v_exp_f32 v85, v85
    v_cvt_pk_bf16_f32 v60, v80, v81
    v_exp_f32 v86, v86
    v_exp_f32 v87, v87
    v_cvt_pk_bf16_f32 v61, v82, v83
    v_cvt_pk_bf16_f32 v62, v84, v85
    v_cvt_pk_bf16_f32 v63, v86, v87
    v_mfma_f32_32x32x16_bf16 v[72:87], v[32:35], v[8:11], 0
    ds_read_b64 v[24:25], v5 offset:5120
    v_exp_f32 v88, v88
    v_exp_f32 v89, v89
    v_exp_f32 v90, v90
    v_exp_f32 v91, v91
    v_mfma_f32_32x32x16_bf16 v[72:87], v[36:39], v[16:19], v[72:87]
    ds_read_b64 v[26:27], v5 offset:5376
    v_exp_f32 v92, v92
    v_exp_f32 v93, v93
    v_cvt_pk_bf16_f32 v64, v88, v89
    v_exp_f32 v94, v94
    v_exp_f32 v95, v95
    v_cvt_pk_bf16_f32 v65, v90, v91
    v_mfma_f32_32x32x16_bf16 v[104:119], v[40:43], v[56:59], v[104:119]
    ds_read_b64 v[28:29], v5 offset:6144
    v_exp_f32 v96, v96
    v_exp_f32 v97, v97
    v_cvt_pk_bf16_f32 v66, v92, v93
    v_exp_f32 v98, v98
    v_exp_f32 v99, v99
    v_cvt_pk_bf16_f32 v67, v94, v95
    v_mfma_f32_32x32x16_bf16 v[104:119], v[44:47], v[60:63], v[104:119]
    v_exp_f32 v100, v100
    v_exp_f32 v101, v101
    v_cvt_pk_bf16_f32 v68, v96, v97
    v_exp_f32 v102, v102
    v_exp_f32 v103, v103
    v_cvt_pk_bf16_f32 v69, v98, v99
    v_cvt_pk_bf16_f32 v70, v100, v101
    v_cvt_pk_bf16_f32 v71, v102, v103
    v_mfma_f32_32x32x16_bf16 v[88:103], v[32:35], v[12:15], 0
    ds_read_b128 v[48:51], v3 offset:2560
    v_exp_f32 v72, v72
    v_exp_f32 v73, v73
    v_exp_f32 v74, v74
    v_exp_f32 v75, v75
    v_mfma_f32_32x32x16_bf16 v[88:103], v[36:39], v[20:23], v[88:103]
    ds_read_b128 v[52:55], v3 offset:3200
    v_exp_f32 v76, v76
    v_exp_f32 v77, v77
    v_cvt_pk_bf16_f32 v56, v72, v73
    v_exp_f32 v78, v78
    v_exp_f32 v79, v79
    v_cvt_pk_bf16_f32 v57, v74, v75
    v_mfma_f32_32x32x16_bf16 v[120:135], v[40:43], v[64:67], v[120:135]
    v_exp_f32 v80, v80
    v_exp_f32 v81, v81
    v_cvt_pk_bf16_f32 v58, v76, v77
    v_exp_f32 v82, v82
    v_exp_f32 v83, v83
    v_cvt_pk_bf16_f32 v59, v78, v79
    v_mfma_f32_32x32x16_bf16 v[120:135], v[44:47], v[68:71], v[120:135]
    s_waitcnt lgkmcnt(0)
    v_exp_f32 v84, v84
    v_exp_f32 v85, v85
    v_cvt_pk_bf16_f32 v60, v80, v81
    v_exp_f32 v86, v86
    v_exp_f32 v87, v87
    v_cvt_pk_bf16_f32 v61, v82, v83
    v_cvt_pk_bf16_f32 v62, v84, v85
    v_cvt_pk_bf16_f32 v63, v86, v87
    v_mfma_f32_32x32x16_bf16 v[72:87], v[24:27], v[8:11], 0
    ds_read_b64 v[32:33], v5 offset:7680
    v_exp_f32 v88, v88
    v_exp_f32 v89, v89
    v_exp_f32 v90, v90
    v_exp_f32 v91, v91
    v_mfma_f32_32x32x16_bf16 v[72:87], v[28:31], v[16:19], v[72:87]
    ds_read_b64 v[34:35], v5 offset:7936
    v_exp_f32 v92, v92
    v_exp_f32 v93, v93
    v_cvt_pk_bf16_f32 v64, v88, v89
    v_exp_f32 v94, v94
    v_exp_f32 v95, v95
    v_cvt_pk_bf16_f32 v65, v90, v91
    v_mfma_f32_32x32x16_bf16 v[104:119], v[48:51], v[56:59], v[104:119]
    ds_read_b64 v[36:37], v5 offset:8704
    v_exp_f32 v96, v96
    v_exp_f32 v97, v97
    v_cvt_pk_bf16_f32 v66, v92, v93
    v_exp_f32 v98, v98
    v_exp_f32 v99, v99
    v_cvt_pk_bf16_f32 v67, v94, v95
    v_mfma_f32_32x32x16_bf16 v[104:119], v[52:55], v[60:63], v[104:119]
    v_exp_f32 v100, v100
    v_exp_f32 v101, v101
    v_cvt_pk_bf16_f32 v68, v96, v97
    v_exp_f32 v102, v102
    v_exp_f32 v103, v103
    v_cvt_pk_bf16_f32 v69, v98, v99
    v_cvt_pk_bf16_f32 v70, v100, v101
    v_cvt_pk_bf16_f32 v71, v102, v103
    v_mfma_f32_32x32x16_bf16 v[88:103], v[24:27], v[12:15], 0
    ds_read_b128 v[40:43], v3 offset:5120
    v_exp_f32 v72, v72
    v_exp_f32 v73, v73
    v_exp_f32 v74, v74
    v_exp_f32 v75, v75
    v_mfma_f32_32x32x16_bf16 v[88:103], v[28:31], v[20:23], v[88:103]
    ds_read_b128 v[44:47], v3 offset:5760
    v_exp_f32 v76, v76
    v_exp_f32 v77, v77
    v_cvt_pk_bf16_f32 v56, v72, v73
    v_exp_f32 v78, v78
    v_exp_f32 v79, v79
    v_cvt_pk_bf16_f32 v57, v74, v75
    v_mfma_f32_32x32x16_bf16 v[120:135], v[48:51], v[64:67], v[120:135]
    v_exp_f32 v80, v80
    v_exp_f32 v81, v81
    v_cvt_pk_bf16_f32 v58, v76, v77
    v_exp_f32 v82, v82
    v_exp_f32 v83, v83
    v_cvt_pk_bf16_f32 v59, v78, v79
    v_mfma_f32_32x32x16_bf16 v[120:135], v[52:55], v[68:71], v[120:135]
    s_waitcnt vmcnt(0) lgkmcnt(0)
    s_barrier
    v_exp_f32 v84, v84
    v_exp_f32 v85, v85
    v_cvt_pk_bf16_f32 v60, v80, v81
    v_exp_f32 v86, v86
    v_exp_f32 v87, v87
    v_cvt_pk_bf16_f32 v61, v82, v83
    v_cvt_pk_bf16_f32 v62, v84, v85
    v_cvt_pk_bf16_f32 v63, v86, v87
    v_mfma_f32_32x32x16_bf16 v[72:87], v[32:35], v[8:11], 0
    ds_read_b64 v[24:25], v5 offset:20480
    v_exp_f32 v88, v88
    v_exp_f32 v89, v89
    v_exp_f32 v90, v90
    v_exp_f32 v91, v91
    v_mfma_f32_32x32x16_bf16 v[72:87], v[36:39], v[16:19], v[72:87]
    ds_read_b64 v[26:27], v5 offset:20736
    v_exp_f32 v92, v92
    v_exp_f32 v93, v93
    v_cvt_pk_bf16_f32 v64, v88, v89
    v_exp_f32 v94, v94
    v_exp_f32 v95, v95
    v_cvt_pk_bf16_f32 v65, v90, v91
    v_mfma_f32_32x32x16_bf16 v[104:119], v[40:43], v[56:59], v[104:119]
    ds_read_b64 v[28:29], v5 offset:21504
    s_add_u32 m0, s26, 40960
    v_exp_f32 v96, v96
    v_exp_f32 v97, v97
    v_cvt_pk_bf16_f32 v66, v92, v93
    v_exp_f32 v98, v98
    v_exp_f32 v99, v99
    v_cvt_pk_bf16_f32 v67, v94, v95
    v_mfma_f32_32x32x16_bf16 v[104:119], v[44:47], v[60:63], v[104:119]
    buffer_load_dwordx4 v136, s[8:11], s20 offen lds
    s_add_u32 s20, s20, 10240
    v_exp_f32 v100, v100
    v_exp_f32 v101, v101
    v_cvt_pk_bf16_f32 v68, v96, v97
    v_exp_f32 v102, v102
    v_exp_f32 v103, v103
    v_cvt_pk_bf16_f32 v69, v98, v99
    v_cvt_pk_bf16_f32 v70, v100, v101
    v_cvt_pk_bf16_f32 v71, v102, v103
    v_mfma_f32_32x32x16_bf16 v[88:103], v[32:35], v[12:15], 0
    ds_read_b128 v[48:51], v3 offset:7680
    v_exp_f32 v72, v72
    v_exp_f32 v73, v73
    v_exp_f32 v74, v74
    v_exp_f32 v75, v75
    v_mfma_f32_32x32x16_bf16 v[88:103], v[36:39], v[20:23], v[88:103]
    ds_read_b128 v[52:55], v3 offset:8320
    v_exp_f32 v76, v76
    v_exp_f32 v77, v77
    v_cvt_pk_bf16_f32 v56, v72, v73
    v_exp_f32 v78, v78
    v_exp_f32 v79, v79
    v_cvt_pk_bf16_f32 v57, v74, v75
    v_mfma_f32_32x32x16_bf16 v[120:135], v[40:43], v[64:67], v[120:135]
    s_add_u32 m0, s26, 49152
    v_exp_f32 v80, v80
    v_exp_f32 v81, v81
    v_cvt_pk_bf16_f32 v58, v76, v77
    v_exp_f32 v82, v82
    v_exp_f32 v83, v83
    v_cvt_pk_bf16_f32 v59, v78, v79
    v_mfma_f32_32x32x16_bf16 v[120:135], v[44:47], v[68:71], v[120:135]
    buffer_load_dwordx4 v136, s[8:11], s21 offen lds
    s_add_u32 s21, s21, 10240
    s_waitcnt lgkmcnt(0)
    v_exp_f32 v84, v84
    v_exp_f32 v85, v85
    v_cvt_pk_bf16_f32 v60, v80, v81
    v_exp_f32 v86, v86
    v_exp_f32 v87, v87
    v_cvt_pk_bf16_f32 v61, v82, v83
    v_cvt_pk_bf16_f32 v62, v84, v85
    v_cvt_pk_bf16_f32 v63, v86, v87
    v_mfma_f32_32x32x16_bf16 v[72:87], v[24:27], v[8:11], 0
    ds_read_b64 v[32:33], v5 offset:23040
    v_exp_f32 v88, v88
    v_exp_f32 v89, v89
    v_exp_f32 v90, v90
    v_exp_f32 v91, v91
    v_mfma_f32_32x32x16_bf16 v[72:87], v[28:31], v[16:19], v[72:87]
    ds_read_b64 v[34:35], v5 offset:23296
    v_exp_f32 v92, v92
    v_exp_f32 v93, v93
    v_cvt_pk_bf16_f32 v64, v88, v89
    v_exp_f32 v94, v94
    v_exp_f32 v95, v95
    v_cvt_pk_bf16_f32 v65, v90, v91
    v_mfma_f32_32x32x16_bf16 v[104:119], v[48:51], v[56:59], v[104:119]
    ds_read_b64 v[36:37], v5 offset:24064
    s_add_u32 m0, s26, 57344
    v_exp_f32 v96, v96
    v_exp_f32 v97, v97
    v_cvt_pk_bf16_f32 v66, v92, v93
    v_exp_f32 v98, v98
    v_exp_f32 v99, v99
    v_cvt_pk_bf16_f32 v67, v94, v95
    v_mfma_f32_32x32x16_bf16 v[104:119], v[52:55], v[60:63], v[104:119]
    s_cbranch_vccz K2_SK3
    buffer_load_dwordx4 v136, s[8:11], s22 offen lds
K2_SK3:
    s_add_u32 s22, s22, 10240
    v_exp_f32 v100, v100
    v_exp_f32 v101, v101
    v_cvt_pk_bf16_f32 v68, v96, v97
    v_exp_f32 v102, v102
    v_exp_f32 v103, v103
    v_cvt_pk_bf16_f32 v69, v98, v99
    v_cvt_pk_bf16_f32 v70, v100, v101
    v_cvt_pk_bf16_f32 v71, v102, v103
    v_mad_u32_u24 v3, v7, s30, v6
    v_mfma_f32_32x32x16_bf16 v[88:103], v[24:27], v[12:15], 0
    ds_read_b128 v[40:43], v3 offset:0
    v_exp_f32 v72, v72
    v_exp_f32 v73, v73
    v_exp_f32 v74, v74
    v_exp_f32 v75, v75
    v_mfma_f32_32x32x16_bf16 v[88:103], v[28:31], v[20:23], v[88:103]
    ds_read_b128 v[44:47], v3 offset:640
    v_exp_f32 v76, v76
    v_exp_f32 v77, v77
    v_cvt_pk_bf16_f32 v56, v72, v73
    v_exp_f32 v78, v78
    v_exp_f32 v79, v79
    v_cvt_pk_bf16_f32 v57, v74, v75
    v_mfma_f32_32x32x16_bf16 v[120:135], v[48:51], v[64:67], v[120:135]
    v_exp_f32 v80, v80
    v_exp_f32 v81, v81
    v_cvt_pk_bf16_f32 v58, v76, v77
    v_exp_f32 v82, v82
    v_exp_f32 v83, v83
    v_cvt_pk_bf16_f32 v59, v78, v79
    v_mfma_f32_32x32x16_bf16 v[120:135], v[52:55], v[68:71], v[120:135]
    s_waitcnt lgkmcnt(0)
    v_exp_f32 v84, v84
    v_exp_f32 v85, v85
    v_cvt_pk_bf16_f32 v60, v80, v81
    v_exp_f32 v86, v86
    v_exp_f32 v87, v87
    v_cvt_pk_bf16_f32 v61, v82, v83
    v_cvt_pk_bf16_f32 v62, v84, v85
    v_cvt_pk_bf16_f32 v63, v86, v87
    v_mfma_f32_32x32x16_bf16 v[72:87], v[32:35], v[8:11], 0
    ds_read_b64 v[24:25], v5 offset:25600
    v_exp_f32 v88, v88
    v_exp_f32 v89, v89
    v_exp_f32 v90, v90
    v_exp_f32 v91, v91
    v_mfma_f32_32x32x16_bf16 v[72:87], v[36:39], v[16:19], v[72:87]
    ds_read_b64 v[26:27], v5 offset:25856
    v_exp_f32 v92, v92
    v_exp_f32 v93, v93
    v_cvt_pk_bf16_f32 v64, v88, v89
    v_exp_f32 v94, v94
    v_exp_f32 v95, v95
    v_cvt_pk_bf16_f32 v65, v90, v91
    v_mfma_f32_32x32x16_bf16 v[104:119], v[40:43], v[56:59], v[104:119]
    ds_read_b64 v[28:29], v5 offset:26624
    v_exp_f32 v96, v96
    v_exp_f32 v97, v97
    v_cvt_pk_bf16_f32 v66, v92, v93
    v_exp_f32 v98, v98
    v_exp_f32 v99, v99
    v_cvt_pk_bf16_f32 v67, v94, v95
    v_mfma_f32_32x32x16_bf16 v[104:119], v[44:47], v[60:63], v[104:119]
    v_exp_f32 v100, v100
    v_exp_f32 v101, v101
    v_cvt_pk_bf16_f32 v68, v96, v97
    v_exp_f32 v102, v102
    v_exp_f32 v103, v103
    v_cvt_pk_bf16_f32 v69, v98, v99
    v_cvt_pk_bf16_f32 v70, v100, v101
    v_cvt_pk_bf16_f32 v71, v102, v103
    v_mfma_f32_32x32x16_bf16 v[88:103], v[32:35], v[12:15], 0
    ds_read_b128 v[48:51], v3 offset:2560
    v_exp_f32 v72, v72
    v_exp_f32 v73, v73
    v_exp_f32 v74, v74
    v_exp_f32 v75, v75
    v_mfma_f32_32x32x16_bf16 v[88:103], v[36:39], v[20:23], v[88:103]
    ds_read_b128 v[52:55], v3 offset:3200
    v_exp_f32 v76, v76
    v_exp_f32 v77, v77
    v_cvt_pk_bf16_f32 v56, v72, v73
    v_exp_f32 v78, v78
    v_exp_f32 v79, v79
    v_cvt_pk_bf16_f32 v57, v74, v75
    v_mfma_f32_32x32x16_bf16 v[120:135], v[40:43], v[64:67], v[120:135]
    v_exp_f32 v80, v80
    v_exp_f32 v81, v81
    v_cvt_pk_bf16_f32 v58, v76, v77
    v_exp_f32 v82, v82
    v_exp_f32 v83, v83
    v_cvt_pk_bf16_f32 v59, v78, v79
    v_mfma_f32_32x32x16_bf16 v[120:135], v[44:47], v[68:71], v[120:135]
    s_waitcnt lgkmcnt(0)
    v_exp_f32 v84, v84
    v_exp_f32 v85, v85
    v_cvt_pk_bf16_f32 v60, v80, v81
    v_exp_f32 v86, v86
    v_exp_f32 v87, v87
    v_cvt_pk_bf16_f32 v61, v82, v83
    v_cvt_pk_bf16_f32 v62, v84, v85
    v_cvt_pk_bf16_f32 v63, v86, v87
    v_mfma_f32_32x32x16_bf16 v[72:87], v[24:27], v[8:11], 0
    ds_read_b64 v[32:33], v5 offset:28160
    v_exp_f32 v88, v88
    v_exp_f32 v89, v89
    v_exp_f32 v90, v90
    v_exp_f32 v91, v91
    v_mfma_f32_32x32x16_bf16 v[72:87], v[28:31], v[16:19], v[72:87]
    ds_read_b64 v[34:35], v5 offset:28416
    v_exp_f32 v92, v92
    v_exp_f32 v93, v93
    v_cvt_pk_bf16_f32 v64, v88, v89
    v_exp_f32 v94, v94
    v_exp_f32 v95, v95
    v_cvt_pk_bf16_f32 v65, v90, v91
    v_mfma_f32_32x32x16_bf16 v[104:119], v[48:51], v[56:59], v[104:119]
    ds_read_b64 v[36:37], v5 offset:29184
    v_exp_f32 v96, v96
    v_exp_f32 v97, v97
    v_cvt_pk_bf16_f32 v66, v92, v93
    v_exp_f32 v98, v98
    v_exp_f32 v99, v99
    v_cvt_pk_bf16_f32 v67, v94, v95
    v_mfma_f32_32x32x16_bf16 v[104:119], v[52:55], v[60:63], v[104:119]
    v_exp_f32 v100, v100
    v_exp_f32 v101, v101
    v_cvt_pk_bf16_f32 v68, v96, v97
    v_exp_f32 v102, v102
    v_exp_f32 v103, v103
    v_cvt_pk_bf16_f32 v69, v98, v99
    v_cvt_pk_bf16_f32 v70, v100, v101
    v_cvt_pk_bf16_f32 v71, v102, v103
    v_mfma_f32_32x32x16_bf16 v[88:103], v[24:27], v[12:15], 0
    ds_read_b128 v[40:43], v3 offset:5120
    v_exp_f32 v72, v72
    v_exp_f32 v73, v73
    v_exp_f32 v74, v74
    v_exp_f32 v75, v75
    v_mfma_f32_32x32x16_bf16 v[88:103], v[28:31], v[20:23], v[88:103]
    ds_read_b128 v[44:47], v3 offset:5760
    v_exp_f32 v76, v76
    v_exp_f32 v77, v77
    v_cvt_pk_bf16_f32 v56, v72, v73
    v_exp_f32 v78, v78
    v_exp_f32 v79, v79
    v_cvt_pk_bf16_f32 v57, v74, v75
    v_mfma_f32_32x32x16_bf16 v[120:135], v[48:51], v[64:67], v[120:135]
    v_exp_f32 v80, v80
    v_exp_f32 v81, v81
    v_cvt_pk_bf16_f32 v58, v76, v77
    v_exp_f32 v82, v82
    v_exp_f32 v83, v83
    v_cvt_pk_bf16_f32 v59, v78, v79
    v_mfma_f32_32x32x16_bf16 v[120:135], v[52:55], v[68:71], v[120:135]
    s_waitcnt vmcnt(0) lgkmcnt(0)
    s_barrier
    v_exp_f32 v84, v84
    v_exp_f32 v85, v85
    v_cvt_pk_bf16_f32 v60, v80, v81
    v_exp_f32 v86, v86
    v_exp_f32 v87, v87
    v_cvt_pk_bf16_f32 v61, v82, v83
    v_cvt_pk_bf16_f32 v62, v84, v85
    v_cvt_pk_bf16_f32 v63, v86, v87
    v_mfma_f32_32x32x16_bf16 v[72:87], v[32:35], v[8:11], 0
    ds_read_b64 v[24:25], v5 offset:40960
    v_exp_f32 v88, v88
    v_exp_f32 v89, v89
    v_exp_f32 v90, v90
    v_exp_f32 v91, v91
    v_mfma_f32_32x32x16_bf16 v[72:87], v[36:39], v[16:19], v[72:87]
    ds_read_b64 v[26:27], v5 offset:41216
    v_exp_f32 v92, v92
    v_exp_f32 v93, v93
    v_cvt_pk_bf16_f32 v64, v88, v89
    v_exp_f32 v94, v94
    v_exp_f32 v95, v95
    v_cvt_pk_bf16_f32 v65, v90, v91
    v_mfma_f32_32x32x16_bf16 v[104:119], v[40:43], v[56:59], v[104:119]
    ds_read_b64 v[28:29], v5 offset:41984
    s_add_u32 m0, s26, 0
    v_exp_f32 v96, v96
    v_exp_f32 v97, v97
    v_cvt_pk_bf16_f32 v66, v92, v93
    v_exp_f32 v98, v98
    v_exp_f32 v99, v99
    v_cvt_pk_bf16_f32 v67, v94, v95
    v_mfma_f32_32x32x16_bf16 v[104:119], v[44:47], v[60:63], v[104:119]
    buffer_load_dwordx4 v136, s[8:11], s20 offen lds
    s_add_u32 s20, s20, 10240
    v_exp_f32 v100, v100
    v_exp_f32 v101, v101
    v_cvt_pk_bf16_f32 v68, v96, v97
    v_exp_f32 v102, v102
    v_exp_f32 v103, v103
    v_cvt_pk_bf16_f32 v69, v98, v99
    v_cvt_pk_bf16_f32 v70, v100, v101
    v_cvt_pk_bf16_f32 v71, v102, v103
    v_mfma_f32_32x32x16_bf16 v[88:103], v[32:35], v[12:15], 0
    ds_read_b128 v[48:51], v3 offset:7680
    v_exp_f32 v72, v72
    v_exp_f32 v73, v73
    v_exp_f32 v74, v74
    v_exp_f32 v75, v75
    v_mfma_f32_32x32x16_bf16 v[88:103], v[36:39], v[20:23], v[88:103]
    ds_read_b128 v[52:55], v3 offset:8320
    v_exp_f32 v76, v76
    v_exp_f32 v77, v77
    v_cvt_pk_bf16_f32 v56, v72, v73
    v_exp_f32 v78, v78
    v_exp_f32 v79, v79
    v_cvt_pk_bf16_f32 v57, v74, v75
    v_mfma_f32_32x32x16_bf16 v[120:135], v[40:43], v[64:67], v[120:135]
    s_add_u32 m0, s26, 8192
    v_exp_f32 v80, v80
    v_exp_f32 v81, v81
    v_cvt_pk_bf16_f32 v58, v76, v77
    v_exp_f32 v82, v82
    v_exp_f32 v83, v83
    v_cvt_pk_bf16_f32 v59, v78, v79
    v_mfma_f32_32x32x16_bf16 v[120:135], v[44:47], v[68:71], v[120:135]
    buffer_load_dwordx4 v136, s[8:11], s21 offen lds
    s_add_u32 s21, s21, 10240
    s_waitcnt lgkmcnt(0)
    v_exp_f32 v84, v84
    v_exp_f32 v85, v85
    v_cvt_pk_bf16_f32 v60, v80, v81
    v_exp_f32 v86, v86
    v_exp_f32 v87, v87
    v_cvt_pk_bf16_f32 v61, v82, v83
    v_cvt_pk_bf16_f32 v62, v84, v85
    v_cvt_pk_bf16_f32 v63, v86, v87
    v_mfma_f32_32x32x16_bf16 v[72:87], v[24:27], v[8:11], 0
    ds_read_b64 v[32:33], v5 offset:43520
    v_exp_f32 v88, v88
    v_exp_f32 v89, v89
    v_exp_f32 v90, v90
    v_exp_f32 v91, v91
    v_mfma_f32_32x32x16_bf16 v[72:87], v[28:31], v[16:19], v[72:87]
    ds_read_b64 v[34:35], v5 offset:43776
    v_exp_f32 v92, v92
    v_exp_f32 v93, v93
    v_cvt_pk_bf16_f32 v64, v88, v89
    v_exp_f32 v94, v94
    v_exp_f32 v95, v95
    v_cvt_pk_bf16_f32 v65, v90, v91
    v_mfma_f32_32x32x16_bf16 v[104:119], v[48:51], v[56:59], v[104:119]
    ds_read_b64 v[36:37], v5 offset:44544
    s_add_u32 m0, s26, 16384
    v_exp_f32 v96, v96
    v_exp_f32 v97, v97
    v_cvt_pk_bf16_f32 v66, v92, v93
    v_exp_f32 v98, v98
    v_exp_f32 v99, v99
    v_cvt_pk_bf16_f32 v67, v94, v95
    v_mfma_f32_32x32x16_bf16 v[104:119], v[52:55], v[60:63], v[104:119]
    s_cbranch_vccz K2_SK4
    buffer_load_dwordx4 v136, s[8:11], s22 offen lds
K2_SK4:
    s_add_u32 s22, s22, 10240
    v_exp_f32 v100, v100
    v_exp_f32 v101, v101
    v_cvt_pk_bf16_f32 v68, v96, v97
    v_exp_f32 v102, v102
    v_exp_f32 v103, v103
    v_cvt_pk_bf16_f32 v69, v98, v99
    v_cvt_pk_bf16_f32 v70, v100, v101
    v_cvt_pk_bf16_f32 v71, v102, v103
    v_mad_u32_u24 v3, v7, s31, v6
    v_mfma_f32_32x32x16_bf16 v[88:103], v[24:27], v[12:15], 0
    ds_read_b128 v[40:43], v3 offset:0
    v_exp_f32 v72, v72
    v_exp_f32 v73, v73
    v_exp_f32 v74, v74
    v_exp_f32 v75, v75
    v_mfma_f32_32x32x16_bf16 v[88:103], v[28:31], v[20:23], v[88:103]
    ds_read_b128 v[44:47], v3 offset:640
    v_exp_f32 v76, v76
    v_exp_f32 v77, v77
    v_cvt_pk_bf16_f32 v56, v72, v73
    v_exp_f32 v78, v78
    v_exp_f32 v79, v79
    v_cvt_pk_bf16_f32 v57, v74, v75
    v_mfma_f32_32x32x16_bf16 v[120:135], v[48:51], v[64:67], v[120:135]
    v_exp_f32 v80, v80
    v_exp_f32 v81, v81
    v_cvt_pk_bf16_f32 v58, v76, v77
    v_exp_f32 v82, v82
    v_exp_f32 v83, v83
    v_cvt_pk_bf16_f32 v59, v78, v79
    v_mfma_f32_32x32x16_bf16 v[120:135], v[52:55], v[68:71], v[120:135]
    s_waitcnt lgkmcnt(0)
    v_exp_f32 v84, v84
    v_exp_f32 v85, v85
    v_cvt_pk_bf16_f32 v60, v80, v81
    v_exp_f32 v86, v86
    v_exp_f32 v87, v87
    v_cvt_pk_bf16_f32 v61, v82, v83
    v_cvt_pk_bf16_f32 v62, v84, v85
    v_cvt_pk_bf16_f32 v63, v86, v87
    v_mfma_f32_32x32x16_bf16 v[72:87], v[32:35], v[8:11], 0
    ds_read_b64 v[24:25], v5 offset:46080
    v_exp_f32 v88, v88
    v_exp_f32 v89, v89
    v_exp_f32 v90, v90
    v_exp_f32 v91, v91
    v_mfma_f32_32x32x16_bf16 v[72:87], v[36:39], v[16:19], v[72:87]
    ds_read_b64 v[26:27], v5 offset:46336
    v_exp_f32 v92, v92
    v_exp_f32 v93, v93
    v_cvt_pk_bf16_f32 v64, v88, v89
    v_exp_f32 v94, v94
    v_exp_f32 v95, v95
    v_cvt_pk_bf16_f32 v65, v90, v91
    v_mfma_f32_32x32x16_bf16 v[104:119], v[40:43], v[56:59], v[104:119]
    ds_read_b64 v[28:29], v5 offset:47104
    v_exp_f32 v96, v96
    v_exp_f32 v97, v97
    v_cvt_pk_bf16_f32 v66, v92, v93
    v_exp_f32 v98, v98
    v_exp_f32 v99, v99
    v_cvt_pk_bf16_f32 v67, v94, v95
    v_mfma_f32_32x32x16_bf16 v[104:119], v[44:47], v[60:63], v[104:119]
    v_exp_f32 v100, v100
    v_exp_f32 v101, v101
    v_cvt_pk_bf16_f32 v68, v96, v97
    v_exp_f32 v102, v102
    v_exp_f32 v103, v103
    v_cvt_pk_bf16_f32 v69, v98, v99
    v_cvt_pk_bf16_f32 v70, v100, v101
    v_cvt_pk_bf16_f32 v71, v102, v103
    v_mfma_f32_32x32x16_bf16 v[88:103], v[32:35], v[12:15], 0
    ds_read_b128 v[48:51], v3 offset:2560
    v_exp_f32 v72, v72
    v_exp_f32 v73, v73
    v_exp_f32 v74, v74
    v_exp_f32 v75, v75
    v_mfma_f32_32x32x16_bf16 v[88:103], v[36:39], v[20:23], v[88:103]
    ds_read_b128 v[52:55], v3 offset:3200
    v_exp_f32 v76, v76
    v_exp_f32 v77, v77
    v_cvt_pk_bf16_f32 v56, v72, v73
    v_exp_f32 v78, v78
    v_exp_f32 v79, v79
    v_cvt_pk_bf16_f32 v57, v74, v75
    v_mfma_f32_32x32x16_bf16 v[120:135], v[40:43], v[64:67], v[120:135]
    v_exp_f32 v80, v80
    v_exp_f32 v81, v81
    v_cvt_pk_bf16_f32 v58, v76, v77
    v_exp_f32 v82, v82
    v_exp_f32 v83, v83
    v_cvt_pk_bf16_f32 v59, v78, v79
    v_mfma_f32_32x32x16_bf16 v[120:135], v[44:47], v[68:71], v[120:135]
    s_waitcnt lgkmcnt(0)
    v_exp_f32 v84, v84
    v_exp_f32 v85, v85
    v_cvt_pk_bf16_f32 v60, v80, v81
    v_exp_f32 v86, v86
    v_exp_f32 v87, v87
    v_cvt_pk_bf16_f32 v61, v82, v83
    v_cvt_pk_bf16_f32 v62, v84, v85
    v_cvt_pk_bf16_f32 v63, v86, v87
    v_mfma_f32_32x32x16_bf16 v[72:87], v[24:27], v[8:11], 0
    ds_read_b64 v[32:33], v5 offset:48640
    v_exp_f32 v88, v88
    v_exp_f32 v89, v89
    v_exp_f32 v90, v90
    v_exp_f32 v91, v91
    v_mfma_f32_32x32x16_bf16 v[72:87], v[28:31], v[16:19], v[72:87]
    ds_read_b64 v[34:35], v5 offset:48896
    v_exp_f32 v92, v92
    v_exp_f32 v93, v93
    v_cvt_pk_bf16_f32 v64, v88, v89
    v_exp_f32 v94, v94
    v_exp_f32 v95, v95
    v_cvt_pk_bf16_f32 v65, v90, v91
    v_mfma_f32_32x32x16_bf16 v[104:119], v[48:51], v[56:59], v[104:119]
    ds_read_b64 v[36:37], v5 offset:49664
    v_exp_f32 v96, v96
    v_exp_f32 v97, v97
    v_cvt_pk_bf16_f32 v66, v92, v93
    v_exp_f32 v98, v98
    v_exp_f32 v99, v99
    v_cvt_pk_bf16_f32 v67, v94, v95
    v_mfma_f32_32x32x16_bf16 v[104:119], v[52:55], v[60:63], v[104:119]
    v_exp_f32 v100, v100
    v_exp_f32 v101, v101
    v_cvt_pk_bf16_f32 v68, v96, v97
    v_exp_f32 v102, v102
    v_exp_f32 v103, v103
    v_cvt_pk_bf16_f32 v69, v98, v99
    v_cvt_pk_bf16_f32 v70, v100, v101
    v_cvt_pk_bf16_f32 v71, v102, v103
    v_mfma_f32_32x32x16_bf16 v[88:103], v[24:27], v[12:15], 0
    ds_read_b128 v[40:43], v3 offset:5120
    v_exp_f32 v72, v72
    v_exp_f32 v73, v73
    v_exp_f32 v74, v74
    v_exp_f32 v75, v75
    v_mfma_f32_32x32x16_bf16 v[88:103], v[28:31], v[20:23], v[88:103]
    ds_read_b128 v[44:47], v3 offset:5760
    v_exp_f32 v76, v76
    v_exp_f32 v77, v77
    v_cvt_pk_bf16_f32 v56, v72, v73
    v_exp_f32 v78, v78
    v_exp_f32 v79, v79
    v_cvt_pk_bf16_f32 v57, v74, v75
    v_mfma_f32_32x32x16_bf16 v[120:135], v[48:51], v[64:67], v[120:135]
    v_exp_f32 v80, v80
    v_exp_f32 v81, v81
    v_cvt_pk_bf16_f32 v58, v76, v77
    v_exp_f32 v82, v82
    v_exp_f32 v83, v83
    v_cvt_pk_bf16_f32 v59, v78, v79
    v_mfma_f32_32x32x16_bf16 v[120:135], v[52:55], v[68:71], v[120:135]
    s_waitcnt vmcnt(0) lgkmcnt(0)
    s_barrier
    v_exp_f32 v84, v84
    v_exp_f32 v85, v85
    v_cvt_pk_bf16_f32 v60, v80, v81
    v_exp_f32 v86, v86
    v_exp_f32 v87, v87
    v_cvt_pk_bf16_f32 v61, v82, v83
    v_cvt_pk_bf16_f32 v62, v84, v85
    v_cvt_pk_bf16_f32 v63, v86, v87
    v_mfma_f32_32x32x16_bf16 v[72:87], v[32:35], v[8:11], 0
    ds_read_b64 v[24:25], v5 offset:0
    v_exp_f32 v88, v88
    v_exp_f32 v89, v89
    v_exp_f32 v90, v90
    v_exp_f32 v91, v91
    v_mfma_f32_32x32x16_bf16 v[72:87], v[36:39], v[16:19], v[72:87]
    ds_read_b64 v[26:27], v5 offset:256
    v_exp_f32 v92, v92
    v_exp_f32 v93, v93
    v_cvt_pk_bf16_f32 v64, v88, v89
    v_exp_f32 v94, v94
    v_exp_f32 v95, v95
    v_cvt_pk_bf16_f32 v65, v90, v91
    v_mfma_f32_32x32x16_bf16 v[104:119], v[40:43], v[56:59], v[104:119]
    ds_read_b64 v[28:29], v5 offset:1024
    s_add_u32 m0, s26, 20480
    v_exp_f32 v96, v96
    v_exp_f32 v97, v97
    v_cvt_pk_bf16_f32 v66, v92, v93
    v_exp_f32 v98, v98
    v_exp_f32 v99, v99
    v_cvt_pk_bf16_f32 v67, v94, v95
    v_mfma_f32_32x32x16_bf16 v[104:119], v[44:47], v[60:63], v[104:119]
    buffer_load_dwordx4 v136, s[8:11], s20 offen lds
    s_add_u32 s20, s20, 10240
    v_exp_f32 v100, v100
    v_exp_f32 v101, v101
    v_cvt_pk_bf16_f32 v68, v96, v97
    v_exp_f32 v102, v102
    v_exp_f32 v103, v103
    v_cvt_pk_bf16_f32 v69, v98, v99
    v_cvt_pk_bf16_f32 v70, v100, v101
    v_cvt_pk_bf16_f32 v71, v102, v103
    v_mfma_f32_32x32x16_bf16 v[88:103], v[32:35], v[12:15], 0
    ds_read_b128 v[48:51], v3 offset:7680
    v_exp_f32 v72, v72
    v_exp_f32 v73, v73
    v_exp_f32 v74, v74
    v_exp_f32 v75, v75
    v_mfma_f32_32x32x16_bf16 v[88:103], v[36:39], v[20:23], v[88:103]
    ds_read_b128 v[52:55], v3 offset:8320
    v_exp_f32 v76, v76
    v_exp_f32 v77, v77
    v_cvt_pk_bf16_f32 v56, v72, v73
    v_exp_f32 v78, v78
    v_exp_f32 v79, v79
    v_cvt_pk_bf16_f32 v57, v74, v75
    v_mfma_f32_32x32x16_bf16 v[120:135], v[40:43], v[64:67], v[120:135]
    s_add_u32 m0, s26, 28672
    v_exp_f32 v80, v80
    v_exp_f32 v81, v81
    v_cvt_pk_bf16_f32 v58, v76, v77
    v_exp_f32 v82, v82
    v_exp_f32 v83, v83
    v_cvt_pk_bf16_f32 v59, v78, v79
    v_mfma_f32_32x32x16_bf16 v[120:135], v[44:47], v[68:71], v[120:135]
    buffer_load_dwordx4 v136, s[8:11], s21 offen lds
    s_add_u32 s21, s21, 10240
    s_waitcnt lgkmcnt(0)
    v_exp_f32 v84, v84
    v_exp_f32 v85, v85
    v_cvt_pk_bf16_f32 v60, v80, v81
    v_exp_f32 v86, v86
    v_exp_f32 v87, v87
    v_cvt_pk_bf16_f32 v61, v82, v83
    v_cvt_pk_bf16_f32 v62, v84, v85
    v_cvt_pk_bf16_f32 v63, v86, v87
    v_mfma_f32_32x32x16_bf16 v[72:87], v[24:27], v[8:11], 0
    ds_read_b64 v[32:33], v5 offset:2560
    v_exp_f32 v88, v88
    v_exp_f32 v89, v89
    v_exp_f32 v90, v90
    v_exp_f32 v91, v91
    v_mfma_f32_32x32x16_bf16 v[72:87], v[28:31], v[16:19], v[72:87]
    ds_read_b64 v[34:35], v5 offset:2816
    v_exp_f32 v92, v92
    v_exp_f32 v93, v93
    v_cvt_pk_bf16_f32 v64, v88, v89
    v_exp_f32 v94, v94
    v_exp_f32 v95, v95
    v_cvt_pk_bf16_f32 v65, v90, v91
    v_mfma_f32_32x32x16_bf16 v[104:119], v[48:51], v[56:59], v[104:119]
    ds_read_b64 v[36:37], v5 offset:3584
    s_add_u32 m0, s26, 36864
    v_exp_f32 v96, v96
    v_exp_f32 v97, v97
    v_cvt_pk_bf16_f32 v66, v92, v93
    v_exp_f32 v98, v98
    v_exp_f32 v99, v99
    v_cvt_pk_bf16_f32 v67, v94, v95
    v_mfma_f32_32x32x16_bf16 v[104:119], v[52:55], v[60:63], v[104:119]
    s_cbranch_vccz K2_SK5
    buffer_load_dwordx4 v136, s[8:11], s22 offen lds
K2_SK5:
    s_add_u32 s22, s22, 10240
    v_exp_f32 v100, v100
    v_exp_f32 v101, v101
    v_cvt_pk_bf16_f32 v68, v96, v97
    v_exp_f32 v102, v102
    v_exp_f32 v103, v103
    v_cvt_pk_bf16_f32 v69, v98, v99
    v_cvt_pk_bf16_f32 v70, v100, v101
    v_cvt_pk_bf16_f32 v71, v102, v103
    v_mov_b32 v3, v6
    v_mfma_f32_32x32x16_bf16 v[88:103], v[24:27], v[12:15], 0
    ds_read_b128 v[40:43], v3 offset:0
    v_exp_f32 v72, v72
    v_exp_f32 v73, v73
    v_exp_f32 v74, v74
    v_exp_f32 v75, v75
    v_mfma_f32_32x32x16_bf16 v[88:103], v[28:31], v[20:23], v[88:103]
    ds_read_b128 v[44:47], v3 offset:640
    v_exp_f32 v76, v76
    v_exp_f32 v77, v77
    v_cvt_pk_bf16_f32 v56, v72, v73
    v_exp_f32 v78, v78
    v_exp_f32 v79, v79
    v_cvt_pk_bf16_f32 v57, v74, v75
    v_mfma_f32_32x32x16_bf16 v[120:135], v[48:51], v[64:67], v[120:135]
    v_exp_f32 v80, v80
    v_exp_f32 v81, v81
    v_cvt_pk_bf16_f32 v58, v76, v77
    v_exp_f32 v82, v82
    v_exp_f32 v83, v83
    v_cvt_pk_bf16_f32 v59, v78, v79
    v_mfma_f32_32x32x16_bf16 v[120:135], v[52:55], v[68:71], v[120:135]
    s_waitcnt lgkmcnt(0)
    v_exp_f32 v84, v84
    v_exp_f32 v85, v85
    v_cvt_pk_bf16_f32 v60, v80, v81
    v_exp_f32 v86, v86
    v_exp_f32 v87, v87
    v_cvt_pk_bf16_f32 v61, v82, v83
    v_cvt_pk_bf16_f32 v62, v84, v85
    v_cvt_pk_bf16_f32 v63, v86, v87
    v_mfma_f32_32x32x16_bf16 v[72:87], v[32:35], v[8:11], 0
    ds_read_b64 v[24:25], v5 offset:5120
    v_exp_f32 v88, v88
    v_exp_f32 v89, v89
    v_exp_f32 v90, v90
    v_exp_f32 v91, v91
    v_mfma_f32_32x32x16_bf16 v[72:87], v[36:39], v[16:19], v[72:87]
    ds_read_b64 v[26:27], v5 offset:5376
    v_exp_f32 v92, v92
    v_exp_f32 v93, v93
    v_cvt_pk_bf16_f32 v64, v88, v89
    v_exp_f32 v94, v94
    v_exp_f32 v95, v95
    v_cvt_pk_bf16_f32 v65, v90, v91
    v_mfma_f32_32x32x16_bf16 v[104:119], v[40:43], v[56:59], v[104:119]
    ds_read_b64 v[28:29], v5 offset:6144
    v_exp_f32 v96, v96
    v_exp_f32 v97, v97
    v_cvt_pk_bf16_f32 v66, v92, v93
    v_exp_f32 v98, v98
    v_exp_f32 v99, v99
    v_cvt_pk_bf16_f32 v67, v94, v95
    v_mfma_f32_32x32x16_bf16 v[104:119], v[44:47], v[60:63], v[104:119]
    v_exp_f32 v100, v100
    v_exp_f32 v101, v101
    v_cvt_pk_bf16_f32 v68, v96, v97
    v_exp_f32 v102, v102
    v_exp_f32 v103, v103
    v_cvt_pk_bf16_f32 v69, v98, v99
    v_cvt_pk_bf16_f32 v70, v100, v101
    v_cvt_pk_bf16_f32 v71, v102, v103
    v_mfma_f32_32x32x16_bf16 v[88:103], v[32:35], v[12:15], 0
    ds_read_b128 v[48:51], v3 offset:2560
    v_exp_f32 v72, v72
    v_exp_f32 v73, v73
    v_exp_f32 v74, v74
    v_exp_f32 v75, v75
    v_mfma_f32_32x32x16_bf16 v[88:103], v[36:39], v[20:23], v[88:103]
    ds_read_b128 v[52:55], v3 offset:3200
    v_exp_f32 v76, v76
    v_exp_f32 v77, v77
    v_cvt_pk_bf16_f32 v56, v72, v73
    v_exp_f32 v78, v78
    v_exp_f32 v79, v79
    v_cvt_pk_bf16_f32 v57, v74, v75
    v_mfma_f32_32x32x16_bf16 v[120:135], v[40:43], v[64:67], v[120:135]
    v_exp_f32 v80, v80
    v_exp_f32 v81, v81
    v_cvt_pk_bf16_f32 v58, v76, v77
    v_exp_f32 v82, v82
    v_exp_f32 v83, v83
    v_cvt_pk_bf16_f32 v59, v78, v79
    v_mfma_f32_32x32x16_bf16 v[120:135], v[44:47], v[68:71], v[120:135]
    s_waitcnt lgkmcnt(0)
    v_exp_f32 v84, v84
    v_exp_f32 v85, v85
    v_cvt_pk_bf16_f32 v60, v80, v81
    v_exp_f32 v86, v86
    v_exp_f32 v87, v87
    v_cvt_pk_bf16_f32 v61, v82, v83
    v_cvt_pk_bf16_f32 v62, v84, v85
    v_cvt_pk_bf16_f32 v63, v86, v87
    v_mfma_f32_32x32x16_bf16 v[72:87], v[24:27], v[8:11], 0
    ds_read_b64 v[32:33], v5 offset:7680
    v_exp_f32 v88, v88
    v_exp_f32 v89, v89
    v_exp_f32 v90, v90
    v_exp_f32 v91, v91
    v_mfma_f32_32x32x16_bf16 v[72:87], v[28:31], v[16:19], v[72:87]
    ds_read_b64 v[34:35], v5 offset:7936
    v_exp_f32 v92, v92
    v_exp_f32 v93, v93
    v_cvt_pk_bf16_f32 v64, v88, v89
    v_exp_f32 v94, v94
    v_exp_f32 v95, v95
    v_cvt_pk_bf16_f32 v65, v90, v91
    v_mfma_f32_32x32x16_bf16 v[104:119], v[48:51], v[56:59], v[104:119]
    ds_read_b64 v[36:37], v5 offset:8704
    v_exp_f32 v96, v96
    v_exp_f32 v97, v97
    v_cvt_pk_bf16_f32 v66, v92, v93
    v_exp_f32 v98, v98
    v_exp_f32 v99, v99
    v_cvt_pk_bf16_f32 v67, v94, v95
    v_mfma_f32_32x32x16_bf16 v[104:119], v[52:55], v[60:63], v[104:119]
    v_exp_f32 v100, v100
    v_exp_f32 v101, v101
    v_cvt_pk_bf16_f32 v68, v96, v97
    v_exp_f32 v102, v102
    v_exp_f32 v103, v103
    v_cvt_pk_bf16_f32 v69, v98, v99
    v_cvt_pk_bf16_f32 v70, v100, v101
    v_cvt_pk_bf16_f32 v71, v102, v103
    v_mfma_f32_32x32x16_bf16 v[88:103], v[24:27], v[12:15], 0
    ds_read_b128 v[40:43], v3 offset:5120
    v_exp_f32 v72, v72
    v_exp_f32 v73, v73
    v_exp_f32 v74, v74
    v_exp_f32 v75, v75
    v_mfma_f32_32x32x16_bf16 v[88:103], v[28:31], v[20:23], v[88:103]
    ds_read_b128 v[44:47], v3 offset:5760
    v_exp_f32 v76, v76
    v_exp_f32 v77, v77
    v_cvt_pk_bf16_f32 v56, v72, v73
    v_exp_f32 v78, v78
    v_exp_f32 v79, v79
    v_cvt_pk_bf16_f32 v57, v74, v75
    v_mfma_f32_32x32x16_bf16 v[120:135], v[48:51], v[64:67], v[120:135]
    v_exp_f32 v80, v80
    v_exp_f32 v81, v81
    v_cvt_pk_bf16_f32 v58, v76, v77
    v_exp_f32 v82, v82
    v_exp_f32 v83, v83
    v_cvt_pk_bf16_f32 v59, v78, v79
    v_mfma_f32_32x32x16_bf16 v[120:135], v[52:55], v[68:71], v[120:135]
    s_waitcnt vmcnt(0) lgkmcnt(0)
    s_barrier
    v_exp_f32 v84, v84
    v_exp_f32 v85, v85
    v_cvt_pk_bf16_f32 v60, v80, v81
    v_exp_f32 v86, v86
    v_exp_f32 v87, v87
    v_cvt_pk_bf16_f32 v61, v82, v83
    v_cvt_pk_bf16_f32 v62, v84, v85
    v_cvt_pk_bf16_f32 v63, v86, v87
    v_mfma_f32_32x32x16_bf16 v[72:87], v[32:35], v[8:11], 0
    ds_read_b64 v[24:25], v5 offset:20480
    v_exp_f32 v88, v88
    v_exp_f32 v89, v89
    v_exp_f32 v90, v90
    v_exp_f32 v91, v91
    v_mfma_f32_32x32x16_bf16 v[72:87], v[36:39], v[16:19], v[72:87]
    ds_read_b64 v[26:27], v5 offset:20736
    v_exp_f32 v92, v92
    v_exp_f32 v93, v93
    v_cvt_pk_bf16_f32 v64, v88, v89
    v_exp_f32 v94, v94
    v_exp_f32 v95, v95
    v_cvt_pk_bf16_f32 v65, v90, v91
    v_mfma_f32_32x32x16_bf16 v[104:119], v[40:43], v[56:59], v[104:119]
    ds_read_b64 v[28:29], v5 offset:21504
    v_exp_f32 v96, v96
    v_exp_f32 v97, v97
    v_cvt_pk_bf16_f32 v66, v92, v93
    v_exp_f32 v98, v98
    v_exp_f32 v99, v99
    v_cvt_pk_bf16_f32 v67, v94, v95
    v_mfma_f32_32x32x16_bf16 v[104:119], v[44:47], v[60:63], v[104:119]
    v_exp_f32 v100, v100
    v_exp_f32 v101, v101
    v_cvt_pk_bf16_f32 v68, v96, v97
    v_exp_f32 v102, v102
    v_exp_f32 v103, v103
    v_cvt_pk_bf16_f32 v69, v98, v99
    v_cvt_pk_bf16_f32 v70, v100, v101
    v_cvt_pk_bf16_f32 v71, v102, v103
    v_mfma_f32_32x32x16_bf16 v[88:103], v[32:35], v[12:15], 0
    ds_read_b128 v[48:51], v3 offset:7680
    v_exp_f32 v72, v72
    v_exp_f32 v73, v73
    v_exp_f32 v74, v74
    v_exp_f32 v75, v75
    v_mfma_f32_32x32x16_bf16 v[88:103], v[36:39], v[20:23], v[88:103]
    ds_read_b128 v[52:55], v3 offset:8320
    v_exp_f32 v76, v76
    v_exp_f32 v77, v77
    v_cvt_pk_bf16_f32 v56, v72, v73
    v_exp_f32 v78, v78
    v_exp_f32 v79, v79
    v_cvt_pk_bf16_f32 v57, v74, v75
    v_mfma_f32_32x32x16_bf16 v[120:135], v[40:43], v[64:67], v[120:135]
    v_exp_f32 v80, v80
    v_exp_f32 v81, v81
    v_cvt_pk_bf16_f32 v58, v76, v77
    v_exp_f32 v82, v82
    v_exp_f32 v83, v83
    v_cvt_pk_bf16_f32 v59, v78, v79
    v_mfma_f32_32x32x16_bf16 v[120:135], v[44:47], v[68:71], v[120:135]
    s_waitcnt lgkmcnt(0)
    v_exp_f32 v84, v84
    v_exp_f32 v85, v85
    v_cvt_pk_bf16_f32 v60, v80, v81
    v_exp_f32 v86, v86
    v_exp_f32 v87, v87
    v_cvt_pk_bf16_f32 v61, v82, v83
    v_cvt_pk_bf16_f32 v62, v84, v85
    v_cvt_pk_bf16_f32 v63, v86, v87
    v_mfma_f32_32x32x16_bf16 v[72:87], v[24:27], v[8:11], 0
    ds_read_b64 v[32:33], v5 offset:23040
    v_exp_f32 v88, v88
    v_exp_f32 v89, v89
    v_exp_f32 v90, v90
    v_exp_f32 v91, v91
    v_mfma_f32_32x32x16_bf16 v[72:87], v[28:31], v[16:19], v[72:87]
    ds_read_b64 v[34:35], v5 offset:23296
    v_exp_f32 v92, v92
    v_exp_f32 v93, v93
    v_cvt_pk_bf16_f32 v64, v88, v89
    v_exp_f32 v94, v94
    v_exp_f32 v95, v95
    v_cvt_pk_bf16_f32 v65, v90, v91
    v_mfma_f32_32x32x16_bf16 v[104:119], v[48:51], v[56:59], v[104:119]
    ds_read_b64 v[36:37], v5 offset:24064
    v_exp_f32 v96, v96
    v_exp_f32 v97, v97
    v_cvt_pk_bf16_f32 v66, v92, v93
    v_exp_f32 v98, v98
    v_exp_f32 v99, v99
    v_cvt_pk_bf16_f32 v67, v94, v95
    v_mfma_f32_32x32x16_bf16 v[104:119], v[52:55], v[60:63], v[104:119]
    v_exp_f32 v100, v100
    v_exp_f32 v101, v101
    v_cvt_pk_bf16_f32 v68, v96, v97
    v_exp_f32 v102, v102
    v_exp_f32 v103, v103
    v_cvt_pk_bf16_f32 v69, v98, v99
    v_cvt_pk_bf16_f32 v70, v100, v101
    v_cvt_pk_bf16_f32 v71, v102, v103
    v_mad_u32_u24 v3, v7, s30, v6
    v_mfma_f32_32x32x16_bf16 v[88:103], v[24:27], v[12:15], 0
    ds_read_b128 v[40:43], v3 offset:0
    v_exp_f32 v72, v72
    v_exp_f32 v73, v73
    v_exp_f32 v74, v74
    v_exp_f32 v75, v75
    v_mfma_f32_32x32x16_bf16 v[88:103], v[28:31], v[20:23], v[88:103]
    ds_read_b128 v[44:47], v3 offset:640
    v_exp_f32 v76, v76
    v_exp_f32 v77, v77
    v_cvt_pk_bf16_f32 v56, v72, v73
    v_exp_f32 v78, v78
    v_exp_f32 v79, v79
    v_cvt_pk_bf16_f32 v57, v74, v75
    v_mfma_f32_32x32x16_bf16 v[120:135], v[48:51], v[64:67], v[120:135]
    v_exp_f32 v80, v80
    v_exp_f32 v81, v81
    v_cvt_pk_bf16_f32 v58, v76, v77
    v_exp_f32 v82, v82
    v_exp_f32 v83, v83
    v_cvt_pk_bf16_f32 v59, v78, v79
    v_mfma_f32_32x32x16_bf16 v[120:135], v[52:55], v[68:71], v[120:135]
    s_waitcnt lgkmcnt(0)
    v_exp_f32 v84, v84
    v_exp_f32 v85, v85
    v_cvt_pk_bf16_f32 v60, v80, v81
    v_exp_f32 v86, v86
    v_exp_f32 v87, v87
    v_cvt_pk_bf16_f32 v61, v82, v83
    v_cvt_pk_bf16_f32 v62, v84, v85
    v_cvt_pk_bf16_f32 v63, v86, v87
    v_mfma_f32_32x32x16_bf16 v[72:87], v[32:35], v[8:11], 0
    ds_read_b64 v[24:25], v5 offset:25600
    v_exp_f32 v88, v88
    v_exp_f32 v89, v89
    v_exp_f32 v90, v90
    v_exp_f32 v91, v91
    v_mfma_f32_32x32x16_bf16 v[72:87], v[36:39], v[16:19], v[72:87]
    ds_read_b64 v[26:27], v5 offset:25856
    v_exp_f32 v92, v92
    v_exp_f32 v93, v93
    v_cvt_pk_bf16_f32 v64, v88, v89
    v_exp_f32 v94, v94
    v_exp_f32 v95, v95
    v_cvt_pk_bf16_f32 v65, v90, v91
    v_mfma_f32_32x32x16_bf16 v[104:119], v[40:43], v[56:59], v[104:119]
    ds_read_b64 v[28:29], v5 offset:26624
    v_exp_f32 v96, v96
    v_exp_f32 v97, v97
    v_cvt_pk_bf16_f32 v66, v92, v93
    v_exp_f32 v98, v98
    v_exp_f32 v99, v99
    v_cvt_pk_bf16_f32 v67, v94, v95
    v_mfma_f32_32x32x16_bf16 v[104:119], v[44:47], v[60:63], v[104:119]
    v_exp_f32 v100, v100
    v_exp_f32 v101, v101
    v_cvt_pk_bf16_f32 v68, v96, v97
    v_exp_f32 v102, v102
    v_exp_f32 v103, v103
    v_cvt_pk_bf16_f32 v69, v98, v99
    v_cvt_pk_bf16_f32 v70, v100, v101
    v_cvt_pk_bf16_f32 v71, v102, v103
    v_mfma_f32_32x32x16_bf16 v[88:103], v[32:35], v[12:15], 0
    ds_read_b128 v[48:51], v3 offset:2560
    v_exp_f32 v72, v72
    v_exp_f32 v73, v73
    v_exp_f32 v74, v74
    v_exp_f32 v75, v75
    v_mfma_f32_32x32x16_bf16 v[88:103], v[36:39], v[20:23], v[88:103]
    ds_read_b128 v[52:55], v3 offset:3200
    v_exp_f32 v76, v76
    v_exp_f32 v77, v77
    v_cvt_pk_bf16_f32 v56, v72, v73
    v_exp_f32 v78, v78
    v_exp_f32 v79, v79
    v_cvt_pk_bf16_f32 v57, v74, v75
    v_mfma_f32_32x32x16_bf16 v[120:135], v[40:43], v[64:67], v[120:135]
    v_exp_f32 v80, v80
    v_exp_f32 v81, v81
    v_cvt_pk_bf16_f32 v58, v76, v77
    v_exp_f32 v82, v82
    v_exp_f32 v83, v83
    v_cvt_pk_bf16_f32 v59, v78, v79
    v_mfma_f32_32x32x16_bf16 v[120:135], v[44:47], v[68:71], v[120:135]
    s_waitcnt lgkmcnt(0)
    v_exp_f32 v84, v84
    v_exp_f32 v85, v85
    v_cvt_pk_bf16_f32 v60, v80, v81
    v_exp_f32 v86, v86
    v_exp_f32 v87, v87
    v_cvt_pk_bf16_f32 v61, v82, v83
    v_cvt_pk_bf16_f32 v62, v84, v85
    v_cvt_pk_bf16_f32 v63, v86, v87
    v_mfma_f32_32x32x16_bf16 v[72:87], v[24:27], v[8:11], 0
    ds_read_b64 v[32:33], v5 offset:28160
    v_exp_f32 v88, v88
    v_exp_f32 v89, v89
    v_exp_f32 v90, v90
    v_exp_f32 v91, v91
    v_mfma_f32_32x32x16_bf16 v[72:87], v[28:31], v[16:19], v[72:87]
    ds_read_b64 v[34:35], v5 offset:28416
    v_exp_f32 v92, v92
    v_exp_f32 v93, v93
    v_cvt_pk_bf16_f32 v64, v88, v89
    v_exp_f32 v94, v94
    v_exp_f32 v95, v95
    v_cvt_pk_bf16_f32 v65, v90, v91
    v_mfma_f32_32x32x16_bf16 v[104:119], v[48:51], v[56:59], v[104:119]
    ds_read_b64 v[36:37], v5 offset:29184
    v_exp_f32 v96, v96
    v_exp_f32 v97, v97
    v_cvt_pk_bf16_f32 v66, v92, v93
    v_exp_f32 v98, v98
    v_exp_f32 v99, v99
    v_cvt_pk_bf16_f32 v67, v94, v95
    v_mfma_f32_32x32x16_bf16 v[104:119], v[52:55], v[60:63], v[104:119]
    v_exp_f32 v100, v100
    v_exp_f32 v101, v101
    v_cvt_pk_bf16_f32 v68, v96, v97
    v_exp_f32 v102, v102
    v_exp_f32 v103, v103
    v_cvt_pk_bf16_f32 v69, v98, v99
    v_cvt_pk_bf16_f32 v70, v100, v101
    v_cvt_pk_bf16_f32 v71, v102, v103
    v_mfma_f32_32x32x16_bf16 v[88:103], v[24:27], v[12:15], 0
    ds_read_b128 v[40:43], v3 offset:5120
    v_exp_f32 v72, v72
    v_exp_f32 v73, v73
    v_exp_f32 v74, v74
    v_exp_f32 v75, v75
    v_mfma_f32_32x32x16_bf16 v[88:103], v[28:31], v[20:23], v[88:103]
    ds_read_b128 v[44:47], v3 offset:5760
    v_exp_f32 v76, v76
    v_exp_f32 v77, v77
    v_cvt_pk_bf16_f32 v56, v72, v73
    v_exp_f32 v78, v78
    v_exp_f32 v79, v79
    v_cvt_pk_bf16_f32 v57, v74, v75
    v_mfma_f32_32x32x16_bf16 v[120:135], v[48:51], v[64:67], v[120:135]
    v_exp_f32 v80, v80
    v_exp_f32 v81, v81
    v_cvt_pk_bf16_f32 v58, v76, v77
    v_exp_f32 v82, v82
    v_exp_f32 v83, v83
    v_cvt_pk_bf16_f32 v59, v78, v79
    v_mfma_f32_32x32x16_bf16 v[120:135], v[52:55], v[68:71], v[120:135]
    s_waitcnt vmcnt(0) lgkmcnt(0)
    s_barrier
    v_exp_f32 v84, v84
    v_exp_f32 v85, v85
    v_cvt_pk_bf16_f32 v60, v80, v81
    v_exp_f32 v86, v86
    v_exp_f32 v87, v87
    v_cvt_pk_bf16_f32 v61, v82, v83
    v_cvt_pk_bf16_f32 v62, v84, v85
    v_cvt_pk_bf16_f32 v63, v86, v87
    v_mfma_f32_32x32x16_bf16 v[72:87], v[32:35], v[8:11], 0
    v_exp_f32 v88, v88
    v_exp_f32 v89, v89
    v_exp_f32 v90, v90
    v_exp_f32 v91, v91
    v_mfma_f32_32x32x16_bf16 v[72:87], v[36:39], v[16:19], v[72:87]
    v_exp_f32 v92, v92
    v_exp_f32 v93, v93
    v_cvt_pk_bf16_f32 v64, v88, v89
    v_exp_f32 v94, v94
    v_exp_f32 v95, v95
    v_cvt_pk_bf16_f32 v65, v90, v91
    v_mfma_f32_32x32x16_bf16 v[104:119], v[40:43], v[56:59], v[104:119]
    v_exp_f32 v96, v96
    v_exp_f32 v97, v97
    v_cvt_pk_bf16_f32 v66, v92, v93
    v_exp_f32 v98, v98
    v_exp_f32 v99, v99
    v_cvt_pk_bf16_f32 v67, v94, v95
    v_mfma_f32_32x32x16_bf16 v[104:119], v[44:47], v[60:63], v[104:119]
    v_exp_f32 v100, v100
    v_exp_f32 v101, v101
    v_cvt_pk_bf16_f32 v68, v96, v97
    v_exp_f32 v102, v102
    v_exp_f32 v103, v103
    v_cvt_pk_bf16_f32 v69, v98, v99
    v_cvt_pk_bf16_f32 v70, v100, v101
    v_cvt_pk_bf16_f32 v71, v102, v103
    v_mfma_f32_32x32x16_bf16 v[88:103], v[32:35], v[12:15], 0
    ds_read_b128 v[48:51], v3 offset:7680
    v_exp_f32 v72, v72
    v_exp_f32 v73, v73
    v_exp_f32 v74, v74
    v_exp_f32 v75, v75
    v_mfma_f32_32x32x16_bf16 v[88:103], v[36:39], v[20:23], v[88:103]
    ds_read_b128 v[52:55], v3 offset:8320
    v_exp_f32 v76, v76
    v_exp_f32 v77, v77
    v_cvt_pk_bf16_f32 v56, v72, v73
    v_exp_f32 v78, v78
    v_exp_f32 v79, v79
    v_cvt_pk_bf16_f32 v57, v74, v75
    v_mfma_f32_32x32x16_bf16 v[120:135], v[40:43], v[64:67], v[120:135]
    v_exp_f32 v80, v80
    v_exp_f32 v81, v81
    v_cvt_pk_bf16_f32 v58, v76, v77
    v_exp_f32 v82, v82
    v_exp_f32 v83, v83
    v_cvt_pk_bf16_f32 v59, v78, v79
    v_mfma_f32_32x32x16_bf16 v[120:135], v[44:47], v[68:71], v[120:135]
    s_waitcnt lgkmcnt(0)
    v_exp_f32 v84, v84
    v_exp_f32 v85, v85
    v_cvt_pk_bf16_f32 v60, v80, v81
    v_exp_f32 v86, v86
    v_exp_f32 v87, v87
    v_cvt_pk_bf16_f32 v61, v82, v83
    v_cvt_pk_bf16_f32 v62, v84, v85
    v_cvt_pk_bf16_f32 v63, v86, v87
    v_exp_f32 v88, v88
    v_exp_f32 v89, v89
    v_exp_f32 v90, v90
    v_exp_f32 v91, v91
    v_exp_f32 v92, v92
    v_exp_f32 v93, v93
    v_cvt_pk_bf16_f32 v64, v88, v89
    v_exp_f32 v94, v94
    v_exp_f32 v95, v95
    v_cvt_pk_bf16_f32 v65, v90, v91
    v_mfma_f32_32x32x16_bf16 v[104:119], v[48:51], v[56:59], v[104:119]
    v_exp_f32 v96, v96
    v_exp_f32 v97, v97
    v_cvt_pk_bf16_f32 v66, v92, v93
    v_exp_f32 v98, v98
    v_exp_f32 v99, v99
    v_cvt_pk_bf16_f32 v67, v94, v95
    v_mfma_f32_32x32x16_bf16 v[104:119], v[52:55], v[60:63], v[104:119]
    v_exp_f32 v100, v100
    v_exp_f32 v101, v101
    v_cvt_pk_bf16_f32 v68, v96, v97
    v_exp_f32 v102, v102
    v_exp_f32 v103, v103
    v_cvt_pk_bf16_f32 v69, v98, v99
    v_cvt_pk_bf16_f32 v70, v100, v101
    v_cvt_pk_bf16_f32 v71, v102, v103
    s_waitcnt lgkmcnt(0)
    v_mfma_f32_32x32x16_bf16 v[120:135], v[48:51], v[64:67], v[120:135]
    v_mfma_f32_32x32x16_bf16 v[120:135], v[52:55], v[68:71], v[120:135]
    v_lshlrev_b32 v138, 4, v0
    s_mul_i32 s23, s14, 3072
    s_add_u32 s3, s23, 22528
    s_cmp_ge_u32 s14, 6
    s_cselect_b32 s23, s3, s23
    v_add_u32 v139, s23, v138
    s_xor_b32 s24, s14, 4
    s_mul_i32 s23, s24, 3072
    s_add_u32 s3, s23, 22528
    s_cmp_ge_u32 s24, 6
    s_cselect_b32 s23, s3, s23
    v_add_u32 v140, s23, v138
    s_cmp_eq_u32 s17, 0
    s_cbranch_scc1 K2_M0
    ds_write_b128 v139, v[104:107] offset:0
    ds_write_b128 v139, v[108:111] offset:1024
    ds_write_b128 v139, v[112:115] offset:2048
    s_nop 1
    v_mov_b32 v104, v120
    v_mov_b32 v105, v121
    v_mov_b32 v106, v122
    v_mov_b32 v107, v123
    v_mov_b32 v108, v124
    v_mov_b32 v109, v125
    v_mov_b32 v110, v126
    v_mov_b32 v111, v127
    v_mov_b32 v112, v128
    v_mov_b32 v113, v129
    v_mov_b32 v114, v130
    v_mov_b32 v115, v131
    v_mov_b32 v8, v12
    v_mov_b32 v16, v20
    v_mov_b32 v9, v13
    v_mov_b32 v17, v21
    v_mov_b32 v10, v14
    v_mov_b32 v18, v22
    v_mov_b32 v11, v15
    v_mov_b32 v19, v23
    s_add_u32 s16, s16, 1
    s_branch K2_M1
K2_M0:
    s_nop 7
    ds_write_b128 v139, v[120:123] offset:0
    ds_write_b128 v139, v[124:127] offset:1024
    ds_write_b128 v139, v[128:131] offset:2048
K2_M1:
    s_waitcnt lgkmcnt(0)
    s_barrier
    ds_read_b128 v[72:75], v140 offset:0
    ds_read_b128 v[76:79], v140 offset:1024
    ds_read_b128 v[80:83], v140 offset:2048
    s_waitcnt lgkmcnt(0)
    v_add_f32 v104, v104, v72
    v_add_f32 v105, v105, v73
    v_add_f32 v106, v106, v74
    v_add_f32 v107, v107, v75
    v_add_f32 v108, v108, v76
    v_add_f32 v109, v109, v77
    v_add_f32 v110, v110, v78
    v_add_f32 v111, v111, v79
    v_add_f32 v112, v112, v80
    v_add_f32 v113, v113, v81
    v_add_f32 v114, v114, v82
    v_add_f32 v115, v115, v83
    v_mov_b32 v138, v112
    v_mov_b32 v140, v112
    s_nop 1
    v_permlane32_swap_b32 v138, v140
    s_nop 1
    v_rcp_f32 v138, v140
    s_nop 0
    v_mul_f32 v104, v104, v138
    v_mul_f32 v105, v105, v138
    v_mul_f32 v106, v106, v138
    v_mul_f32 v107, v107, v138
    v_mul_f32 v108, v108, v138
    v_mul_f32 v109, v109, v138
    v_mul_f32 v110, v110, v138
    v_mul_f32 v111, v111, v138
    v_mul_f32 v112, v112, v138
    v_mul_f32 v113, v113, v138
    v_mul_f32 v114, v114, v138
    v_mul_f32 v115, v115, v138
    s_mov_b32 s23, 0x76800000
    v_cmp_gt_u32 vcc, 32, v0
    v_add_f32 v142, |v104|, |v105|
    v_add_f32 v142, v142, |v106|
    v_add_f32 v142, v142, |v107|
    v_add_f32 v142, v142, |v108|
    v_add_f32 v142, v142, |v109|
    v_add_f32 v142, v142, |v110|
    v_add_f32 v142, v142, |v111|
    v_add_f32 v144, |v112|, |v113|
    v_add_f32 v144, v144, |v114|
    v_add_f32 v144, v144, |v115|
    v_cndmask_b32 v144, 0, v144, vcc
    v_add_f32 v142, v142, v144
    v_cmp_gt_f32 vcc, s23, v140
    s_mov_b32 s23, 0x7f000000
    v_cmp_gt_f32 s[30:31], s23, v142
    v_mul_f32 v144, v142, v140
    s_mov_b32 s23, 0x0d800000
    s_and_b64 vcc, vcc, s[30:31]
    v_cmp_le_f32 s[30:31], s23, v144
    s_nop 1
    s_and_b64 vcc, vcc, s[30:31]
    s_cmp_eq_u64 vcc, exec
    s_cbranch_scc0 K2_SLOW
    v_cvt_pk_bf16_f32 v56, v104, v105
    v_cvt_pk_bf16_f32 v57, v106, v107
    v_cvt_pk_bf16_f32 v58, v108, v109
    v_cvt_pk_bf16_f32 v59, v110, v111
    v_cvt_pk_bf16_f32 v60, v112, v113
    v_cvt_pk_bf16_f32 v61, v114, v115
    s_mul_i32 s23, s16, 136
    s_add_u32 s24, s23, s15
    s_add_u32 s24, s24, 96
    s_lshl_b32 s24, s24, 10
    s_add_u32 s24, s24, 9437184
    buffer_store_dwordx4 v[56:59], v136, s[8:11], s24 offen sc1
    s_lshr_b32 s3, s15, 2
    s_add_u32 s23, s23, s3
    s_add_u32 s23, s23, 128
    s_lshl_b32 s23, s23, 10
    s_add_u32 s23, s23, 9437184
    s_bfe_u32 s3, s15, 0x10001
    s_lshl_b32 s3, s3, 9
    s_add_u32 s23, s23, s3
    s_and_b32 s3, s15, 1
    s_lshl_b32 s3, s3, 3
    s_add_u32 s23, s23, s3
    s_mov_b64 exec, 0xffffffff
    buffer_store_dwordx2 v[60:61], v136, s[8:11], s23 offen sc1
    s_mov_b64 exec, -1
K2_DONE:
    s_branch K2_FIN
K2_SLOW:
    v_and_b32 v147, 31, v0
    v_lshrrev_b32 v138, 5, v0
    v_mul_u32_u24 v141, 320, v138
    v_min_u32 v140, 19, v147
    v_lshl_add_u32 v152, v140, 4, v141
    v_add_u32 v152, 1280, v152
    v_and_b32 v139, 15, v0
    v_lshlrev_b32 v139, 4, v139
    v_bfe_u32 v142, v0, 4, 1
    v_lshl_add_u32 v139, v142, 3, v139
    v_lshl_add_u32 v153, v138, 9, v139
    v_mov_b32 v150, 0xff800000
    v_mov_b32 v18, 0
    v_mov_b32 v19, 0
    s_mov_b32 s28, s25
    s_mov_b32 s19, 0
K2_SLOW_A:
    buffer_load_dwordx2 v[24:25], v153, s[8:11], s28 offen
    buffer_load_dwordx2 v[26:27], v153, s[8:11], s28 offen offset:256
    buffer_load_dwordx2 v[28:29], v153, s[8:11], s28 offen offset:1024
    s_waitcnt vmcnt(0)
    v_mfma_f32_32x32x16_bf16 v[72:87], v[24:27], v[8:11], 0
    v_mfma_f32_32x32x16_bf16 v[72:87], v[28:31], v[16:19], v[72:87]
    s_nop 7
    s_nop 7
    v_max3_f32 v150, v72, v73, v150
    v_max3_f32 v150, v74, v75, v150
    v_max3_f32 v150, v76, v77, v150
    v_max3_f32 v150, v78, v79, v150
    v_max3_f32 v150, v80, v81, v150
    v_max3_f32 v150, v82, v83, v150
    v_max3_f32 v150, v84, v85, v150
    v_max3_f32 v150, v86, v87, v150
    s_add_u32 s28, s28, 2560
    s_add_u32 s19, s19, 1
    s_cmp_lt_u32 s19, 64
    s_cbranch_scc1 K2_SLOW_A
    v_mov_b32 v138, v150
    s_nop 1
    v_permlane32_swap_b32 v138, v150
    s_nop 1
    v_max_f32 v150, v150, v138
    v_mov_b32 v104, 0
    v_mov_b32 v105, 0
    v_mov_b32 v106, 0
    v_mov_b32 v107, 0
    v_mov_b32 v108, 0
    v_mov_b32 v109, 0
    v_mov_b32 v110, 0
    v_mov_b32 v111, 0
    v_mov_b32 v112, 0
    v_mov_b32 v113, 0
    v_mov_b32 v114, 0
    v_mov_b32 v115, 0
    v_mov_b32 v116, 0
    v_mov_b32 v117, 0
    v_mov_b32 v118, 0
    v_mov_b32 v119, 0
    s_mov_b32 s28, s25
    s_mov_b32 s19, 0
    s_mov_b32 s30, 0x00100000
    s_mov_b32 s31, 0x00100000
K2_SLOW_B:
    buffer_load_dwordx2 v[24:25], v153, s[8:11], s28 offen
    buffer_load_dwordx2 v[26:27], v153, s[8:11], s28 offen offset:256
    buffer_load_dwordx2 v[28:29], v153, s[8:11], s28 offen offset:1024
    buffer_load_dwordx4 v[40:43], v152, s[8:11], s28 offen
    buffer_load_dwordx4 v[44:47], v152, s[8:11], s28 offen offset:640
    s_waitcnt vmcnt(0)
    v_mov_b32 v138, 0x3f803f80
    v_cndmask_b32 v40, v40, v138, s[30:31]
    v_cndmask_b32 v44, v44, v138, s[30:31]
    v_cndmask_b32 v41, v41, v138, s[30:31]
    v_cndmask_b32 v45, v45, v138, s[30:31]
    v_cndmask_b32 v42, v42, v138, s[30:31]
    v_cndmask_b32 v46, v46, v138, s[30:31]
    v_cndmask_b32 v43, v43, v138, s[30:31]
    v_cndmask_b32 v47, v47, v138, s[30:31]
    v_mfma_f32_32x32x16_bf16 v[72:87], v[24:27], v[8:11], 0
    v_mfma_f32_32x32x16_bf16 v[72:87], v[28:31], v[16:19], v[72:87]
    s_nop 7
    s_nop 7
    v_sub_f32 v72, v72, v150
    v_sub_f32 v73, v73, v150
    v_sub_f32 v74, v74, v150
    v_sub_f32 v75, v75, v150
    v_sub_f32 v76, v76, v150
    v_sub_f32 v77, v77, v150
    v_sub_f32 v78, v78, v150
    v_sub_f32 v79, v79, v150
    v_sub_f32 v80, v80, v150
    v_sub_f32 v81, v81, v150
    v_sub_f32 v82, v82, v150
    v_sub_f32 v83, v83, v150
    v_sub_f32 v84, v84, v150
    v_sub_f32 v85, v85, v150
    v_sub_f32 v86, v86, v150
    v_sub_f32 v87, v87, v150
    v_exp_f32 v72, v72
    v_exp_f32 v73, v73
    v_exp_f32 v74, v74
    v_exp_f32 v75, v75
    v_exp_f32 v76, v76
    v_exp_f32 v77, v77
    v_exp_f32 v78, v78
    v_exp_f32 v79, v79
    v_exp_f32 v80, v80
    v_exp_f32 v81, v81
    v_exp_f32 v82, v82
    v_exp_f32 v83, v83
    v_exp_f32 v84, v84
    v_exp_f32 v85, v85
    v_exp_f32 v86, v86
    v_exp_f32 v87, v87
    s_nop 0
    v_cvt_pk_bf16_f32 v56, v72, v73
    v_cvt_pk_bf16_f32 v57, v74, v75
    v_cvt_pk_bf16_f32 v58, v76, v77
    v_cvt_pk_bf16_f32 v59, v78, v79
    v_cvt_pk_bf16_f32 v60, v80, v81
    v_cvt_pk_bf16_f32 v61, v82, v83
    v_cvt_pk_bf16_f32 v62, v84, v85
    v_cvt_pk_bf16_f32 v63, v86, v87
    s_nop 1
    v_mfma_f32_32x32x16_bf16 v[104:119], v[40:43], v[56:59], v[104:119]
    v_mfma_f32_32x32x16_bf16 v[104:119], v[44:47], v[60:63], v[104:119]
    s_add_u32 s28, s28, 2560
    s_add_u32 s19, s19, 1
    s_cmp_lt_u32 s19, 64
    s_cbranch_scc1 K2_SLOW_B
    s_nop 7
    s_nop 7
    v_mov_b32 v138, v112
    v_mov_b32 v140, v112
    s_nop 1
    v_permlane32_swap_b32 v138, v140
    s_nop 1
    v_rcp_f32 v138, v140
    s_nop 0
    v_mul_f32 v104, v104, v138
    v_mul_f32 v105, v105, v138
    v_mul_f32 v106, v106, v138
    v_mul_f32 v107, v107, v138
    v_mul_f32 v108, v108, v138
    v_mul_f32 v109, v109, v138
    v_mul_f32 v110, v110, v138
    v_mul_f32 v111, v111, v138
    v_mul_f32 v112, v112, v138
    v_mul_f32 v113, v113, v138
    v_mul_f32 v114, v114, v138
    v_mul_f32 v115, v115, v138
    v_cvt_pk_bf16_f32 v56, v104, v105
    v_cvt_pk_bf16_f32 v57, v106, v107
    v_cvt_pk_bf16_f32 v58, v108, v109
    v_cvt_pk_bf16_f32 v59, v110, v111
    v_cvt_pk_bf16_f32 v60, v112, v113
    v_cvt_pk_bf16_f32 v61, v114, v115
    s_mul_i32 s23, s16, 136
    s_add_u32 s24, s23, s15
    s_add_u32 s24, s24, 96
    s_lshl_b32 s24, s24, 10
    s_add_u32 s24, s24, 9437184
    buffer_store_dwordx4 v[56:59], v136, s[8:11], s24 offen sc1
    s_lshr_b32 s3, s15, 2
    s_add_u32 s23, s23, s3
    s_add_u32 s23, s23, 128
    s_lshl_b32 s23, s23, 10
    s_add_u32 s23, s23, 9437184
    s_bfe_u32 s3, s15, 0x10001
    s_lshl_b32 s3, s3, 9
    s_add_u32 s23, s23, s3
    s_and_b32 s3, s15, 1
    s_lshl_b32 s3, s3, 3
    s_add_u32 s23, s23, s3
    s_mov_b64 exec, 0xffffffff
    buffer_store_dwordx2 v[60:61], v136, s[8:11], s23 offen sc1
    s_mov_b64 exec, -1
    s_branch K2_DONE
    s_branch K2_FIN
K2_DOWN:
    s_sub_u32 s56, s14, 8
    s_and_b32 s3, s2, 7
    s_lshr_b32 s15, s2, 3
    s_mul_i32 s3, s3, 28
    s_add_u32 s15, s15, s3
    s_lshr_b32 s16, s2, 3
    s_cmp_ge_u32 s16, 28
    s_cbranch_scc1 K2_FIN
    s_cmp_ge_u32 s15, 220
    s_cbranch_scc1 K2_FIN
    s_load_dwordx2 s[6:7], s[0:1], 0
    s_load_dwordx2 s[72:73], s[0:1], 16
    s_load_dwordx4 s[68:71], s[0:1], 48
    v_lshlrev_b32 v160, 4, v0
    s_getpc_b64 s[96:97]
K2PF_PC:
    s_sub_u32 s96, s96, K2PF_PC-k2_attn_kernel
    s_subb_u32 s97, s97, 0
    s_and_b32 s97, s97, 0xffff
    s_mov_b32 s98, K2_END-k2_attn_kernel
    s_mov_b32 s99, 0x20000
    s_lshl_b32 s100, s56, 10
    buffer_load_dwordx4 v[70:73], v160, s[96:99], s100 offen
    s_add_u32 s100, s100, 4096
    buffer_load_dwordx4 v[74:77], v160, s[96:99], s100 offen
    s_add_u32 s100, s100, 4096
    buffer_load_dwordx4 v[78:81], v160, s[96:99], s100 offen
    s_add_u32 s100, s100, 4096
    buffer_load_dwordx4 v[82:85], v160, s[96:99], s100 offen
    s_add_u32 s100, s100, 4096
    buffer_load_dwordx4 v[86:89], v160, s[96:99], s100 offen
    s_add_u32 s100, s100, 4096
    buffer_load_dwordx4 v[90:93], v160, s[96:99], s100 offen
    s_add_u32 s100, s100, 4096
    buffer_load_dwordx4 v[94:97], v160, s[96:99], s100 offen
    s_add_u32 s100, s100, 4096
    buffer_load_dwordx4 v[98:101], v160, s[96:99], s100 offen
    s_add_u32 s100, s100, 4096
    s_barrier
    s_barrier
    s_waitcnt vmcnt(0)
    s_mul_hi_u32 s57, s15, 429496730
    s_mul_i32 s64, s57, 10
    s_sub_u32 s58, s15, s64
    s_waitcnt lgkmcnt(0)
    s_mov_b32 s44, s4
    s_and_b32 s45, s5, 0xffff
    s_mov_b32 s46, 18350080
    s_mov_b32 s47, 0x20000
    s_mov_b32 s48, s68
    s_and_b32 s49, s69, 0xffff
    s_mov_b32 s50, 1966080
    s_mov_b32 s51, 0x20000
    s_mov_b32 s40, s70
    s_and_b32 s41, s71, 0xffff
    s_mov_b32 s42, 2621440
    s_mov_b32 s43, 0x20000
    s_mov_b32 s36, s6
    s_and_b32 s37, s7, 0xffff
    s_mov_b32 s38, 2621440
    s_mov_b32 s39, 0x20000
    s_mov_b32 s52, s72
    s_and_b32 s53, s73, 0xffff
    s_mov_b32 s54, 819200
    s_mov_b32 s55, 0x20000
    v_lshlrev_b32 v1, 4, v0
    v_lshrrev_b32 v80, 3, v0
    v_and_b32 v81, 7, v0
    v_bfe_u32 v82, v80, 1, 1
    v_lshlrev_b32 v82, 2, v82
    v_xor_b32 v82, v82, v81
    v_lshlrev_b32 v82, 4, v82
    v_mul_u32_u24 v83, 1280, v80
    v_add_u32 v2, v83, v82
    v_lshrrev_b32 v83, 2, v80
    v_mul_u32_u24 v83, 40, v83
    v_and_b32 v84, 3, v80
    v_add_u32 v83, v83, v84
    v_mul_u32_u24 v83, 1280, v83
    v_add_u32 v3, v83, v82
    v_and_b32 v85, 15, v0
    v_lshrrev_b32 v86, 2, v85
    v_lshrrev_b32 v87, 5, v0
    v_lshl_add_u32 v86, v87, 2, v86
    v_lshlrev_b32 v86, 7, v86
    v_bfe_u32 v87, v0, 4, 1
    v_lshl_add_u32 v86, v87, 5, v86
    v_and_b32 v87, 3, v85
    v_lshl_add_u32 v86, v87, 3, v86
    v_lshrrev_b32 v87, 3, v85
    v_lshl_add_u32 v4, v87, 6, v86
    v_xor_b32 v87, 1, v87
    v_lshl_add_u32 v5, v87, 6, v86
    s_mul_i32 s67, s56, 20480
    s_add_u32 s67, s67, 75776
    v_add_u32 v4, s67, v4
    v_add_u32 v5, s67, v5
    s_lshl_b32 s58, s58, 7
    s_mul_i32 s59, s57, 3
    s_add_u32 s59, s59, 0
    s_mul_i32 s59, s59, 139264
    s_add_u32 s59, s59, 9437184
    s_mul_i32 s60, s57, 3
    s_add_u32 s60, s60, 1
    s_mul_i32 s60, s60, 139264
    s_add_u32 s60, s60, 9437184
    s_mul_i32 s61, s57, 3
    s_add_u32 s61, s61, 2
    s_mul_i32 s61, s61, 139264
    s_add_u32 s61, s61, 9437184
    s_mul_i32 s64, s56, 24
    s_add_u32 s64, s64, 0
    s_lshl_b32 s65, s64, 10
    s_mul_i32 s62, s64, 20480
    s_add_u32 s62, s62, s58
    s_add_u32 s63, s62, 10240
    s_add_u32 m0, s67, 0
    s_add_u32 s66, s59, s65
    buffer_load_dwordx4 v2, s[48:51], s62 offen lds
    s_add_u32 m0, s67, 1024
    s_nop 0
    buffer_load_dwordx4 v2, s[48:51], s63 offen lds
    buffer_load_dwordx4 v[22:25], v1, s[44:47], s66 offen
    s_add_u32 s66, s60, s65
    buffer_load_dwordx4 v[26:29], v1, s[44:47], s66 offen
    s_add_u32 s66, s61, s65
    buffer_load_dwordx4 v[30:33], v1, s[44:47], s66 offen
    s_mul_i32 s64, s56, 24
    s_add_u32 s64, s64, 1
    s_lshl_b32 s65, s64, 10
    s_mul_i32 s62, s64, 20480
    s_add_u32 s62, s62, s58
    s_add_u32 s63, s62, 10240
    s_add_u32 m0, s67, 2048
    s_add_u32 s66, s59, s65
    buffer_load_dwordx4 v2, s[48:51], s62 offen lds
    s_add_u32 m0, s67, 3072
    s_nop 0
    buffer_load_dwordx4 v2, s[48:51], s63 offen lds
    buffer_load_dwordx4 v[34:37], v1, s[44:47], s66 offen
    s_add_u32 s66, s60, s65
    buffer_load_dwordx4 v[38:41], v1, s[44:47], s66 offen
    s_add_u32 s66, s61, s65
    buffer_load_dwordx4 v[42:45], v1, s[44:47], s66 offen
    s_mul_i32 s64, s56, 24
    s_add_u32 s64, s64, 2
    s_lshl_b32 s65, s64, 10
    s_mul_i32 s62, s64, 20480
    s_add_u32 s62, s62, s58
    s_add_u32 s63, s62, 10240
    s_add_u32 m0, s67, 4096
    s_add_u32 s66, s59, s65
    buffer_load_dwordx4 v2, s[48:51], s62 offen lds
    s_add_u32 m0, s67, 5120
    s_nop 0
    buffer_load_dwordx4 v2, s[48:51], s63 offen lds
    buffer_load_dwordx4 v[46:49], v1, s[44:47], s66 offen
    s_add_u32 s66, s60, s65
    buffer_load_dwordx4 v[50:53], v1, s[44:47], s66 offen
    s_add_u32 s66, s61, s65
    buffer_load_dwordx4 v[54:57], v1, s[44:47], s66 offen
    v_mov_b32 v70, 0
    v_mov_b32 v71, 0
    v_mov_b32 v72, 0
    v_mov_b32 v73, 0
    v_mov_b32 v74, 0
    v_mov_b32 v75, 0
    v_mov_b32 v76, 0
    v_mov_b32 v77, 0
    v_mov_b32 v78, 0
    v_mov_b32 v79, 0
    v_mov_b32 v80, 0
    v_mov_b32 v81, 0
    v_mov_b32 v82, 0
    v_mov_b32 v83, 0
    v_mov_b32 v84, 0
    v_mov_b32 v85, 0
    v_mov_b32 v86, 0
    v_mov_b32 v87, 0
    v_mov_b32 v88, 0
    v_mov_b32 v89, 0
    v_mov_b32 v90, 0
    v_mov_b32 v91, 0
    v_mov_b32 v92, 0
    v_mov_b32 v93, 0
    v_mov_b32 v94, 0
    v_mov_b32 v95, 0
    v_mov_b32 v96, 0
    v_mov_b32 v97, 0
    v_mov_b32 v98, 0
    v_mov_b32 v99, 0
    v_mov_b32 v100, 0
    v_mov_b32 v101, 0
    v_mov_b32 v102, 0
    v_mov_b32 v103, 0
    v_mov_b32 v104, 0
    v_mov_b32 v105, 0
    v_mov_b32 v106, 0
    v_mov_b32 v107, 0
    v_mov_b32 v108, 0
    v_mov_b32 v109, 0
    v_mov_b32 v110, 0
    v_mov_b32 v111, 0
    v_mov_b32 v112, 0
    v_mov_b32 v113, 0
    v_mov_b32 v114, 0
    v_mov_b32 v115, 0
    v_mov_b32 v116, 0
    v_mov_b32 v117, 0
    v_mov_b32 v118, 0
    v_mov_b32 v119, 0
    v_mov_b32 v120, 0
    v_mov_b32 v121, 0
    v_mov_b32 v122, 0
    v_mov_b32 v123, 0
    v_mov_b32 v124, 0
    v_mov_b32 v125, 0
    v_mov_b32 v126, 0
    v_mov_b32 v127, 0
    v_mov_b32 v128, 0
    v_mov_b32 v129, 0
    v_mov_b32 v130, 0
    v_mov_b32 v131, 0
    v_mov_b32 v132, 0
    v_mov_b32 v133, 0
    v_mov_b32 v134, 0
    v_mov_b32 v135, 0
    v_mov_b32 v136, 0
    v_mov_b32 v137, 0
    v_mov_b32 v138, 0
    v_mov_b32 v139, 0
    v_mov_b32 v140, 0
    v_mov_b32 v141, 0
    v_mov_b32 v142, 0
    v_mov_b32 v143, 0
    v_mov_b32 v144, 0
    v_mov_b32 v145, 0
    v_mov_b32 v146, 0
    v_mov_b32 v147, 0
    v_mov_b32 v148, 0
    v_mov_b32 v149, 0
    v_mov_b32 v150, 0
    v_mov_b32 v151, 0
    v_mov_b32 v152, 0
    v_mov_b32 v153, 0
    v_mov_b32 v154, 0
    v_mov_b32 v155, 0
    v_mov_b32 v156, 0
    v_mov_b32 v157, 0
    v_mov_b32 v158, 0
    v_mov_b32 v159, 0
    v_mov_b32 v160, 0
    v_mov_b32 v161, 0
    v_mov_b32 v162, 0
    v_mov_b32 v163, 0
    v_mov_b32 v164, 0
    v_mov_b32 v165, 0
    s_barrier
    s_waitcnt vmcnt(10)
    ds_read_b64_tr_b16 v[6:7], v4 offset:0
    ds_read_b64_tr_b16 v[8:9], v4 offset:1024
    ds_read_b64_tr_b16 v[10:11], v5 offset:0
    ds_read_b64_tr_b16 v[12:13], v5 offset:1024
    s_waitcnt vmcnt(5) lgkmcnt(0)
    v_mfma_f32_32x32x16_bf16 v[70:85], v[6:9], v[22:25], v[70:85]
    ds_read_b64_tr_b16 v[14:15], v4 offset:2048
    ds_read_b64_tr_b16 v[16:17], v4 offset:3072
    v_mfma_f32_32x32x16_bf16 v[86:101], v[10:13], v[22:25], v[86:101]
    ds_read_b64_tr_b16 v[18:19], v5 offset:2048
    ds_read_b64_tr_b16 v[20:21], v5 offset:3072
    v_mfma_f32_32x32x16_bf16 v[102:117], v[6:9], v[26:29], v[102:117]
    s_mul_i32 s64, s56, 24
    s_add_u32 s64, s64, 3
    s_lshl_b32 s65, s64, 10
    s_mul_i32 s62, s64, 20480
    s_add_u32 s62, s62, s58
    s_add_u32 s63, s62, 10240
    s_add_u32 m0, s67, 6144
    s_add_u32 s66, s59, s65
    buffer_load_dwordx4 v2, s[48:51], s62 offen lds
    s_add_u32 m0, s67, 7168
    s_nop 0
    buffer_load_dwordx4 v2, s[48:51], s63 offen lds
    v_mfma_f32_32x32x16_bf16 v[118:133], v[10:13], v[26:29], v[118:133]
    buffer_load_dwordx4 v[58:61], v1, s[44:47], s66 offen
    s_add_u32 s66, s60, s65
    buffer_load_dwordx4 v[62:65], v1, s[44:47], s66 offen
    v_mfma_f32_32x32x16_bf16 v[134:149], v[6:9], v[30:33], v[134:149]
    s_add_u32 s66, s61, s65
    buffer_load_dwordx4 v[66:69], v1, s[44:47], s66 offen
    v_mfma_f32_32x32x16_bf16 v[150:165], v[10:13], v[30:33], v[150:165]
    s_waitcnt vmcnt(5) lgkmcnt(0)
    v_mfma_f32_32x32x16_bf16 v[70:85], v[14:17], v[34:37], v[70:85]
    ds_read_b64_tr_b16 v[6:7], v4 offset:4096
    ds_read_b64_tr_b16 v[8:9], v4 offset:5120
    v_mfma_f32_32x32x16_bf16 v[86:101], v[18:21], v[34:37], v[86:101]
    ds_read_b64_tr_b16 v[10:11], v5 offset:4096
    ds_read_b64_tr_b16 v[12:13], v5 offset:5120
    v_mfma_f32_32x32x16_bf16 v[102:117], v[14:17], v[38:41], v[102:117]
    s_mul_i32 s64, s56, 24
    s_add_u32 s64, s64, 4
    s_lshl_b32 s65, s64, 10
    s_mul_i32 s62, s64, 20480
    s_add_u32 s62, s62, s58
    s_add_u32 s63, s62, 10240
    s_add_u32 m0, s67, 0
    s_add_u32 s66, s59, s65
    buffer_load_dwordx4 v2, s[48:51], s62 offen lds
    s_add_u32 m0, s67, 1024
    s_nop 0
    buffer_load_dwordx4 v2, s[48:51], s63 offen lds
    v_mfma_f32_32x32x16_bf16 v[118:133], v[18:21], v[38:41], v[118:133]
    buffer_load_dwordx4 v[22:25], v1, s[44:47], s66 offen
    s_add_u32 s66, s60, s65
    buffer_load_dwordx4 v[26:29], v1, s[44:47], s66 offen
    v_mfma_f32_32x32x16_bf16 v[134:149], v[14:17], v[42:45], v[134:149]
    s_add_u32 s66, s61, s65
    buffer_load_dwordx4 v[30:33], v1, s[44:47], s66 offen
    v_mfma_f32_32x32x16_bf16 v[150:165], v[18:21], v[42:45], v[150:165]
    s_waitcnt vmcnt(5) lgkmcnt(0)
    v_mfma_f32_32x32x16_bf16 v[70:85], v[6:9], v[46:49], v[70:85]
    ds_read_b64_tr_b16 v[14:15], v4 offset:6144
    ds_read_b64_tr_b16 v[16:17], v4 offset:7168
    v_mfma_f32_32x32x16_bf16 v[86:101], v[10:13], v[46:49], v[86:101]
    ds_read_b64_tr_b16 v[18:19], v5 offset:6144
    ds_read_b64_tr_b16 v[20:21], v5 offset:7168
    v_mfma_f32_32x32x16_bf16 v[102:117], v[6:9], v[50:53], v[102:117]
    s_mul_i32 s64, s56, 24
    s_add_u32 s64, s64, 5
    s_lshl_b32 s65, s64, 10
    s_mul_i32 s62, s64, 20480
    s_add_u32 s62, s62, s58
    s_add_u32 s63, s62, 10240
    s_add_u32 m0, s67, 2048
    s_add_u32 s66, s59, s65
    buffer_load_dwordx4 v2, s[48:51], s62 offen lds
    s_add_u32 m0, s67, 3072
    s_nop 0
    buffer_load_dwordx4 v2, s[48:51], s63 offen lds
    v_mfma_f32_32x32x16_bf16 v[118:133], v[10:13], v[50:53], v[118:133]
    buffer_load_dwordx4 v[34:37], v1, s[44:47], s66 offen
    s_add_u32 s66, s60, s65
    buffer_load_dwordx4 v[38:41], v1, s[44:47], s66 offen
    v_mfma_f32_32x32x16_bf16 v[134:149], v[6:9], v[54:57], v[134:149]
    s_add_u32 s66, s61, s65
    buffer_load_dwordx4 v[42:45], v1, s[44:47], s66 offen
    v_mfma_f32_32x32x16_bf16 v[150:165], v[10:13], v[54:57], v[150:165]
    s_barrier
    s_waitcnt vmcnt(5) lgkmcnt(0)
    v_mfma_f32_32x32x16_bf16 v[70:85], v[14:17], v[58:61], v[70:85]
    ds_read_b64_tr_b16 v[6:7], v4 offset:0
    ds_read_b64_tr_b16 v[8:9], v4 offset:1024
    v_mfma_f32_32x32x16_bf16 v[86:101], v[18:21], v[58:61], v[86:101]
    ds_read_b64_tr_b16 v[10:11], v5 offset:0
    ds_read_b64_tr_b16 v[12:13], v5 offset:1024
    v_mfma_f32_32x32x16_bf16 v[102:117], v[14:17], v[62:65], v[102:117]
    s_mul_i32 s64, s56, 24
    s_add_u32 s64, s64, 6
    s_lshl_b32 s65, s64, 10
    s_mul_i32 s62, s64, 20480
    s_add_u32 s62, s62, s58
    s_add_u32 s63, s62, 10240
    s_add_u32 m0, s67, 4096
    s_add_u32 s66, s59, s65
    buffer_load_dwordx4 v2, s[48:51], s62 offen lds
    s_add_u32 m0, s67, 5120
    s_nop 0
    buffer_load_dwordx4 v2, s[48:51], s63 offen lds
    v_mfma_f32_32x32x16_bf16 v[118:133], v[18:21], v[62:65], v[118:133]
    buffer_load_dwordx4 v[46:49], v1, s[44:47], s66 offen
    s_add_u32 s66, s60, s65
    buffer_load_dwordx4 v[50:53], v1, s[44:47], s66 offen
    v_mfma_f32_32x32x16_bf16 v[134:149], v[14:17], v[66:69], v[134:149]
    s_add_u32 s66, s61, s65
    buffer_load_dwordx4 v[54:57], v1, s[44:47], s66 offen
    v_mfma_f32_32x32x16_bf16 v[150:165], v[18:21], v[66:69], v[150:165]
    s_waitcnt vmcnt(5) lgkmcnt(0)
    v_mfma_f32_32x32x16_bf16 v[70:85], v[6:9], v[22:25], v[70:85]
    ds_read_b64_tr_b16 v[14:15], v4 offset:2048
    ds_read_b64_tr_b16 v[16:17], v4 offset:3072
    v_mfma_f32_32x32x16_bf16 v[86:101], v[10:13], v[22:25], v[86:101]
    ds_read_b64_tr_b16 v[18:19], v5 offset:2048
    ds_read_b64_tr_b16 v[20:21], v5 offset:3072
    v_mfma_f32_32x32x16_bf16 v[102:117], v[6:9], v[26:29], v[102:117]
    s_mul_i32 s64, s56, 24
    s_add_u32 s64, s64, 7
    s_lshl_b32 s65, s64, 10
    s_mul_i32 s62, s64, 20480
    s_add_u32 s62, s62, s58
    s_add_u32 s63, s62, 10240
    s_add_u32 m0, s67, 6144
    s_add_u32 s66, s59, s65
    buffer_load_dwordx4 v2, s[48:51], s62 offen lds
    s_add_u32 m0, s67, 7168
    s_nop 0
    buffer_load_dwordx4 v2, s[48:51], s63 offen lds
    v_mfma_f32_32x32x16_bf16 v[118:133], v[10:13], v[26:29], v[118:133]
    buffer_load_dwordx4 v[58:61], v1, s[44:47], s66 offen
    s_add_u32 s66, s60, s65
    buffer_load_dwordx4 v[62:65], v1, s[44:47], s66 offen
    v_mfma_f32_32x32x16_bf16 v[134:149], v[6:9], v[30:33], v[134:149]
    s_add_u32 s66, s61, s65
    buffer_load_dwordx4 v[66:69], v1, s[44:47], s66 offen
    v_mfma_f32_32x32x16_bf16 v[150:165], v[10:13], v[30:33], v[150:165]
    s_waitcnt vmcnt(5) lgkmcnt(0)
    v_mfma_f32_32x32x16_bf16 v[70:85], v[14:17], v[34:37], v[70:85]
    ds_read_b64_tr_b16 v[6:7], v4 offset:4096
    ds_read_b64_tr_b16 v[8:9], v4 offset:5120
    v_mfma_f32_32x32x16_bf16 v[86:101], v[18:21], v[34:37], v[86:101]
    ds_read_b64_tr_b16 v[10:11], v5 offset:4096
    ds_read_b64_tr_b16 v[12:13], v5 offset:5120
    v_mfma_f32_32x32x16_bf16 v[102:117], v[14:17], v[38:41], v[102:117]
    s_mul_i32 s64, s56, 24
    s_add_u32 s64, s64, 8
    s_lshl_b32 s65, s64, 10
    s_mul_i32 s62, s64, 20480
    s_add_u32 s62, s62, s58
    s_add_u32 s63, s62, 10240
    s_add_u32 m0, s67, 0
    s_add_u32 s66, s59, s65
    buffer_load_dwordx4 v2, s[48:51], s62 offen lds
    s_add_u32 m0, s67, 1024
    s_nop 0
    buffer_load_dwordx4 v2, s[48:51], s63 offen lds
    v_mfma_f32_32x32x16_bf16 v[118:133], v[18:21], v[38:41], v[118:133]
    buffer_load_dwordx4 v[22:25], v1, s[44:47], s66 offen
    s_add_u32 s66, s60, s65
    buffer_load_dwordx4 v[26:29], v1, s[44:47], s66 offen
    v_mfma_f32_32x32x16_bf16 v[134:149], v[14:17], v[42:45], v[134:149]
    s_add_u32 s66, s61, s65
    buffer_load_dwordx4 v[30:33], v1, s[44:47], s66 offen
    v_mfma_f32_32x32x16_bf16 v[150:165], v[18:21], v[42:45], v[150:165]
    s_barrier
    s_waitcnt vmcnt(5) lgkmcnt(0)
    v_mfma_f32_32x32x16_bf16 v[70:85], v[6:9], v[46:49], v[70:85]
    ds_read_b64_tr_b16 v[14:15], v4 offset:6144
    ds_read_b64_tr_b16 v[16:17], v4 offset:7168
    v_mfma_f32_32x32x16_bf16 v[86:101], v[10:13], v[46:49], v[86:101]
    ds_read_b64_tr_b16 v[18:19], v5 offset:6144
    ds_read_b64_tr_b16 v[20:21], v5 offset:7168
    v_mfma_f32_32x32x16_bf16 v[102:117], v[6:9], v[50:53], v[102:117]
    s_mul_i32 s64, s56, 24
    s_add_u32 s64, s64, 9
    s_lshl_b32 s65, s64, 10
    s_mul_i32 s62, s64, 20480
    s_add_u32 s62, s62, s58
    s_add_u32 s63, s62, 10240
    s_add_u32 m0, s67, 2048
    s_add_u32 s66, s59, s65
    buffer_load_dwordx4 v2, s[48:51], s62 offen lds
    s_add_u32 m0, s67, 3072
    s_nop 0
    buffer_load_dwordx4 v2, s[48:51], s63 offen lds
    v_mfma_f32_32x32x16_bf16 v[118:133], v[10:13], v[50:53], v[118:133]
    buffer_load_dwordx4 v[34:37], v1, s[44:47], s66 offen
    s_add_u32 s66, s60, s65
    buffer_load_dwordx4 v[38:41], v1, s[44:47], s66 offen
    v_mfma_f32_32x32x16_bf16 v[134:149], v[6:9], v[54:57], v[134:149]
    s_add_u32 s66, s61, s65
    buffer_load_dwordx4 v[42:45], v1, s[44:47], s66 offen
    v_mfma_f32_32x32x16_bf16 v[150:165], v[10:13], v[54:57], v[150:165]
    s_waitcnt vmcnt(5) lgkmcnt(0)
    v_mfma_f32_32x32x16_bf16 v[70:85], v[14:17], v[58:61], v[70:85]
    ds_read_b64_tr_b16 v[6:7], v4 offset:0
    ds_read_b64_tr_b16 v[8:9], v4 offset:1024
    v_mfma_f32_32x32x16_bf16 v[86:101], v[18:21], v[58:61], v[86:101]
    ds_read_b64_tr_b16 v[10:11], v5 offset:0
    ds_read_b64_tr_b16 v[12:13], v5 offset:1024
    v_mfma_f32_32x32x16_bf16 v[102:117], v[14:17], v[62:65], v[102:117]
    s_mul_i32 s64, s56, 24
    s_add_u32 s64, s64, 10
    s_lshl_b32 s65, s64, 10
    s_mul_i32 s62, s64, 20480
    s_add_u32 s62, s62, s58
    s_add_u32 s63, s62, 10240
    s_add_u32 m0, s67, 4096
    s_add_u32 s66, s59, s65
    buffer_load_dwordx4 v2, s[48:51], s62 offen lds
    s_add_u32 m0, s67, 5120
    s_nop 0
    buffer_load_dwordx4 v2, s[48:51], s63 offen lds
    v_mfma_f32_32x32x16_bf16 v[118:133], v[18:21], v[62:65], v[118:133]
    buffer_load_dwordx4 v[46:49], v1, s[44:47], s66 offen
    s_add_u32 s66, s60, s65
    buffer_load_dwordx4 v[50:53], v1, s[44:47], s66 offen
    v_mfma_f32_32x32x16_bf16 v[134:149], v[14:17], v[66:69], v[134:149]
    s_add_u32 s66, s61, s65
    buffer_load_dwordx4 v[54:57], v1, s[44:47], s66 offen
    v_mfma_f32_32x32x16_bf16 v[150:165], v[18:21], v[66:69], v[150:165]
    s_waitcnt vmcnt(5) lgkmcnt(0)
    v_mfma_f32_32x32x16_bf16 v[70:85], v[6:9], v[22:25], v[70:85]
    ds_read_b64_tr_b16 v[14:15], v4 offset:2048
    ds_read_b64_tr_b16 v[16:17], v4 offset:3072
    v_mfma_f32_32x32x16_bf16 v[86:101], v[10:13], v[22:25], v[86:101]
    ds_read_b64_tr_b16 v[18:19], v5 offset:2048
    ds_read_b64_tr_b16 v[20:21], v5 offset:3072
    v_mfma_f32_32x32x16_bf16 v[102:117], v[6:9], v[26:29], v[102:117]
    s_mul_i32 s64, s56, 24
    s_add_u32 s64, s64, 11
    s_lshl_b32 s65, s64, 10
    s_mul_i32 s62, s64, 20480
    s_add_u32 s62, s62, s58
    s_add_u32 s63, s62, 10240
    s_add_u32 m0, s67, 6144
    s_add_u32 s66, s59, s65
    buffer_load_dwordx4 v2, s[48:51], s62 offen lds
    s_add_u32 m0, s67, 7168
    s_nop 0
    buffer_load_dwordx4 v2, s[48:51], s63 offen lds
    v_mfma_f32_32x32x16_bf16 v[118:133], v[10:13], v[26:29], v[118:133]
    buffer_load_dwordx4 v[58:61], v1, s[44:47], s66 offen
    s_add_u32 s66, s60, s65
    buffer_load_dwordx4 v[62:65], v1, s[44:47], s66 offen
    v_mfma_f32_32x32x16_bf16 v[134:149], v[6:9], v[30:33], v[134:149]
    s_add_u32 s66, s61, s65
    buffer_load_dwordx4 v[66:69], v1, s[44:47], s66 offen
    v_mfma_f32_32x32x16_bf16 v[150:165], v[10:13], v[30:33], v[150:165]
    s_barrier
    s_waitcnt vmcnt(5) lgkmcnt(0)
    v_mfma_f32_32x32x16_bf16 v[70:85], v[14:17], v[34:37], v[70:85]
    ds_read_b64_tr_b16 v[6:7], v4 offset:4096
    ds_read_b64_tr_b16 v[8:9], v4 offset:5120
    v_mfma_f32_32x32x16_bf16 v[86:101], v[18:21], v[34:37], v[86:101]
    ds_read_b64_tr_b16 v[10:11], v5 offset:4096
    ds_read_b64_tr_b16 v[12:13], v5 offset:5120
    v_mfma_f32_32x32x16_bf16 v[102:117], v[14:17], v[38:41], v[102:117]
    s_mul_i32 s64, s56, 24
    s_add_u32 s64, s64, 12
    s_lshl_b32 s65, s64, 10
    s_mul_i32 s62, s64, 20480
    s_add_u32 s62, s62, s58
    s_add_u32 s63, s62, 10240
    s_add_u32 m0, s67, 0
    s_add_u32 s66, s59, s65
    buffer_load_dwordx4 v2, s[48:51], s62 offen lds
    s_add_u32 m0, s67, 1024
    s_nop 0
    buffer_load_dwordx4 v2, s[48:51], s63 offen lds
    v_mfma_f32_32x32x16_bf16 v[118:133], v[18:21], v[38:41], v[118:133]
    buffer_load_dwordx4 v[22:25], v1, s[44:47], s66 offen
    s_add_u32 s66, s60, s65
    buffer_load_dwordx4 v[26:29], v1, s[44:47], s66 offen
    v_mfma_f32_32x32x16_bf16 v[134:149], v[14:17], v[42:45], v[134:149]
    s_add_u32 s66, s61, s65
    buffer_load_dwordx4 v[30:33], v1, s[44:47], s66 offen
    v_mfma_f32_32x32x16_bf16 v[150:165], v[18:21], v[42:45], v[150:165]
    s_waitcnt vmcnt(5) lgkmcnt(0)
    v_mfma_f32_32x32x16_bf16 v[70:85], v[6:9], v[46:49], v[70:85]
    ds_read_b64_tr_b16 v[14:15], v4 offset:6144
    ds_read_b64_tr_b16 v[16:17], v4 offset:7168
    v_mfma_f32_32x32x16_bf16 v[86:101], v[10:13], v[46:49], v[86:101]
    ds_read_b64_tr_b16 v[18:19], v5 offset:6144
    ds_read_b64_tr_b16 v[20:21], v5 offset:7168
    v_mfma_f32_32x32x16_bf16 v[102:117], v[6:9], v[50:53], v[102:117]
    s_mul_i32 s64, s56, 24
    s_add_u32 s64, s64, 13
    s_lshl_b32 s65, s64, 10
    s_mul_i32 s62, s64, 20480
    s_add_u32 s62, s62, s58
    s_add_u32 s63, s62, 10240
    s_add_u32 m0, s67, 2048
    s_add_u32 s66, s59, s65
    buffer_load_dwordx4 v2, s[48:51], s62 offen lds
    s_add_u32 m0, s67, 3072
    s_nop 0
    buffer_load_dwordx4 v2, s[48:51], s63 offen lds
    v_mfma_f32_32x32x16_bf16 v[118:133], v[10:13], v[50:53], v[118:133]
    buffer_load_dwordx4 v[34:37], v1, s[44:47], s66 offen
    s_add_u32 s66, s60, s65
    buffer_load_dwordx4 v[38:41], v1, s[44:47], s66 offen
    v_mfma_f32_32x32x16_bf16 v[134:149], v[6:9], v[54:57], v[134:149]
    s_add_u32 s66, s61, s65
    buffer_load_dwordx4 v[42:45], v1, s[44:47], s66 offen
    v_mfma_f32_32x32x16_bf16 v[150:165], v[10:13], v[54:57], v[150:165]
    s_waitcnt vmcnt(5) lgkmcnt(0)
    v_mfma_f32_32x32x16_bf16 v[70:85], v[14:17], v[58:61], v[70:85]
    ds_read_b64_tr_b16 v[6:7], v4 offset:0
    ds_read_b64_tr_b16 v[8:9], v4 offset:1024
    v_mfma_f32_32x32x16_bf16 v[86:101], v[18:21], v[58:61], v[86:101]
    ds_read_b64_tr_b16 v[10:11], v5 offset:0
    ds_read_b64_tr_b16 v[12:13], v5 offset:1024
    v_mfma_f32_32x32x16_bf16 v[102:117], v[14:17], v[62:65], v[102:117]
    s_mul_i32 s64, s56, 24
    s_add_u32 s64, s64, 14
    s_lshl_b32 s65, s64, 10
    s_mul_i32 s62, s64, 20480
    s_add_u32 s62, s62, s58
    s_add_u32 s63, s62, 10240
    s_add_u32 m0, s67, 4096
    s_add_u32 s66, s59, s65
    buffer_load_dwordx4 v2, s[48:51], s62 offen lds
    s_add_u32 m0, s67, 5120
    s_nop 0
    buffer_load_dwordx4 v2, s[48:51], s63 offen lds
    v_mfma_f32_32x32x16_bf16 v[118:133], v[18:21], v[62:65], v[118:133]
    buffer_load_dwordx4 v[46:49], v1, s[44:47], s66 offen
    s_add_u32 s66, s60, s65
    buffer_load_dwordx4 v[50:53], v1, s[44:47], s66 offen
    v_mfma_f32_32x32x16_bf16 v[134:149], v[14:17], v[66:69], v[134:149]
    s_add_u32 s66, s61, s65
    buffer_load_dwordx4 v[54:57], v1, s[44:47], s66 offen
    v_mfma_f32_32x32x16_bf16 v[150:165], v[18:21], v[66:69], v[150:165]
    s_barrier
    s_waitcnt vmcnt(5) lgkmcnt(0)
    v_mfma_f32_32x32x16_bf16 v[70:85], v[6:9], v[22:25], v[70:85]
    ds_read_b64_tr_b16 v[14:15], v4 offset:2048
    ds_read_b64_tr_b16 v[16:17], v4 offset:3072
    v_mfma_f32_32x32x16_bf16 v[86:101], v[10:13], v[22:25], v[86:101]
    ds_read_b64_tr_b16 v[18:19], v5 offset:2048
    ds_read_b64_tr_b16 v[20:21], v5 offset:3072
    v_mfma_f32_32x32x16_bf16 v[102:117], v[6:9], v[26:29], v[102:117]
    s_mul_i32 s64, s56, 24
    s_add_u32 s64, s64, 15
    s_lshl_b32 s65, s64, 10
    s_mul_i32 s62, s64, 20480
    s_add_u32 s62, s62, s58
    s_add_u32 s63, s62, 10240
    s_add_u32 m0, s67, 6144
    s_add_u32 s66, s59, s65
    buffer_load_dwordx4 v2, s[48:51], s62 offen lds
    s_add_u32 m0, s67, 7168
    s_nop 0
    buffer_load_dwordx4 v2, s[48:51], s63 offen lds
    v_mfma_f32_32x32x16_bf16 v[118:133], v[10:13], v[26:29], v[118:133]
    buffer_load_dwordx4 v[58:61], v1, s[44:47], s66 offen
    s_add_u32 s66, s60, s65
    buffer_load_dwordx4 v[62:65], v1, s[44:47], s66 offen
    v_mfma_f32_32x32x16_bf16 v[134:149], v[6:9], v[30:33], v[134:149]
    s_add_u32 s66, s61, s65
    buffer_load_dwordx4 v[66:69], v1, s[44:47], s66 offen
    v_mfma_f32_32x32x16_bf16 v[150:165], v[10:13], v[30:33], v[150:165]
    s_waitcnt vmcnt(5) lgkmcnt(0)
    v_mfma_f32_32x32x16_bf16 v[70:85], v[14:17], v[34:37], v[70:85]
    ds_read_b64_tr_b16 v[6:7], v4 offset:4096
    ds_read_b64_tr_b16 v[8:9], v4 offset:5120
    v_mfma_f32_32x32x16_bf16 v[86:101], v[18:21], v[34:37], v[86:101]
    ds_read_b64_tr_b16 v[10:11], v5 offset:4096
    ds_read_b64_tr_b16 v[12:13], v5 offset:5120
    v_mfma_f32_32x32x16_bf16 v[102:117], v[14:17], v[38:41], v[102:117]
    s_mul_i32 s64, s56, 24
    s_add_u32 s64, s64, 16
    s_lshl_b32 s65, s64, 10
    s_mul_i32 s62, s64, 20480
    s_add_u32 s62, s62, s58
    s_add_u32 s63, s62, 10240
    s_add_u32 m0, s67, 0
    s_add_u32 s66, s59, s65
    buffer_load_dwordx4 v2, s[48:51], s62 offen lds
    s_add_u32 m0, s67, 1024
    s_nop 0
    buffer_load_dwordx4 v2, s[48:51], s63 offen lds
    v_mfma_f32_32x32x16_bf16 v[118:133], v[18:21], v[38:41], v[118:133]
    buffer_load_dwordx4 v[22:25], v1, s[44:47], s66 offen
    s_add_u32 s66, s60, s65
    buffer_load_dwordx4 v[26:29], v1, s[44:47], s66 offen
    v_mfma_f32_32x32x16_bf16 v[134:149], v[14:17], v[42:45], v[134:149]
    s_add_u32 s66, s61, s65
    buffer_load_dwordx4 v[30:33], v1, s[44:47], s66 offen
    v_mfma_f32_32x32x16_bf16 v[150:165], v[18:21], v[42:45], v[150:165]
    s_barrier
    s_waitcnt vmcnt(5) lgkmcnt(0)
    v_mfma_f32_32x32x16_bf16 v[70:85], v[6:9], v[46:49], v[70:85]
    ds_read_b64_tr_b16 v[14:15], v4 offset:6144
    ds_read_b64_tr_b16 v[16:17], v4 offset:7168
    v_mfma_f32_32x32x16_bf16 v[86:101], v[10:13], v[46:49], v[86:101]
    ds_read_b64_tr_b16 v[18:19], v5 offset:6144
    ds_read_b64_tr_b16 v[20:21], v5 offset:7168
    v_mfma_f32_32x32x16_bf16 v[102:117], v[6:9], v[50:53], v[102:117]
    s_mul_i32 s64, s56, 24
    s_add_u32 s64, s64, 17
    s_lshl_b32 s65, s64, 10
    s_mul_i32 s62, s64, 20480
    s_add_u32 s62, s62, s58
    s_add_u32 s63, s62, 10240
    s_add_u32 m0, s67, 2048
    s_add_u32 s66, s59, s65
    buffer_load_dwordx4 v2, s[48:51], s62 offen lds
    s_add_u32 m0, s67, 3072
    s_nop 0
    buffer_load_dwordx4 v2, s[48:51], s63 offen lds
    v_mfma_f32_32x32x16_bf16 v[118:133], v[10:13], v[50:53], v[118:133]
    buffer_load_dwordx4 v[34:37], v1, s[44:47], s66 offen
    s_add_u32 s66, s60, s65
    buffer_load_dwordx4 v[38:41], v1, s[44:47], s66 offen
    v_mfma_f32_32x32x16_bf16 v[134:149], v[6:9], v[54:57], v[134:149]
    s_add_u32 s66, s61, s65
    buffer_load_dwordx4 v[42:45], v1, s[44:47], s66 offen
    v_mfma_f32_32x32x16_bf16 v[150:165], v[10:13], v[54:57], v[150:165]
    s_waitcnt vmcnt(5) lgkmcnt(0)
    v_mfma_f32_32x32x16_bf16 v[70:85], v[14:17], v[58:61], v[70:85]
    ds_read_b64_tr_b16 v[6:7], v4 offset:0
    ds_read_b64_tr_b16 v[8:9], v4 offset:1024
    v_mfma_f32_32x32x16_bf16 v[86:101], v[18:21], v[58:61], v[86:101]
    ds_read_b64_tr_b16 v[10:11], v5 offset:0
    ds_read_b64_tr_b16 v[12:13], v5 offset:1024
    v_mfma_f32_32x32x16_bf16 v[102:117], v[14:17], v[62:65], v[102:117]
    s_mul_i32 s64, s56, 24
    s_add_u32 s64, s64, 18
    s_lshl_b32 s65, s64, 10
    s_mul_i32 s62, s64, 20480
    s_add_u32 s62, s62, s58
    s_add_u32 s63, s62, 10240
    s_add_u32 m0, s67, 4096
    s_add_u32 s66, s59, s65
    buffer_load_dwordx4 v2, s[48:51], s62 offen lds
    s_add_u32 m0, s67, 5120
    s_nop 0
    buffer_load_dwordx4 v2, s[48:51], s63 offen lds
    v_mfma_f32_32x32x16_bf16 v[118:133], v[18:21], v[62:65], v[118:133]
    buffer_load_dwordx4 v[46:49], v1, s[44:47], s66 offen
    s_add_u32 s66, s60, s65
    buffer_load_dwordx4 v[50:53], v1, s[44:47], s66 offen
    v_mfma_f32_32x32x16_bf16 v[134:149], v[14:17], v[66:69], v[134:149]
    s_add_u32 s66, s61, s65
    buffer_load_dwordx4 v[54:57], v1, s[44:47], s66 offen
    v_mfma_f32_32x32x16_bf16 v[150:165], v[18:21], v[66:69], v[150:165]
    s_barrier
    s_waitcnt vmcnt(5) lgkmcnt(0)
    v_mfma_f32_32x32x16_bf16 v[70:85], v[6:9], v[22:25], v[70:85]
    ds_read_b64_tr_b16 v[14:15], v4 offset:2048
    ds_read_b64_tr_b16 v[16:17], v4 offset:3072
    v_mfma_f32_32x32x16_bf16 v[86:101], v[10:13], v[22:25], v[86:101]
    ds_read_b64_tr_b16 v[18:19], v5 offset:2048
    ds_read_b64_tr_b16 v[20:21], v5 offset:3072
    v_mfma_f32_32x32x16_bf16 v[102:117], v[6:9], v[26:29], v[102:117]
    s_mul_i32 s64, s56, 24
    s_add_u32 s64, s64, 19
    s_lshl_b32 s65, s64, 10
    s_mul_i32 s62, s64, 20480
    s_add_u32 s62, s62, s58
    s_add_u32 s63, s62, 10240
    s_add_u32 m0, s67, 6144
    s_add_u32 s66, s59, s65
    buffer_load_dwordx4 v2, s[48:51], s62 offen lds
    s_add_u32 m0, s67, 7168
    s_nop 0
    buffer_load_dwordx4 v2, s[48:51], s63 offen lds
    v_mfma_f32_32x32x16_bf16 v[118:133], v[10:13], v[26:29], v[118:133]
    buffer_load_dwordx4 v[58:61], v1, s[44:47], s66 offen
    s_add_u32 s66, s60, s65
    buffer_load_dwordx4 v[62:65], v1, s[44:47], s66 offen
    v_mfma_f32_32x32x16_bf16 v[134:149], v[6:9], v[30:33], v[134:149]
    s_add_u32 s66, s61, s65
    buffer_load_dwordx4 v[66:69], v1, s[44:47], s66 offen
    v_mfma_f32_32x32x16_bf16 v[150:165], v[10:13], v[30:33], v[150:165]
    s_waitcnt vmcnt(5) lgkmcnt(0)
    v_mfma_f32_32x32x16_bf16 v[70:85], v[14:17], v[34:37], v[70:85]
    ds_read_b64_tr_b16 v[6:7], v4 offset:4096
    ds_read_b64_tr_b16 v[8:9], v4 offset:5120
    v_mfma_f32_32x32x16_bf16 v[86:101], v[18:21], v[34:37], v[86:101]
    ds_read_b64_tr_b16 v[10:11], v5 offset:4096
    ds_read_b64_tr_b16 v[12:13], v5 offset:5120
    v_mfma_f32_32x32x16_bf16 v[102:117], v[14:17], v[38:41], v[102:117]
    s_mul_i32 s64, s56, 24
    s_add_u32 s64, s64, 20
    s_lshl_b32 s65, s64, 10
    s_mul_i32 s62, s64, 20480
    s_add_u32 s62, s62, s58
    s_add_u32 s63, s62, 10240
    s_add_u32 m0, s67, 0
    s_add_u32 s66, s59, s65
    buffer_load_dwordx4 v2, s[48:51], s62 offen lds
    s_add_u32 m0, s67, 1024
    s_nop 0
    buffer_load_dwordx4 v2, s[48:51], s63 offen lds
    v_mfma_f32_32x32x16_bf16 v[118:133], v[18:21], v[38:41], v[118:133]
    buffer_load_dwordx4 v[22:25], v1, s[44:47], s66 offen
    s_add_u32 s66, s60, s65
    buffer_load_dwordx4 v[26:29], v1, s[44:47], s66 offen
    v_mfma_f32_32x32x16_bf16 v[134:149], v[14:17], v[42:45], v[134:149]
    s_add_u32 s66, s61, s65
    buffer_load_dwordx4 v[30:33], v1, s[44:47], s66 offen
    v_mfma_f32_32x32x16_bf16 v[150:165], v[18:21], v[42:45], v[150:165]
    s_barrier
    s_waitcnt vmcnt(5) lgkmcnt(0)
    v_mfma_f32_32x32x16_bf16 v[70:85], v[6:9], v[46:49], v[70:85]
    ds_read_b64_tr_b16 v[14:15], v4 offset:6144
    ds_read_b64_tr_b16 v[16:17], v4 offset:7168
    v_mfma_f32_32x32x16_bf16 v[86:101], v[10:13], v[46:49], v[86:101]
    ds_read_b64_tr_b16 v[18:19], v5 offset:6144
    ds_read_b64_tr_b16 v[20:21], v5 offset:7168
    v_mfma_f32_32x32x16_bf16 v[102:117], v[6:9], v[50:53], v[102:117]
    s_mul_i32 s64, s56, 24
    s_add_u32 s64, s64, 21
    s_lshl_b32 s65, s64, 10
    s_mul_i32 s62, s64, 20480
    s_add_u32 s62, s62, s58
    s_add_u32 s63, s62, 10240
    s_add_u32 m0, s67, 2048
    s_add_u32 s66, s59, s65
    buffer_load_dwordx4 v2, s[48:51], s62 offen lds
    s_add_u32 m0, s67, 3072
    s_nop 0
    buffer_load_dwordx4 v2, s[48:51], s63 offen lds
    v_mfma_f32_32x32x16_bf16 v[118:133], v[10:13], v[50:53], v[118:133]
    buffer_load_dwordx4 v[34:37], v1, s[44:47], s66 offen
    s_add_u32 s66, s60, s65
    buffer_load_dwordx4 v[38:41], v1, s[44:47], s66 offen
    v_mfma_f32_32x32x16_bf16 v[134:149], v[6:9], v[54:57], v[134:149]
    s_add_u32 s66, s61, s65
    buffer_load_dwordx4 v[42:45], v1, s[44:47], s66 offen
    v_mfma_f32_32x32x16_bf16 v[150:165], v[10:13], v[54:57], v[150:165]
    s_waitcnt vmcnt(5) lgkmcnt(0)
    v_mfma_f32_32x32x16_bf16 v[70:85], v[14:17], v[58:61], v[70:85]
    ds_read_b64_tr_b16 v[6:7], v4 offset:0
    ds_read_b64_tr_b16 v[8:9], v4 offset:1024
    v_mfma_f32_32x32x16_bf16 v[86:101], v[18:21], v[58:61], v[86:101]
    ds_read_b64_tr_b16 v[10:11], v5 offset:0
    ds_read_b64_tr_b16 v[12:13], v5 offset:1024
    v_mfma_f32_32x32x16_bf16 v[102:117], v[14:17], v[62:65], v[102:117]
    s_mul_i32 s64, s56, 24
    s_add_u32 s64, s64, 22
    s_lshl_b32 s65, s64, 10
    s_mul_i32 s62, s64, 20480
    s_add_u32 s62, s62, s58
    s_add_u32 s63, s62, 10240
    s_add_u32 m0, s67, 4096
    s_add_u32 s66, s59, s65
    buffer_load_dwordx4 v2, s[48:51], s62 offen lds
    s_add_u32 m0, s67, 5120
    s_nop 0
    buffer_load_dwordx4 v2, s[48:51], s63 offen lds
    v_mfma_f32_32x32x16_bf16 v[118:133], v[18:21], v[62:65], v[118:133]
    buffer_load_dwordx4 v[46:49], v1, s[44:47], s66 offen
    s_add_u32 s66, s60, s65
    buffer_load_dwordx4 v[50:53], v1, s[44:47], s66 offen
    v_mfma_f32_32x32x16_bf16 v[134:149], v[14:17], v[66:69], v[134:149]
    s_add_u32 s66, s61, s65
    buffer_load_dwordx4 v[54:57], v1, s[44:47], s66 offen
    v_mfma_f32_32x32x16_bf16 v[150:165], v[18:21], v[66:69], v[150:165]
    s_mul_i32 s64, s56, 8
    s_add_u32 s64, s64, 4
    s_add_u32 s65, s64, 96
    s_lshl_b32 s65, s65, 10
    s_mul_i32 s62, s64, 25600
    s_add_u32 s62, s62, s58
    s_add_u32 s63, s62, 10240
    s_add_u32 m0, s67, 8192
    s_nop 0
    buffer_load_dwordx4 v2, s[52:55], s62 offen lds
    s_add_u32 m0, s67, 9216
    s_nop 0
    buffer_load_dwordx4 v2, s[52:55], s63 offen lds
    s_mul_i32 s64, s56, 8
    s_add_u32 s64, s64, 5
    s_add_u32 s65, s64, 96
    s_lshl_b32 s65, s65, 10
    s_mul_i32 s62, s64, 25600
    s_add_u32 s62, s62, s58
    s_add_u32 s63, s62, 10240
    s_add_u32 m0, s67, 10240
    s_nop 0
    buffer_load_dwordx4 v2, s[52:55], s62 offen lds
    s_add_u32 m0, s67, 11264
    s_nop 0
    buffer_load_dwordx4 v2, s[52:55], s63 offen lds
    s_mul_i32 s64, s56, 8
    s_add_u32 s64, s64, 6
    s_add_u32 s65, s64, 96
    s_lshl_b32 s65, s65, 10
    s_mul_i32 s62, s64, 25600
    s_add_u32 s62, s62, s58
    s_add_u32 s63, s62, 10240
    s_add_u32 m0, s67, 12288
    s_nop 0
    buffer_load_dwordx4 v2, s[52:55], s62 offen lds
    s_add_u32 m0, s67, 13312
    s_nop 0
    buffer_load_dwordx4 v2, s[52:55], s63 offen lds
    s_mul_i32 s64, s56, 8
    s_add_u32 s64, s64, 7
    s_add_u32 s65, s64, 96
    s_lshl_b32 s65, s65, 10
    s_mul_i32 s62, s64, 25600
    s_add_u32 s62, s62, s58
    s_add_u32 s63, s62, 10240
    s_add_u32 m0, s67, 14336
    s_nop 0
    buffer_load_dwordx4 v2, s[52:55], s62 offen lds
    s_add_u32 m0, s67, 15360
    s_nop 0
    buffer_load_dwordx4 v2, s[52:55], s63 offen lds
    s_mul_i32 s64, s56, 2
    s_add_u32 s64, s64, 0
    s_add_u32 s65, s64, 128
    s_lshl_b32 s65, s65, 10
    s_mul_i32 s62, s64, 102400
    s_add_u32 s62, s62, 20480
    s_add_u32 s62, s62, s58
    s_add_u32 s63, s62, 25600
    s_add_u32 m0, s67, 16384
    s_nop 0
    buffer_load_dwordx4 v3, s[52:55], s62 offen lds
    s_add_u32 m0, s67, 17408
    s_nop 0
    buffer_load_dwordx4 v3, s[52:55], s63 offen lds
    s_mul_i32 s64, s56, 2
    s_add_u32 s64, s64, 1
    s_add_u32 s65, s64, 128
    s_lshl_b32 s65, s65, 10
    s_mul_i32 s62, s64, 102400
    s_add_u32 s62, s62, 20480
    s_add_u32 s62, s62, s58
    s_add_u32 s63, s62, 25600
    s_add_u32 m0, s67, 18432
    s_nop 0
    buffer_load_dwordx4 v3, s[52:55], s62 offen lds
    s_add_u32 m0, s67, 19456
    s_nop 0
    buffer_load_dwordx4 v3, s[52:55], s63 offen lds
    s_barrier
    s_waitcnt vmcnt(17) lgkmcnt(0)
    v_mfma_f32_32x32x16_bf16 v[70:85], v[6:9], v[22:25], v[70:85]
    ds_read_b64_tr_b16 v[14:15], v4 offset:2048
    ds_read_b64_tr_b16 v[16:17], v4 offset:3072
    v_mfma_f32_32x32x16_bf16 v[86:101], v[10:13], v[22:25], v[86:101]
    ds_read_b64_tr_b16 v[18:19], v5 offset:2048
    ds_read_b64_tr_b16 v[20:21], v5 offset:3072
    v_mfma_f32_32x32x16_bf16 v[102:117], v[6:9], v[26:29], v[102:117]
    s_mul_i32 s64, s56, 24
    s_add_u32 s64, s64, 23
    s_lshl_b32 s65, s64, 10
    s_mul_i32 s62, s64, 20480
    s_add_u32 s62, s62, s58
    s_add_u32 s63, s62, 10240
    s_add_u32 m0, s67, 6144
    s_add_u32 s66, s59, s65
    buffer_load_dwordx4 v2, s[48:51], s62 offen lds
    s_add_u32 m0, s67, 7168
    s_nop 0
    buffer_load_dwordx4 v2, s[48:51], s63 offen lds
    v_mfma_f32_32x32x16_bf16 v[118:133], v[10:13], v[26:29], v[118:133]
    buffer_load_dwordx4 v[58:61], v1, s[44:47], s66 offen
    s_add_u32 s66, s60, s65
    buffer_load_dwordx4 v[62:65], v1, s[44:47], s66 offen
    v_mfma_f32_32x32x16_bf16 v[134:149], v[6:9], v[30:33], v[134:149]
    s_add_u32 s66, s61, s65
    buffer_load_dwordx4 v[66:69], v1, s[44:47], s66 offen
    v_mfma_f32_32x32x16_bf16 v[150:165], v[10:13], v[30:33], v[150:165]
    s_waitcnt vmcnt(17) lgkmcnt(0)
    v_mfma_f32_32x32x16_bf16 v[70:85], v[14:17], v[34:37], v[70:85]
    ds_read_b64_tr_b16 v[6:7], v4 offset:4096
    ds_read_b64_tr_b16 v[8:9], v4 offset:5120
    v_mfma_f32_32x32x16_bf16 v[86:101], v[18:21], v[34:37], v[86:101]
    ds_read_b64_tr_b16 v[10:11], v5 offset:4096
    ds_read_b64_tr_b16 v[12:13], v5 offset:5120
    v_mfma_f32_32x32x16_bf16 v[102:117], v[14:17], v[38:41], v[102:117]
    v_mfma_f32_32x32x16_bf16 v[118:133], v[18:21], v[38:41], v[118:133]
    v_mfma_f32_32x32x16_bf16 v[134:149], v[14:17], v[42:45], v[134:149]
    v_mfma_f32_32x32x16_bf16 v[150:165], v[18:21], v[42:45], v[150:165]
    s_waitcnt vmcnt(0) lgkmcnt(0)
    v_mfma_f32_32x32x16_bf16 v[70:85], v[6:9], v[46:49], v[70:85]
    ds_read_b64_tr_b16 v[14:15], v4 offset:6144
    ds_read_b64_tr_b16 v[16:17], v4 offset:7168
    v_mfma_f32_32x32x16_bf16 v[86:101], v[10:13], v[46:49], v[86:101]
    ds_read_b64_tr_b16 v[18:19], v5 offset:6144
    ds_read_b64_tr_b16 v[20:21], v5 offset:7168
    v_mfma_f32_32x32x16_bf16 v[102:117], v[6:9], v[50:53], v[102:117]
    v_mfma_f32_32x32x16_bf16 v[118:133], v[10:13], v[50:53], v[118:133]
    v_mfma_f32_32x32x16_bf16 v[134:149], v[6:9], v[54:57], v[134:149]
    v_mfma_f32_32x32x16_bf16 v[150:165], v[10:13], v[54:57], v[150:165]
    s_waitcnt lgkmcnt(0)
    v_mfma_f32_32x32x16_bf16 v[70:85], v[14:17], v[58:61], v[70:85]
    v_mfma_f32_32x32x16_bf16 v[86:101], v[18:21], v[58:61], v[86:101]
    v_mfma_f32_32x32x16_bf16 v[102:117], v[14:17], v[62:65], v[102:117]
    v_mfma_f32_32x32x16_bf16 v[118:133], v[18:21], v[62:65], v[118:133]
    v_mfma_f32_32x32x16_bf16 v[134:149], v[14:17], v[66:69], v[134:149]
    v_mfma_f32_32x32x16_bf16 v[150:165], v[18:21], v[66:69], v[150:165]
    s_mul_i32 s64, s56, 8
    s_add_u32 s64, s64, 0
    s_add_u32 s65, s64, 96
    s_lshl_b32 s65, s65, 10
    s_mul_i32 s62, s64, 25600
    s_add_u32 s62, s62, s58
    s_add_u32 s63, s62, 10240
    s_add_u32 m0, s67, 0
    s_nop 0
    buffer_load_dwordx4 v2, s[52:55], s62 offen lds
    s_add_u32 m0, s67, 1024
    s_nop 0
    buffer_load_dwordx4 v2, s[52:55], s63 offen lds
    s_mul_i32 s64, s56, 8
    s_add_u32 s64, s64, 1
    s_add_u32 s65, s64, 96
    s_lshl_b32 s65, s65, 10
    s_mul_i32 s62, s64, 25600
    s_add_u32 s62, s62, s58
    s_add_u32 s63, s62, 10240
    s_add_u32 m0, s67, 2048
    s_nop 0
    buffer_load_dwordx4 v2, s[52:55], s62 offen lds
    s_add_u32 m0, s67, 3072
    s_nop 0
    buffer_load_dwordx4 v2, s[52:55], s63 offen lds
    s_mul_i32 s64, s56, 8
    s_add_u32 s64, s64, 2
    s_add_u32 s65, s64, 96
    s_lshl_b32 s65, s65, 10
    s_mul_i32 s62, s64, 25600
    s_add_u32 s62, s62, s58
    s_add_u32 s63, s62, 10240
    s_add_u32 m0, s67, 4096
    s_nop 0
    buffer_load_dwordx4 v2, s[52:55], s62 offen lds
    s_add_u32 m0, s67, 5120
    s_nop 0
    buffer_load_dwordx4 v2, s[52:55], s63 offen lds
    s_mul_i32 s64, s56, 8
    s_add_u32 s64, s64, 3
    s_add_u32 s65, s64, 96
    s_lshl_b32 s65, s65, 10
    s_mul_i32 s62, s64, 25600
    s_add_u32 s62, s62, s58
    s_add_u32 s63, s62, 10240
    s_add_u32 m0, s67, 6144
    s_nop 0
    buffer_load_dwordx4 v2, s[52:55], s62 offen lds
    s_add_u32 m0, s67, 7168
    s_nop 0
    buffer_load_dwordx4 v2, s[52:55], s63 offen lds
    s_mul_i32 s64, s56, 8
    s_add_u32 s64, s64, 0
    s_add_u32 s65, s64, 96
    s_lshl_b32 s65, s65, 10
    s_mul_i32 s62, s64, 25600
    s_add_u32 s62, s62, s58
    s_add_u32 s63, s62, 10240
    s_add_u32 s66, s59, s65
    buffer_load_dwordx4 v[22:25], v1, s[44:47], s66 offen sc1
    s_add_u32 s66, s60, s65
    buffer_load_dwordx4 v[26:29], v1, s[44:47], s66 offen sc1
    s_add_u32 s66, s61, s65
    buffer_load_dwordx4 v[30:33], v1, s[44:47], s66 offen sc1
    s_mul_i32 s64, s56, 8
    s_add_u32 s64, s64, 1
    s_add_u32 s65, s64, 96
    s_lshl_b32 s65, s65, 10
    s_mul_i32 s62, s64, 25600
    s_add_u32 s62, s62, s58
    s_add_u32 s63, s62, 10240
    s_add_u32 s66, s59, s65
    buffer_load_dwordx4 v[34:37], v1, s[44:47], s66 offen sc1
    s_add_u32 s66, s60, s65
    buffer_load_dwordx4 v[38:41], v1, s[44:47], s66 offen sc1
    s_add_u32 s66, s61, s65
    buffer_load_dwordx4 v[42:45], v1, s[44:47], s66 offen sc1
    s_mul_i32 s64, s56, 8
    s_add_u32 s64, s64, 2
    s_add_u32 s65, s64, 96
    s_lshl_b32 s65, s65, 10
    s_mul_i32 s62, s64, 25600
    s_add_u32 s62, s62, s58
    s_add_u32 s63, s62, 10240
    s_add_u32 s66, s59, s65
    buffer_load_dwordx4 v[46:49], v1, s[44:47], s66 offen sc1
    s_add_u32 s66, s60, s65
    buffer_load_dwordx4 v[50:53], v1, s[44:47], s66 offen sc1
    s_add_u32 s66, s61, s65
    buffer_load_dwordx4 v[54:57], v1, s[44:47], s66 offen sc1
    s_mul_i32 s64, s56, 8
    s_add_u32 s64, s64, 3
    s_add_u32 s65, s64, 96
    s_lshl_b32 s65, s65, 10
    s_mul_i32 s62, s64, 25600
    s_add_u32 s62, s62, s58
    s_add_u32 s63, s62, 10240
    s_add_u32 s66, s59, s65
    buffer_load_dwordx4 v[58:61], v1, s[44:47], s66 offen sc1
    s_add_u32 s66, s60, s65
    buffer_load_dwordx4 v[62:65], v1, s[44:47], s66 offen sc1
    s_add_u32 s66, s61, s65
    buffer_load_dwordx4 v[66:69], v1, s[44:47], s66 offen sc1
    s_waitcnt vmcnt(12)
    ds_read_b64_tr_b16 v[6:7], v4 offset:0
    ds_read_b64_tr_b16 v[8:9], v4 offset:1024
    ds_read_b64_tr_b16 v[10:11], v5 offset:0
    ds_read_b64_tr_b16 v[12:13], v5 offset:1024
    s_mov_b32 s16, 0x8000
    s_waitcnt vmcnt(9) lgkmcnt(0)
K2D_CHK0:
    v_max3_u32 v166, v22, v23, v24
    v_max3_u32 v166, v166, v25, v26
    v_max3_u32 v166, v166, v27, v28
    v_max3_u32 v166, v166, v29, v30
    v_max3_u32 v166, v166, v31, v32
    v_max_u32 v166, v166, v33
    v_cmp_eq_u32 vcc, -1, v166
    s_nop 1
    s_cmp_eq_u64 vcc, 0
    s_cbranch_scc1 K2D_OK0
    s_sub_u32 s16, s16, 1
    s_cmp_eq_u32 s16, 0
    s_cbranch_scc1 K2D_OK0
    s_sleep 2
    s_mul_i32 s64, s56, 8
    s_add_u32 s64, s64, 0
    s_add_u32 s65, s64, 96
    s_lshl_b32 s65, s65, 10
    s_mul_i32 s62, s64, 25600
    s_add_u32 s62, s62, s58
    s_add_u32 s63, s62, 10240
    s_add_u32 s66, s59, s65
    buffer_load_dwordx4 v[22:25], v1, s[44:47], s66 offen sc1
    s_add_u32 s66, s60, s65
    buffer_load_dwordx4 v[26:29], v1, s[44:47], s66 offen sc1
    s_add_u32 s66, s61, s65
    buffer_load_dwordx4 v[30:33], v1, s[44:47], s66 offen sc1
    s_waitcnt vmcnt(0)
    s_branch K2D_CHK0
K2D_OK0:
    v_mfma_f32_32x32x16_bf16 v[70:85], v[6:9], v[22:25], v[70:85]
    ds_read_b64_tr_b16 v[14:15], v4 offset:2048
    ds_read_b64_tr_b16 v[16:17], v4 offset:3072
    v_mfma_f32_32x32x16_bf16 v[86:101], v[10:13], v[22:25], v[86:101]
    ds_read_b64_tr_b16 v[18:19], v5 offset:2048
    ds_read_b64_tr_b16 v[20:21], v5 offset:3072
    v_mfma_f32_32x32x16_bf16 v[102:117], v[6:9], v[26:29], v[102:117]
    v_mfma_f32_32x32x16_bf16 v[118:133], v[10:13], v[26:29], v[118:133]
    v_mfma_f32_32x32x16_bf16 v[134:149], v[6:9], v[30:33], v[134:149]
    v_mfma_f32_32x32x16_bf16 v[150:165], v[10:13], v[30:33], v[150:165]
    s_mul_i32 s64, s56, 8
    s_add_u32 s64, s64, 4
    s_add_u32 s65, s64, 96
    s_lshl_b32 s65, s65, 10
    s_mul_i32 s62, s64, 25600
    s_add_u32 s62, s62, s58
    s_add_u32 s63, s62, 10240
    s_add_u32 s66, s59, s65
    buffer_load_dwordx4 v[22:25], v1, s[44:47], s66 offen sc1
    s_add_u32 s66, s60, s65
    buffer_load_dwordx4 v[26:29], v1, s[44:47], s66 offen sc1
    s_add_u32 s66, s61, s65
    buffer_load_dwordx4 v[30:33], v1, s[44:47], s66 offen sc1
    s_waitcnt vmcnt(9) lgkmcnt(0)
K2D_CHK1:
    v_max3_u32 v166, v34, v35, v36
    v_max3_u32 v166, v166, v37, v38
    v_max3_u32 v166, v166, v39, v40
    v_max3_u32 v166, v166, v41, v42
    v_max3_u32 v166, v166, v43, v44
    v_max_u32 v166, v166, v45
    v_cmp_eq_u32 vcc, -1, v166
    s_nop 1
    s_cmp_eq_u64 vcc, 0
    s_cbranch_scc1 K2D_OK1
    s_sub_u32 s16, s16, 1
    s_cmp_eq_u32 s16, 0
    s_cbranch_scc1 K2D_OK1
    s_sleep 2
    s_mul_i32 s64, s56, 8
    s_add_u32 s64, s64, 1
    s_add_u32 s65, s64, 96
    s_lshl_b32 s65, s65, 10
    s_mul_i32 s62, s64, 25600
    s_add_u32 s62, s62, s58
    s_add_u32 s63, s62, 10240
    s_add_u32 s66, s59, s65
    buffer_load_dwordx4 v[34:37], v1, s[44:47], s66 offen sc1
    s_add_u32 s66, s60, s65
    buffer_load_dwordx4 v[38:41], v1, s[44:47], s66 offen sc1
    s_add_u32 s66, s61, s65
    buffer_load_dwordx4 v[42:45], v1, s[44:47], s66 offen sc1
    s_waitcnt vmcnt(0)
    s_branch K2D_CHK1
K2D_OK1:
    v_mfma_f32_32x32x16_bf16 v[70:85], v[14:17], v[34:37], v[70:85]
    ds_read_b64_tr_b16 v[6:7], v4 offset:4096
    ds_read_b64_tr_b16 v[8:9], v4 offset:5120
    v_mfma_f32_32x32x16_bf16 v[86:101], v[18:21], v[34:37], v[86:101]
    ds_read_b64_tr_b16 v[10:11], v5 offset:4096
    ds_read_b64_tr_b16 v[12:13], v5 offset:5120
    v_mfma_f32_32x32x16_bf16 v[102:117], v[14:17], v[38:41], v[102:117]
    v_mfma_f32_32x32x16_bf16 v[118:133], v[18:21], v[38:41], v[118:133]
    v_mfma_f32_32x32x16_bf16 v[134:149], v[14:17], v[42:45], v[134:149]
    v_mfma_f32_32x32x16_bf16 v[150:165], v[18:21], v[42:45], v[150:165]
    s_mul_i32 s64, s56, 8
    s_add_u32 s64, s64, 5
    s_add_u32 s65, s64, 96
    s_lshl_b32 s65, s65, 10
    s_mul_i32 s62, s64, 25600
    s_add_u32 s62, s62, s58
    s_add_u32 s63, s62, 10240
    s_add_u32 s66, s59, s65
    buffer_load_dwordx4 v[34:37], v1, s[44:47], s66 offen sc1
    s_add_u32 s66, s60, s65
    buffer_load_dwordx4 v[38:41], v1, s[44:47], s66 offen sc1
    s_add_u32 s66, s61, s65
    buffer_load_dwordx4 v[42:45], v1, s[44:47], s66 offen sc1
    s_waitcnt vmcnt(9) lgkmcnt(0)
K2D_CHK2:
    v_max3_u32 v166, v46, v47, v48
    v_max3_u32 v166, v166, v49, v50
    v_max3_u32 v166, v166, v51, v52
    v_max3_u32 v166, v166, v53, v54
    v_max3_u32 v166, v166, v55, v56
    v_max_u32 v166, v166, v57
    v_cmp_eq_u32 vcc, -1, v166
    s_nop 1
    s_cmp_eq_u64 vcc, 0
    s_cbranch_scc1 K2D_OK2
    s_sub_u32 s16, s16, 1
    s_cmp_eq_u32 s16, 0
    s_cbranch_scc1 K2D_OK2
    s_sleep 2
    s_mul_i32 s64, s56, 8
    s_add_u32 s64, s64, 2
    s_add_u32 s65, s64, 96
    s_lshl_b32 s65, s65, 10
    s_mul_i32 s62, s64, 25600
    s_add_u32 s62, s62, s58
    s_add_u32 s63, s62, 10240
    s_add_u32 s66, s59, s65
    buffer_load_dwordx4 v[46:49], v1, s[44:47], s66 offen sc1
    s_add_u32 s66, s60, s65
    buffer_load_dwordx4 v[50:53], v1, s[44:47], s66 offen sc1
    s_add_u32 s66, s61, s65
    buffer_load_dwordx4 v[54:57], v1, s[44:47], s66 offen sc1
    s_waitcnt vmcnt(0)
    s_branch K2D_CHK2
K2D_OK2:
    v_mfma_f32_32x32x16_bf16 v[70:85], v[6:9], v[46:49], v[70:85]
    ds_read_b64_tr_b16 v[14:15], v4 offset:6144
    ds_read_b64_tr_b16 v[16:17], v4 offset:7168
    v_mfma_f32_32x32x16_bf16 v[86:101], v[10:13], v[46:49], v[86:101]
    ds_read_b64_tr_b16 v[18:19], v5 offset:6144
    ds_read_b64_tr_b16 v[20:21], v5 offset:7168
    v_mfma_f32_32x32x16_bf16 v[102:117], v[6:9], v[50:53], v[102:117]
    v_mfma_f32_32x32x16_bf16 v[118:133], v[10:13], v[50:53], v[118:133]
    v_mfma_f32_32x32x16_bf16 v[134:149], v[6:9], v[54:57], v[134:149]
    v_mfma_f32_32x32x16_bf16 v[150:165], v[10:13], v[54:57], v[150:165]
    s_mul_i32 s64, s56, 8
    s_add_u32 s64, s64, 6
    s_add_u32 s65, s64, 96
    s_lshl_b32 s65, s65, 10
    s_mul_i32 s62, s64, 25600
    s_add_u32 s62, s62, s58
    s_add_u32 s63, s62, 10240
    s_add_u32 s66, s59, s65
    buffer_load_dwordx4 v[46:49], v1, s[44:47], s66 offen sc1
    s_add_u32 s66, s60, s65
    buffer_load_dwordx4 v[50:53], v1, s[44:47], s66 offen sc1
    s_add_u32 s66, s61, s65
    buffer_load_dwordx4 v[54:57], v1, s[44:47], s66 offen sc1
    s_waitcnt vmcnt(9) lgkmcnt(0)
K2D_CHK3:
    v_max3_u32 v166, v58, v59, v60
    v_max3_u32 v166, v166, v61, v62
    v_max3_u32 v166, v166, v63, v64
    v_max3_u32 v166, v166, v65, v66
    v_max3_u32 v166, v166, v67, v68
    v_max_u32 v166, v166, v69
    v_cmp_eq_u32 vcc, -1, v166
    s_nop 1
    s_cmp_eq_u64 vcc, 0
    s_cbranch_scc1 K2D_OK3
    s_sub_u32 s16, s16, 1
    s_cmp_eq_u32 s16, 0
    s_cbranch_scc1 K2D_OK3
    s_sleep 2
    s_mul_i32 s64, s56, 8
    s_add_u32 s64, s64, 3
    s_add_u32 s65, s64, 96
    s_lshl_b32 s65, s65, 10
    s_mul_i32 s62, s64, 25600
    s_add_u32 s62, s62, s58
    s_add_u32 s63, s62, 10240
    s_add_u32 s66, s59, s65
    buffer_load_dwordx4 v[58:61], v1, s[44:47], s66 offen sc1
    s_add_u32 s66, s60, s65
    buffer_load_dwordx4 v[62:65], v1, s[44:47], s66 offen sc1
    s_add_u32 s66, s61, s65
    buffer_load_dwordx4 v[66:69], v1, s[44:47], s66 offen sc1
    s_waitcnt vmcnt(0)
    s_branch K2D_CHK3
K2D_OK3:
    v_mfma_f32_32x32x16_bf16 v[70:85], v[14:17], v[58:61], v[70:85]
    ds_read_b64_tr_b16 v[6:7], v4 offset:8192
    ds_read_b64_tr_b16 v[8:9], v4 offset:9216
    v_mfma_f32_32x32x16_bf16 v[86:101], v[18:21], v[58:61], v[86:101]
    ds_read_b64_tr_b16 v[10:11], v5 offset:8192
    ds_read_b64_tr_b16 v[12:13], v5 offset:9216
    v_mfma_f32_32x32x16_bf16 v[102:117], v[14:17], v[62:65], v[102:117]
    v_mfma_f32_32x32x16_bf16 v[118:133], v[18:21], v[62:65], v[118:133]
    v_mfma_f32_32x32x16_bf16 v[134:149], v[14:17], v[66:69], v[134:149]
    v_mfma_f32_32x32x16_bf16 v[150:165], v[18:21], v[66:69], v[150:165]
    s_mul_i32 s64, s56, 8
    s_add_u32 s64, s64, 7
    s_add_u32 s65, s64, 96
    s_lshl_b32 s65, s65, 10
    s_mul_i32 s62, s64, 25600
    s_add_u32 s62, s62, s58
    s_add_u32 s63, s62, 10240
    s_add_u32 s66, s59, s65
    buffer_load_dwordx4 v[58:61], v1, s[44:47], s66 offen sc1
    s_add_u32 s66, s60, s65
    buffer_load_dwordx4 v[62:65], v1, s[44:47], s66 offen sc1
    s_add_u32 s66, s61, s65
    buffer_load_dwordx4 v[66:69], v1, s[44:47], s66 offen sc1
    s_waitcnt vmcnt(9) lgkmcnt(0)
K2D_CHK4:
    v_max3_u32 v166, v22, v23, v24
    v_max3_u32 v166, v166, v25, v26
    v_max3_u32 v166, v166, v27, v28
    v_max3_u32 v166, v166, v29, v30
    v_max3_u32 v166, v166, v31, v32
    v_max_u32 v166, v166, v33
    v_cmp_eq_u32 vcc, -1, v166
    s_nop 1
    s_cmp_eq_u64 vcc, 0
    s_cbranch_scc1 K2D_OK4
    s_sub_u32 s16, s16, 1
    s_cmp_eq_u32 s16, 0
    s_cbranch_scc1 K2D_OK4
    s_sleep 2
    s_mul_i32 s64, s56, 8
    s_add_u32 s64, s64, 4
    s_add_u32 s65, s64, 96
    s_lshl_b32 s65, s65, 10
    s_mul_i32 s62, s64, 25600
    s_add_u32 s62, s62, s58
    s_add_u32 s63, s62, 10240
    s_add_u32 s66, s59, s65
    buffer_load_dwordx4 v[22:25], v1, s[44:47], s66 offen sc1
    s_add_u32 s66, s60, s65
    buffer_load_dwordx4 v[26:29], v1, s[44:47], s66 offen sc1
    s_add_u32 s66, s61, s65
    buffer_load_dwordx4 v[30:33], v1, s[44:47], s66 offen sc1
    s_waitcnt vmcnt(0)
    s_branch K2D_CHK4
K2D_OK4:
    v_mfma_f32_32x32x16_bf16 v[70:85], v[6:9], v[22:25], v[70:85]
    ds_read_b64_tr_b16 v[14:15], v4 offset:10240
    ds_read_b64_tr_b16 v[16:17], v4 offset:11264
    v_mfma_f32_32x32x16_bf16 v[86:101], v[10:13], v[22:25], v[86:101]
    ds_read_b64_tr_b16 v[18:19], v5 offset:10240
    ds_read_b64_tr_b16 v[20:21], v5 offset:11264
    v_mfma_f32_32x32x16_bf16 v[102:117], v[6:9], v[26:29], v[102:117]
    v_mfma_f32_32x32x16_bf16 v[118:133], v[10:13], v[26:29], v[118:133]
    v_mfma_f32_32x32x16_bf16 v[134:149], v[6:9], v[30:33], v[134:149]
    v_mfma_f32_32x32x16_bf16 v[150:165], v[10:13], v[30:33], v[150:165]
    s_mul_i32 s64, s56, 2
    s_add_u32 s64, s64, 0
    s_add_u32 s65, s64, 128
    s_lshl_b32 s65, s65, 10
    s_mul_i32 s62, s64, 102400
    s_add_u32 s62, s62, 20480
    s_add_u32 s62, s62, s58
    s_add_u32 s63, s62, 25600
    s_add_u32 s66, s59, s65
    buffer_load_dwordx4 v[22:25], v1, s[44:47], s66 offen sc1
    s_add_u32 s66, s60, s65
    buffer_load_dwordx4 v[26:29], v1, s[44:47], s66 offen sc1
    s_add_u32 s66, s61, s65
    buffer_load_dwordx4 v[30:33], v1, s[44:47], s66 offen sc1
    s_waitcnt vmcnt(9) lgkmcnt(0)
K2D_CHK5:
    v_max3_u32 v166, v34, v35, v36
    v_max3_u32 v166, v166, v37, v38
    v_max3_u32 v166, v166, v39, v40
    v_max3_u32 v166, v166, v41, v42
    v_max3_u32 v166, v166, v43, v44
    v_max_u32 v166, v166, v45
    v_cmp_eq_u32 vcc, -1, v166
    s_nop 1
    s_cmp_eq_u64 vcc, 0
    s_cbranch_scc1 K2D_OK5
    s_sub_u32 s16, s16, 1
    s_cmp_eq_u32 s16, 0
    s_cbranch_scc1 K2D_OK5
    s_sleep 2
    s_mul_i32 s64, s56, 8
    s_add_u32 s64, s64, 5
    s_add_u32 s65, s64, 96
    s_lshl_b32 s65, s65, 10
    s_mul_i32 s62, s64, 25600
    s_add_u32 s62, s62, s58
    s_add_u32 s63, s62, 10240
    s_add_u32 s66, s59, s65
    buffer_load_dwordx4 v[34:37], v1, s[44:47], s66 offen sc1
    s_add_u32 s66, s60, s65
    buffer_load_dwordx4 v[38:41], v1, s[44:47], s66 offen sc1
    s_add_u32 s66, s61, s65
    buffer_load_dwordx4 v[42:45], v1, s[44:47], s66 offen sc1
    s_waitcnt vmcnt(0)
    s_branch K2D_CHK5
K2D_OK5:
    v_mfma_f32_32x32x16_bf16 v[70:85], v[14:17], v[34:37], v[70:85]
    ds_read_b64_tr_b16 v[6:7], v4 offset:12288
    ds_read_b64_tr_b16 v[8:9], v4 offset:13312
    v_mfma_f32_32x32x16_bf16 v[86:101], v[18:21], v[34:37], v[86:101]
    ds_read_b64_tr_b16 v[10:11], v5 offset:12288
    ds_read_b64_tr_b16 v[12:13], v5 offset:13312
    v_mfma_f32_32x32x16_bf16 v[102:117], v[14:17], v[38:41], v[102:117]
    v_mfma_f32_32x32x16_bf16 v[118:133], v[18:21], v[38:41], v[118:133]
    v_mfma_f32_32x32x16_bf16 v[134:149], v[14:17], v[42:45], v[134:149]
    v_mfma_f32_32x32x16_bf16 v[150:165], v[18:21], v[42:45], v[150:165]
    s_mul_i32 s64, s56, 2
    s_add_u32 s64, s64, 1
    s_add_u32 s65, s64, 128
    s_lshl_b32 s65, s65, 10
    s_mul_i32 s62, s64, 102400
    s_add_u32 s62, s62, 20480
    s_add_u32 s62, s62, s58
    s_add_u32 s63, s62, 25600
    s_add_u32 s66, s59, s65
    buffer_load_dwordx4 v[34:37], v1, s[44:47], s66 offen sc1
    s_add_u32 s66, s60, s65
    buffer_load_dwordx4 v[38:41], v1, s[44:47], s66 offen sc1
    s_add_u32 s66, s61, s65
    buffer_load_dwordx4 v[42:45], v1, s[44:47], s66 offen sc1
    s_waitcnt vmcnt(9) lgkmcnt(0)
K2D_CHK6:
    v_max3_u32 v166, v46, v47, v48
    v_max3_u32 v166, v166, v49, v50
    v_max3_u32 v166, v166, v51, v52
    v_max3_u32 v166, v166, v53, v54
    v_max3_u32 v166, v166, v55, v56
    v_max_u32 v166, v166, v57
    v_cmp_eq_u32 vcc, -1, v166
    s_nop 1
    s_cmp_eq_u64 vcc, 0
    s_cbranch_scc1 K2D_OK6
    s_sub_u32 s16, s16, 1
    s_cmp_eq_u32 s16, 0
    s_cbranch_scc1 K2D_OK6
    s_sleep 2
    s_mul_i32 s64, s56, 8
    s_add_u32 s64, s64, 6
    s_add_u32 s65, s64, 96
    s_lshl_b32 s65, s65, 10
    s_mul_i32 s62, s64, 25600
    s_add_u32 s62, s62, s58
    s_add_u32 s63, s62, 10240
    s_add_u32 s66, s59, s65
    buffer_load_dwordx4 v[46:49], v1, s[44:47], s66 offen sc1
    s_add_u32 s66, s60, s65
    buffer_load_dwordx4 v[50:53], v1, s[44:47], s66 offen sc1
    s_add_u32 s66, s61, s65
    buffer_load_dwordx4 v[54:57], v1, s[44:47], s66 offen sc1
    s_waitcnt vmcnt(0)
    s_branch K2D_CHK6
K2D_OK6:
    v_mfma_f32_32x32x16_bf16 v[70:85], v[6:9], v[46:49], v[70:85]
    ds_read_b64_tr_b16 v[14:15], v4 offset:14336
    ds_read_b64_tr_b16 v[16:17], v4 offset:15360
    v_mfma_f32_32x32x16_bf16 v[86:101], v[10:13], v[46:49], v[86:101]
    ds_read_b64_tr_b16 v[18:19], v5 offset:14336
    ds_read_b64_tr_b16 v[20:21], v5 offset:15360
    v_mfma_f32_32x32x16_bf16 v[102:117], v[6:9], v[50:53], v[102:117]
    v_mfma_f32_32x32x16_bf16 v[118:133], v[10:13], v[50:53], v[118:133]
    v_mfma_f32_32x32x16_bf16 v[134:149], v[6:9], v[54:57], v[134:149]
    v_mfma_f32_32x32x16_bf16 v[150:165], v[10:13], v[54:57], v[150:165]
    s_waitcnt vmcnt(6) lgkmcnt(0)
K2D_CHK7:
    v_max3_u32 v166, v58, v59, v60
    v_max3_u32 v166, v166, v61, v62
    v_max3_u32 v166, v166, v63, v64
    v_max3_u32 v166, v166, v65, v66
    v_max3_u32 v166, v166, v67, v68
    v_max_u32 v166, v166, v69
    v_cmp_eq_u32 vcc, -1, v166
    s_nop 1
    s_cmp_eq_u64 vcc, 0
    s_cbranch_scc1 K2D_OK7
    s_sub_u32 s16, s16, 1
    s_cmp_eq_u32 s16, 0
    s_cbranch_scc1 K2D_OK7
    s_sleep 2
    s_mul_i32 s64, s56, 8
    s_add_u32 s64, s64, 7
    s_add_u32 s65, s64, 96
    s_lshl_b32 s65, s65, 10
    s_mul_i32 s62, s64, 25600
    s_add_u32 s62, s62, s58
    s_add_u32 s63, s62, 10240
    s_add_u32 s66, s59, s65
    buffer_load_dwordx4 v[58:61], v1, s[44:47], s66 offen sc1
    s_add_u32 s66, s60, s65
    buffer_load_dwordx4 v[62:65], v1, s[44:47], s66 offen sc1
    s_add_u32 s66, s61, s65
    buffer_load_dwordx4 v[66:69], v1, s[44:47], s66 offen sc1
    s_waitcnt vmcnt(0)
    s_branch K2D_CHK7
K2D_OK7:
    v_mfma_f32_32x32x16_bf16 v[70:85], v[14:17], v[58:61], v[70:85]
    ds_read_b64_tr_b16 v[6:7], v4 offset:16384
    ds_read_b64_tr_b16 v[8:9], v4 offset:17408
    v_mfma_f32_32x32x16_bf16 v[86:101], v[18:21], v[58:61], v[86:101]
    ds_read_b64_tr_b16 v[10:11], v5 offset:16384
    ds_read_b64_tr_b16 v[12:13], v5 offset:17408
    v_mfma_f32_32x32x16_bf16 v[102:117], v[14:17], v[62:65], v[102:117]
    v_mfma_f32_32x32x16_bf16 v[118:133], v[18:21], v[62:65], v[118:133]
    v_mfma_f32_32x32x16_bf16 v[134:149], v[14:17], v[66:69], v[134:149]
    v_mfma_f32_32x32x16_bf16 v[150:165], v[18:21], v[66:69], v[150:165]
    s_waitcnt vmcnt(3) lgkmcnt(0)
K2D_CHK8:
    v_max3_u32 v166, v22, v23, v24
    v_max3_u32 v166, v166, v25, v26
    v_max3_u32 v166, v166, v27, v28
    v_max3_u32 v166, v166, v29, v30
    v_max3_u32 v166, v166, v31, v32
    v_max_u32 v166, v166, v33
    v_cmp_eq_u32 vcc, -1, v166
    s_nop 1
    s_cmp_eq_u64 vcc, 0
    s_cbranch_scc1 K2D_OK8
    s_sub_u32 s16, s16, 1
    s_cmp_eq_u32 s16, 0
    s_cbranch_scc1 K2D_OK8
    s_sleep 2
    s_mul_i32 s64, s56, 2
    s_add_u32 s64, s64, 0
    s_add_u32 s65, s64, 128
    s_lshl_b32 s65, s65, 10
    s_mul_i32 s62, s64, 102400
    s_add_u32 s62, s62, 20480
    s_add_u32 s62, s62, s58
    s_add_u32 s63, s62, 25600
    s_add_u32 s66, s59, s65
    buffer_load_dwordx4 v[22:25], v1, s[44:47], s66 offen sc1
    s_add_u32 s66, s60, s65
    buffer_load_dwordx4 v[26:29], v1, s[44:47], s66 offen sc1
    s_add_u32 s66, s61, s65
    buffer_load_dwordx4 v[30:33], v1, s[44:47], s66 offen sc1
    s_waitcnt vmcnt(0)
    s_branch K2D_CHK8
K2D_OK8:
    v_mfma_f32_32x32x16_bf16 v[70:85], v[6:9], v[22:25], v[70:85]
    ds_read_b64_tr_b16 v[14:15], v4 offset:18432
    ds_read_b64_tr_b16 v[16:17], v4 offset:19456
    v_mfma_f32_32x32x16_bf16 v[86:101], v[10:13], v[22:25], v[86:101]
    ds_read_b64_tr_b16 v[18:19], v5 offset:18432
    ds_read_b64_tr_b16 v[20:21], v5 offset:19456
    v_mfma_f32_32x32x16_bf16 v[102:117], v[6:9], v[26:29], v[102:117]
    v_mfma_f32_32x32x16_bf16 v[118:133], v[10:13], v[26:29], v[118:133]
    v_mfma_f32_32x32x16_bf16 v[134:149], v[6:9], v[30:33], v[134:149]
    v_mfma_f32_32x32x16_bf16 v[150:165], v[10:13], v[30:33], v[150:165]
    s_waitcnt vmcnt(0) lgkmcnt(0)
K2D_CHK9:
    v_max3_u32 v166, v34, v35, v36
    v_max3_u32 v166, v166, v37, v38
    v_max3_u32 v166, v166, v39, v40
    v_max3_u32 v166, v166, v41, v42
    v_max3_u32 v166, v166, v43, v44
    v_max_u32 v166, v166, v45
    v_cmp_eq_u32 vcc, -1, v166
    s_nop 1
    s_cmp_eq_u64 vcc, 0
    s_cbranch_scc1 K2D_OK9
    s_sub_u32 s16, s16, 1
    s_cmp_eq_u32 s16, 0
    s_cbranch_scc1 K2D_OK9
    s_sleep 2
    s_mul_i32 s64, s56, 2
    s_add_u32 s64, s64, 1
    s_add_u32 s65, s64, 128
    s_lshl_b32 s65, s65, 10
    s_mul_i32 s62, s64, 102400
    s_add_u32 s62, s62, 20480
    s_add_u32 s62, s62, s58
    s_add_u32 s63, s62, 25600
    s_add_u32 s66, s59, s65
    buffer_load_dwordx4 v[34:37], v1, s[44:47], s66 offen sc1
    s_add_u32 s66, s60, s65
    buffer_load_dwordx4 v[38:41], v1, s[44:47], s66 offen sc1
    s_add_u32 s66, s61, s65
    buffer_load_dwordx4 v[42:45], v1, s[44:47], s66 offen sc1
    s_waitcnt vmcnt(0)
    s_branch K2D_CHK9
K2D_OK9:
    v_mfma_f32_32x32x16_bf16 v[70:85], v[14:17], v[34:37], v[70:85]
    v_mfma_f32_32x32x16_bf16 v[86:101], v[18:21], v[34:37], v[86:101]
    v_mfma_f32_32x32x16_bf16 v[102:117], v[14:17], v[38:41], v[102:117]
    v_mfma_f32_32x32x16_bf16 v[118:133], v[18:21], v[38:41], v[118:133]
    v_mfma_f32_32x32x16_bf16 v[134:149], v[14:17], v[42:45], v[134:149]
    v_mfma_f32_32x32x16_bf16 v[150:165], v[18:21], v[42:45], v[150:165]
    s_nop 7
    s_nop 7
    s_barrier
    v_and_b32 v12, 31, v0
    v_lshrrev_b32 v13, 5, v0
    v_mul_u32_u24 v6, 272, v12
    v_lshl_add_u32 v6, v13, 4, v6
    s_mul_i32 s3, s56, 26112
    s_add_u32 s3, s3, 0
    v_add_u32 v6, s3, v6
    s_lshl_b32 s3, s56, 6
    v_add_u32 v12, s3, v0
    v_lshrrev_b32 v13, 3, v12
    v_and_b32 v14, 7, v12
    v_mul_u32_u24 v7, 272, v13
    v_lshl_add_u32 v7, v14, 5, v7
    v_add_u32 v7, 0, v7
    s_mul_i32 s3, s57, 96
    v_add_u32 v13, s3, v13
    v_mul_u32_u24 v13, 1280, v13
    v_lshl_add_u32 v13, v14, 4, v13
    v_add_u32 v9, s58, v13
    v_add_u32 v8, 52224, v7
    v_add_u32 v10, 40960, v9
    v_add_u32 v11, 81920, v9
    buffer_load_dwordx4 v[22:25], v9, s[36:39], 0 offen
    buffer_load_dwordx4 v[26:29], v10, s[36:39], 0 offen
    buffer_load_dwordx4 v[30:33], v11, s[36:39], 0 offen
    ds_write_b128 v6, v[70:73] offset:0
    ds_write_b128 v6, v[74:77] offset:32
    ds_write_b128 v6, v[78:81] offset:64
    ds_write_b128 v6, v[82:85] offset:96
    ds_write_b128 v6, v[86:89] offset:128
    ds_write_b128 v6, v[90:93] offset:160
    ds_write_b128 v6, v[94:97] offset:192
    ds_write_b128 v6, v[98:101] offset:224
    ds_write_b128 v6, v[102:105] offset:8704
    ds_write_b128 v6, v[106:109] offset:8736
    ds_write_b128 v6, v[110:113] offset:8768
    ds_write_b128 v6, v[114:117] offset:8800
    ds_write_b128 v6, v[118:121] offset:8832
    ds_write_b128 v6, v[122:125] offset:8864
    ds_write_b128 v6, v[126:129] offset:8896
    ds_write_b128 v6, v[130:133] offset:8928
    ds_write_b128 v6, v[134:137] offset:17408
    ds_write_b128 v6, v[138:141] offset:17440
    ds_write_b128 v6, v[142:145] offset:17472
    ds_write_b128 v6, v[146:149] offset:17504
    ds_write_b128 v6, v[150:153] offset:17536
    ds_write_b128 v6, v[154:157] offset:17568
    ds_write_b128 v6, v[158:161] offset:17600
    ds_write_b128 v6, v[162:165] offset:17632
    s_waitcnt lgkmcnt(0)
    s_barrier
    ds_read_b128 v[70:73], v7 offset:0
    ds_read_b128 v[74:77], v7 offset:16
    ds_read_b128 v[78:81], v7 offset:26112
    ds_read_b128 v[82:85], v7 offset:26128
    ds_read_b128 v[86:89], v8 offset:0
    ds_read_b128 v[90:93], v8 offset:16
    ds_read_b128 v[94:97], v8 offset:26112
    ds_read_b128 v[98:101], v8 offset:26128
    s_waitcnt lgkmcnt(0)
    ds_read_b128 v[102:105], v7 offset:8704
    ds_read_b128 v[106:109], v7 offset:8720
    ds_read_b128 v[110:113], v7 offset:34816
    ds_read_b128 v[114:117], v7 offset:34832
    ds_read_b128 v[118:121], v8 offset:8704
    ds_read_b128 v[122:125], v8 offset:8720
    ds_read_b128 v[126:129], v8 offset:34816
    ds_read_b128 v[130:133], v8 offset:34832
    v_add_f32 v70, v70, v78
    v_add_f32 v71, v71, v79
    v_add_f32 v72, v72, v80
    v_add_f32 v73, v73, v81
    v_add_f32 v74, v74, v82
    v_add_f32 v75, v75, v83
    v_add_f32 v76, v76, v84
    v_add_f32 v77, v77, v85
    v_add_f32 v86, v86, v94
    v_add_f32 v87, v87, v95
    v_add_f32 v88, v88, v96
    v_add_f32 v89, v89, v97
    v_add_f32 v90, v90, v98
    v_add_f32 v91, v91, v99
    v_add_f32 v92, v92, v100
    v_add_f32 v93, v93, v101
    v_add_f32 v70, v70, v86
    v_add_f32 v71, v71, v87
    v_add_f32 v72, v72, v88
    v_add_f32 v73, v73, v89
    v_add_f32 v74, v74, v90
    v_add_f32 v75, v75, v91
    v_add_f32 v76, v76, v92
    v_add_f32 v77, v77, v93
    s_waitcnt vmcnt(2)
    v_lshlrev_b32 v12, 16, v22
    v_and_b32 v13, 0xffff0000, v22
    v_add_f32 v70, v70, v12
    v_add_f32 v71, v71, v13
    v_lshlrev_b32 v12, 16, v23
    v_and_b32 v13, 0xffff0000, v23
    v_add_f32 v72, v72, v12
    v_add_f32 v73, v73, v13
    v_lshlrev_b32 v12, 16, v24
    v_and_b32 v13, 0xffff0000, v24
    v_add_f32 v74, v74, v12
    v_add_f32 v75, v75, v13
    v_lshlrev_b32 v12, 16, v25
    v_and_b32 v13, 0xffff0000, v25
    v_add_f32 v76, v76, v12
    v_add_f32 v77, v77, v13
    v_cvt_pk_bf16_f32 v78, v70, v71
    v_cvt_pk_bf16_f32 v79, v72, v73
    v_cvt_pk_bf16_f32 v80, v74, v75
    v_cvt_pk_bf16_f32 v81, v76, v77
    buffer_store_dwordx4 v[78:81], v9, s[40:43], 0 offen nt
    s_waitcnt lgkmcnt(0)
    ds_read_b128 v[134:137], v7 offset:17408
    ds_read_b128 v[138:141], v7 offset:17424
    ds_read_b128 v[142:145], v7 offset:43520
    ds_read_b128 v[146:149], v7 offset:43536
    ds_read_b128 v[150:153], v8 offset:17408
    ds_read_b128 v[154:157], v8 offset:17424
    ds_read_b128 v[158:161], v8 offset:43520
    ds_read_b128 v[162:165], v8 offset:43536
    v_add_f32 v102, v102, v110
    v_add_f32 v103, v103, v111
    v_add_f32 v104, v104, v112
    v_add_f32 v105, v105, v113
    v_add_f32 v106, v106, v114
    v_add_f32 v107, v107, v115
    v_add_f32 v108, v108, v116
    v_add_f32 v109, v109, v117
    v_add_f32 v118, v118, v126
    v_add_f32 v119, v119, v127
    v_add_f32 v120, v120, v128
    v_add_f32 v121, v121, v129
    v_add_f32 v122, v122, v130
    v_add_f32 v123, v123, v131
    v_add_f32 v124, v124, v132
    v_add_f32 v125, v125, v133
    v_add_f32 v102, v102, v118
    v_add_f32 v103, v103, v119
    v_add_f32 v104, v104, v120
    v_add_f32 v105, v105, v121
    v_add_f32 v106, v106, v122
    v_add_f32 v107, v107, v123
    v_add_f32 v108, v108, v124
    v_add_f32 v109, v109, v125
    s_waitcnt vmcnt(2)
    v_lshlrev_b32 v12, 16, v26
    v_and_b32 v13, 0xffff0000, v26
    v_add_f32 v102, v102, v12
    v_add_f32 v103, v103, v13
    v_lshlrev_b32 v12, 16, v27
    v_and_b32 v13, 0xffff0000, v27
    v_add_f32 v104, v104, v12
    v_add_f32 v105, v105, v13
    v_lshlrev_b32 v12, 16, v28
    v_and_b32 v13, 0xffff0000, v28
    v_add_f32 v106, v106, v12
    v_add_f32 v107, v107, v13
    v_lshlrev_b32 v12, 16, v29
    v_and_b32 v13, 0xffff0000, v29
    v_add_f32 v108, v108, v12
    v_add_f32 v109, v109, v13
    v_cvt_pk_bf16_f32 v110, v102, v103
    v_cvt_pk_bf16_f32 v111, v104, v105
    v_cvt_pk_bf16_f32 v112, v106, v107
    v_cvt_pk_bf16_f32 v113, v108, v109
    buffer_store_dwordx4 v[110:113], v10, s[40:43], 0 offen nt
    s_waitcnt lgkmcnt(0)
    v_add_f32 v134, v134, v142
    v_add_f32 v135, v135, v143
    v_add_f32 v136, v136, v144
    v_add_f32 v137, v137, v145
    v_add_f32 v138, v138, v146
    v_add_f32 v139, v139, v147
    v_add_f32 v140, v140, v148
    v_add_f32 v141, v141, v149
    v_add_f32 v150, v150, v158
    v_add_f32 v151, v151, v159
    v_add_f32 v152, v152, v160
    v_add_f32 v153, v153, v161
    v_add_f32 v154, v154, v162
    v_add_f32 v155, v155, v163
    v_add_f32 v156, v156, v164
    v_add_f32 v157, v157, v165
    v_add_f32 v134, v134, v150
    v_add_f32 v135, v135, v151
    v_add_f32 v136, v136, v152
    v_add_f32 v137, v137, v153
    v_add_f32 v138, v138, v154
    v_add_f32 v139, v139, v155
    v_add_f32 v140, v140, v156
    v_add_f32 v141, v141, v157
    s_waitcnt vmcnt(2)
    v_lshlrev_b32 v12, 16, v30
    v_and_b32 v13, 0xffff0000, v30
    v_add_f32 v134, v134, v12
    v_add_f32 v135, v135, v13
    v_lshlrev_b32 v12, 16, v31
    v_and_b32 v13, 0xffff0000, v31
    v_add_f32 v136, v136, v12
    v_add_f32 v137, v137, v13
    v_lshlrev_b32 v12, 16, v32
    v_and_b32 v13, 0xffff0000, v32
    v_add_f32 v138, v138, v12
    v_add_f32 v139, v139, v13
    v_lshlrev_b32 v12, 16, v33
    v_and_b32 v13, 0xffff0000, v33
    v_add_f32 v140, v140, v12
    v_add_f32 v141, v141, v13
    v_cvt_pk_bf16_f32 v142, v134, v135
    v_cvt_pk_bf16_f32 v143, v136, v137
    v_cvt_pk_bf16_f32 v144, v138, v139
    v_cvt_pk_bf16_f32 v145, v140, v141
    buffer_store_dwordx4 v[142:145], v11, s[40:43], 0 offen nt
K2_FIN:
K2_END:
    s_endpgm
.section .rodata,"a"
.p2align 6
.amdhsa_kernel k1_proj_kernel
  .amdhsa_next_free_vgpr 256
  .amdhsa_next_free_sgpr 102
  .amdhsa_accum_offset 256
  .amdhsa_group_segment_fixed_size 0
  .amdhsa_kernarg_size 80
  .amdhsa_user_sgpr_count 2
  .amdhsa_user_sgpr_kernarg_segment_ptr 1
  .amdhsa_system_sgpr_workgroup_id_x 1
.end_amdhsa_kernel
.p2align 6
.amdhsa_kernel k2_attn_kernel
  .amdhsa_next_free_vgpr 168
  .amdhsa_next_free_sgpr 102
  .amdhsa_accum_offset 168
  .amdhsa_group_segment_fixed_size 0
  .amdhsa_kernarg_size 80
  .amdhsa_user_sgpr_count 2
  .amdhsa_user_sgpr_kernarg_segment_ptr 1
  .amdhsa_system_sgpr_workgroup_id_x 1
.end_amdhsa_kernel
```
